```python
import torch

def _softmax(x, axis=-1):
    return torch.softmax(x, dim=axis)
def _gelu(x):
    return torch.nn.functional.gelu(x, approximate="tanh")
def _silu(x):
    return torch.nn.functional.silu(x)
def _sigmoid(x):
    return torch.sigmoid(x)
def _layernorm(x, axis=-1, eps=1e-5):
    m = x.mean(dim=axis, keepdim=True)
    v = x.var(dim=axis, keepdim=True, unbiased=False)
    return (x - m) / torch.sqrt(v + eps)
def _scatter_add(tgt, idx, src, axis=0):
    return tgt.clone().index_add_(axis, idx, src)
def _segment_sum(src, seg, n):
    out = torch.zeros((n,) + src.shape[1:], dtype=src.dtype)
    return out.index_add_(0, seg, src)
def _pad(x, pw):
    flat = tuple(v for pair in reversed(pw) for v in pair)
    return torch.nn.functional.pad(x, flat)

kernel_name = 'concat_heads__sliding_local_dilated__linear_attn_block__prompt'

def setup_inputs():

    _w = (lambda a: (lambda t: t.to(torch.bfloat16) if t.is_floating_point() else t)(torch.as_tensor(a)))
    def _A_setup():
        B, S, D = 1, 2048, 640
        return {
            "x": _w((lambda *s: torch.randn(*s, dtype=torch.bfloat16) * 0.2)(B, S, D)),
            "wqkv": _w((lambda *s: torch.randn(*s, dtype=torch.bfloat16) * 0.2)(D, 3 * D)),
            "wo": _w((lambda *s: torch.randn(*s, dtype=torch.bfloat16) * 0.05)(D, D)),
        }
    _A_in = _A_setup()

    def _B_setup():
        B, S, D = 1, 2048, 640
        return {
            "x": _w((lambda *s: torch.randn(*s, dtype=torch.bfloat16) * 0.05)(B, S, D)),
            "wqkv": _w((lambda *s: torch.randn(*s, dtype=torch.bfloat16) * 1.6)(D, 3 * D)),
            "wo": _w((lambda *s: torch.randn(*s, dtype=torch.bfloat16) * 0.8)(D, D)),
        }
    _B_in = _B_setup()

    return {
        "A_x": _A_in["x"],
        "A_wqkv": _A_in["wqkv"],
        "A_wo": _A_in["wo"],
        "B_x": _B_in["x"],
        "B_wqkv": _B_in["wqkv"],
        "B_wo": _B_in["wo"],
    }

def reference(A_x, A_wqkv, A_wo, B_x, B_wqkv, B_wo):
    def _A_ref(x, wqkv, wo):
        B, S, D = x.shape
        H = 32; Dh = D // H
        W, dil = 8, 2
        qkv = (lambda x, *d: x.permute(*d))((x @ wqkv).reshape(B, S, 3, H, Dh), 2, 0, 3, 1, 4)
        q, k, v = qkv[0], qkv[1], qkv[2]
        scale = Dh ** -0.5
        pos = torch.arange(S)
        off = torch.arange(W) * dil
        idx = pos[:, None] - off[None, :]
        mask = idx >= 0
        idx_c = torch.where(mask, idx, 0).reshape(-1)
        kg = k[:, :, idx_c, :].reshape(B, H, S, W, Dh)
        vg = v[:, :, idx_c, :].reshape(B, H, S, W, Dh)
        logits = torch.einsum("bhsd,bhswd->bhsw", q, kg) * scale
        logits = torch.where(mask[None, None, :, :], logits, -1e9)
        attn = _softmax(logits, axis=-1)
        o = torch.einsum("bhsw,bhswd->bhsd", attn, vg)
        return (lambda x, *d: x.permute(*d))(o, 0, 2, 1, 3).reshape(B, S, D) @ wo

    def _B_ref(x, wqkv, wo):
        B, S, D = x.shape
        H = 32; Dh = D // H
        qkv = (lambda x, *d: x.permute(*d))((x @ wqkv).reshape(B, S, 3, H, Dh), 2, 0, 3, 1, 4)
        q, k, v = qkv[0], qkv[1], qkv[2]
        phi = lambda t: torch.where(t > 0, t + 1, torch.exp(t)) + 1e-6
        pq, pk = phi(q), phi(k)
        kv = torch.einsum("bhsd,bhse->bhde", pk, v)
        z = torch.einsum("bhsd->bhd", pk)
        num = torch.einsum("bhqd,bhde->bhqe", pq, kv)
        den = torch.einsum("bhqd,bhd->bhq", pq, z)[..., None] + 1e-6
        o = num / den
        return (lambda x, *d: x.permute(*d))(o, 0, 2, 1, 3).reshape(B, S, D) @ wo

    a = _A_ref(A_x, A_wqkv, A_wo)
    b = _B_ref(B_x, B_wqkv, B_wo)
    return torch.concatenate([a, b], axis=-1)
```

```asm
; @launch grid=(256,1,1) block=(256,1,1) lds=163840
.amdgcn_target "amdgcn-amd-amdhsa--gfx950"
.text
.globl concat_heads__sliding_local_dilated__linear_attn_block__prompt_kernel
.p2align 8
.type concat_heads__sliding_local_dilated__linear_attn_block__prompt_kernel,@function
concat_heads__sliding_local_dilated__linear_attn_block__prompt_kernel:
  s_cmp_ge_u32 s2, 0x100
  s_cbranch_scc1 L_end
  s_load_dwordx16 s[4:19], s[0:1], 0
  s_load_dwordx2 s[20:21], s[0:1], 64
  v_lshrrev_b32 v4, 6, v0
  v_and_b32 v1, 63, v0
  v_readfirstlane_b32 s22, v4
  s_and_b32 s26, s2, 7
  s_lshr_b32 s3, s2, 3
  s_lshr_b32 s25, s26, 2
  s_and_b32 s23, s26, 1
  s_lshl_b32 s23, s23, 3
  s_bfe_u32 s24, s26, 0x10001
  s_lshl_b32 s24, s24, 2
  s_or_b32 s72, s23, s24
  s_and_b32 s27, s3, 3
  s_or_b32 s72, s72, s27
  s_lshr_b32 s73, s3, 2
  s_and_b32 s27, s3, 7
  s_or_b32 s23, s23, s27
  s_lshr_b32 s27, s3, 3
  s_or_b32 s24, s24, s27
  v_lshlrev_b32 v6, 4, v1
  v_mul_u32_u24 v8, 0x199a, v1
  s_mov_b32 s83, 0x3c00
  s_mov_b32 s84, 0xe60
  s_mul_i32 s26, s24, 0xa0
  v_add_u32 v9, s26, v6
  v_mov_b32 v4, v8
  v_lshrrev_b32 v4, 16, v4
  v_bfe_u32 v5, v4, 2, 1
  v_bfe_u32 v10, v4, 3, 1
  v_sub_u32 v5, v5, v10
  v_mad_i32_i24 v10, v5, s83, v9
  v_mad_u32_u24 v10, v4, s84, v10
  v_add_u32 v4, 0x66680, v8
  v_lshrrev_b32 v4, 16, v4
  v_bfe_u32 v5, v4, 2, 1
  v_bfe_u32 v11, v4, 3, 1
  v_sub_u32 v5, v5, v11
  v_mad_i32_i24 v11, v5, s83, v9
  v_mad_u32_u24 v11, v4, s84, v11
  v_add_u32 v4, 0xccd00, v8
  v_lshrrev_b32 v4, 16, v4
  v_bfe_u32 v5, v4, 2, 1
  v_bfe_u32 v12, v4, 3, 1
  v_sub_u32 v5, v5, v12
  v_mad_i32_i24 v12, v5, s83, v9
  v_mad_u32_u24 v12, v4, s84, v12
  v_add_u32 v4, 0x133380, v8
  v_lshrrev_b32 v4, 16, v4
  v_bfe_u32 v5, v4, 2, 1
  v_bfe_u32 v13, v4, 3, 1
  v_sub_u32 v5, v5, v13
  v_mad_i32_i24 v13, v5, s83, v9
  v_mad_u32_u24 v13, v4, s84, v13
  v_add_u32 v4, 0x199a00, v8
  v_lshrrev_b32 v4, 16, v4
  v_bfe_u32 v5, v4, 2, 1
  v_bfe_u32 v14, v4, 3, 1
  v_sub_u32 v5, v5, v14
  v_mad_i32_i24 v14, v5, s83, v9
  v_mad_u32_u24 v14, v4, s84, v14
  v_add_u32 v14, 0x1000, v14
  s_add_u32 s26, s23, s24
  s_mul_i32 s27, s26, 52
  s_lshr_b32 s27, s27, 8
  s_mul_i32 s27, s27, 5
  s_sub_u32 s26, s26, s27
  s_mul_i32 s26, s26, 3
  s_mov_b32 s27, 0x3444688
  s_lshr_b32 s27, s27, s26
  s_bfe_u32 s76, s27, 0x30000
  s_lshl_b32 s76, s76, 8
  s_bfe_u32 s77, s27, 0x30003
  s_lshl_b32 s77, s77, 8
  s_bfe_u32 s78, s27, 0x30006
  s_lshl_b32 s78, s78, 8
  s_bfe_u32 s79, s27, 0x30009
  s_lshl_b32 s79, s79, 8
  s_bfe_u32 s80, s27, 0x3000c
  s_lshl_b32 s80, s80, 8
  s_mul_i32 s81, s22, 0x1e000
  s_mul_i32 s74, s22, 0x1400
  s_mul_i32 s82, s22, 0x2800
  s_add_u32 s82, s82, 0x1e000
  v_and_b32 v2, 15, v1
  v_lshrrev_b32 v3, 4, v1
  s_lshl_b32 s26, s23, 7
  s_lshr_b32 s27, s22, 1
  s_lshl_b32 s27, s27, 6
  s_add_u32 s26, s26, s27
  s_and_b32 s27, s22, 1
  s_add_u32 s26, s26, s27
  v_lshrrev_b32 v4, 3, v1
  v_lshl_add_u32 v4, v4, 1, s26
  v_mul_u32_u24 v4, 0x500, v4
  v_and_b32 v5, 1, v3
  v_lshlrev_b32 v9, 2, v5
  v_and_b32 v5, 2, v3
  v_or_b32 v5, v5, v9
  v_xor_b32 v5, v5, v1
  v_and_b32 v5, 7, v5
  v_lshl_add_u32 v4, v5, 4, v4
  s_lshr_b32 s27, s22, 1
  s_lshl_b32 s27, s27, 7
  v_add_u32 v15, s27, v4
  v_add_u32 v16, 0x4c00, v15
  v_add_u32 v17, 0xa000, v15
  v_add_u32 v18, 0xec00, v15
  s_lshr_b32 s27, s22, 1
  s_xor_b32 s27, s27, 1
  s_lshl_b32 s27, s27, 7
  v_add_u32 v19, s27, v4
  v_add_u32 v20, 0x4c00, v19
  v_add_u32 v21, 0xa000, v19
  v_add_u32 v22, 0xec00, v19
  v_and_b32 v5, 1, v3
  v_lshlrev_b32 v5, 1, v5
  v_xor_b32 v5, v5, v1
  v_and_b32 v5, 3, v5
  v_lshlrev_b32 v9, 4, v5
  s_waitcnt lgkmcnt(0)
  s_cmp_eq_u32 s25, 0
  s_cselect_b64 s[32:33], s[6:7], s[12:13]
  s_cselect_b64 s[28:29], s[4:5], s[10:11]
  s_and_b32 s33, s33, 0xffff
  s_mov_b32 s34, 0x258000
  s_mov_b32 s35, 0x20000
  s_and_b32 s29, s29, 0xffff
  s_mov_b32 s30, 0x280000
  s_mov_b32 s31, 0x20000
  s_mul_i32 s75, s76, 0x780
  s_add_u32 s75, s75, s81
  s_add_u32 s75, s75, 0x500
  s_add_u32 m0, s74, 0
  s_nop 0
  buffer_load_dwordx4 v10, s[32:35], s75 offen lds
  buffer_load_dwordx4 v11, s[32:35], s75 offen offset:1024 lds
  buffer_load_dwordx4 v12, s[32:35], s75 offen offset:2048 lds
  buffer_load_dwordx4 v13, s[32:35], s75 offen offset:3072 lds
  s_add_u32 m0, s74, 0x1000
  s_nop 0
  buffer_load_dwordx4 v14, s[32:35], s75 offen lds
  s_add_u32 m0, s82, 0
  s_nop 0
  buffer_load_dwordx4 v15, s[28:31], s76 offen lds
  buffer_load_dwordx4 v16, s[28:31], s76 offen offset:1024 lds
  s_add_u32 m0, s82, 0x800
  s_nop 0
  buffer_load_dwordx4 v17, s[28:31], s76 offen lds
  buffer_load_dwordx4 v18, s[28:31], s76 offen offset:1024 lds
  s_add_u32 m0, s82, 0x1000
  s_nop 0
  buffer_load_dwordx4 v19, s[28:31], s76 offen lds
  buffer_load_dwordx4 v20, s[28:31], s76 offen offset:1024 lds
  s_add_u32 m0, s82, 0x1800
  s_nop 0
  buffer_load_dwordx4 v21, s[28:31], s76 offen lds
  buffer_load_dwordx4 v22, s[28:31], s76 offen offset:1024 lds
  s_cmp_eq_u32 s25, 1
  s_cbranch_scc1 L_B
L_A:
  s_getpc_b64 s[100:101]
L_pcA:
  s_mov_b32 s27, L_B-L_pcA-196
  s_lshl_b32 s26, s3, 2
  s_add_u32 s26, s26, s22
  s_lshl_b32 s26, s26, 8
  s_min_u32 s26, s26, s27
  s_add_u32 s100, s100, s26
  s_addc_u32 s101, s101, 0
  s_load_dword s0, s[100:101], 0
  s_load_dword s0, s[100:101], 64
  s_load_dword s0, s[100:101], 128
  s_load_dword s0, s[100:101], 192
  v_bfe_u32 v4, v1, 2, 3
  v_lshrrev_b32 v5, 5, v1
  v_lshl_add_u32 v4, v4, 1, v5
  s_lshl_b32 s26, s23, 7
  s_sub_u32 s26, s26, 16
  v_add_u32 v4, s26, v4
  v_max_i32 v4, 0, v4
  v_mul_u32_u24 v4, 0x500, v4
  s_lshl_b32 s27, s22, 6
  v_add3_u32 v23, v4, v9, s27
  s_add_u32 m0, s82, 0x2000
  s_nop 0
  buffer_load_dwordx4 v23, s[28:31], s76 offen lds
  s_mov_b32 s40, s8
  s_and_b32 s41, s9, 0xffff
  s_mov_b32 s42, 0xc8000
  s_mov_b32 s43, 0x20000
  s_mov_b32 s36, s20
  s_and_b32 s37, s21, 0xffff
  s_mov_b32 s38, 0x800000
  s_mov_b32 s39, 0x20000
  s_mov_b32 s44, s18
  s_and_b32 s45, s19, 0xffff
  s_mov_b32 s46, 0x100
  s_mov_b32 s47, 0x20000
  s_mov_b32 s48, s16
  s_and_b32 s49, s17, 0xffff
  s_mov_b32 s50, 0x500000
  s_mov_b32 s51, 0x20000
  s_mul_i32 s75, s76, 0x780
  s_add_u32 s75, s75, s81
  s_add_u32 m0, s74, 0x5000
  s_nop 0
  buffer_load_dwordx4 v10, s[32:35], s75 offen lds
  buffer_load_dwordx4 v11, s[32:35], s75 offen offset:1024 lds
  buffer_load_dwordx4 v12, s[32:35], s75 offen offset:2048 lds
  buffer_load_dwordx4 v13, s[32:35], s75 offen offset:3072 lds
  s_add_u32 m0, s74, 0x6000
  s_nop 0
  buffer_load_dwordx4 v14, s[32:35], s75 offen lds
  v_lshrrev_b32 v4, 1, v3
  v_lshlrev_b32 v4, 4, v4
  v_and_b32 v5, 1, v3
  v_lshl_add_u32 v4, v5, 2, v4
  v_bfe_u32 v5, v1, 2, 2
  v_add_u32 v4, v5, v4
  v_mul_u32_u24 v4, 0xa0, v4
  v_and_b32 v5, 3, v1
  v_lshl_add_u32 v4, v5, 3, v4
  s_xor_b32 s27, s22, 0
  s_mul_i32 s27, s27, 0x1400
  v_add_u32 v9, s27, v4
  v_add_u32 v24, 0xf000, v9
  s_xor_b32 s27, s22, 1
  s_mul_i32 s27, s27, 0x1400
  v_add_u32 v25, s27, v4
  v_add_u32 v26, 0xf000, v25
  s_xor_b32 s27, s22, 2
  s_mul_i32 s27, s27, 0x1400
  v_add_u32 v27, s27, v4
  v_add_u32 v28, 0xf000, v27
  s_xor_b32 s27, s22, 3
  s_mul_i32 s27, s27, 0x1400
  v_add_u32 v29, s27, v4
  v_add_u32 v30, 0xf000, v29
  v_bfe_u32 v4, v1, 2, 1
  v_lshlrev_b32 v4, 1, v4
  v_xor_b32 v4, v4, v3
  v_lshlrev_b32 v4, 4, v4
  v_lshl_add_u32 v4, v2, 6, v4
  v_add_u32 v31, s82, v4
  v_bfe_u32 v4, v1, 2, 1
  v_lshlrev_b32 v4, 1, v4
  v_xor_b32 v4, v4, v3
  v_bfe_u32 v5, v1, 1, 1
  v_xor_b32 v5, s22, v5
  v_and_b32 v5, 1, v5
  v_lshl_add_u32 v4, v5, 2, v4
  v_lshlrev_b32 v4, 4, v4
  v_lshl_add_u32 v4, v2, 7, v4
  v_add_u32 v32, s82, v4
  v_xor_b32 v33, 64, v32
  v_lshlrev_b32 v7, 3, v1
  s_mov_b32 s52, 0xffff0000
  s_mov_b32 s53, 0xffffffff
  s_mov_b32 s54, 0
  s_mov_b32 s55, 0xffffffff
  s_mov_b32 s56, 0
  s_mov_b32 s57, 0xffff0000
  s_lshl_b32 s26, s23, 2
  s_add_u32 s26, s26, s22
  s_mul_i32 s26, s26, 0xa000
  s_lshr_b32 s27, s24, 1
  s_mul_i32 s27, s27, 0x1400
  s_add_u32 s26, s26, s27
  s_and_b32 s27, s24, 1
  s_lshl_b32 s100, s27, 11
  s_add_u32 s94, s26, s100
  s_add_u32 s95, s94, 0x5000
  s_lshl_b32 s100, s27, 9
  s_add_u32 s96, s26, s100
  s_add_u32 s96, s96, 0x1000
  s_add_u32 s97, s96, 0x5000
  s_lshl_b32 s26, s72, 2
  s_add_u32 s26, s26, s22
  s_mul_i32 s91, s26, 0xa000
  v_mov_b32 v62, 0x40000000
  s_cmp_eq_u32 s22, 0
  s_cselect_b32 s27, 0, 0x40000000
  s_lshl_b32 s26, s23, 2
  s_add_u32 s26, s26, s27
  v_writelane_b32 v62, s26, 0
  s_lshl_b32 s26, s72, 2
  v_mov_b32 v63, s26
  s_mul_i32 s26, s73, 0xa0
  s_mov_b32 s84, 0x460
  v_add_u32 v70, s26, v6
  v_mov_b32 v4, v8
  v_lshrrev_b32 v4, 16, v4
  v_mad_u32_u24 v65, v4, s84, v70
  v_add_u32 v4, 0x66680, v8
  v_lshrrev_b32 v4, 16, v4
  v_mad_u32_u24 v66, v4, s84, v70
  v_add_u32 v4, 0xccd00, v8
  v_lshrrev_b32 v4, 16, v4
  v_mad_u32_u24 v67, v4, s84, v70
  v_add_u32 v4, 0x133380, v8
  v_lshrrev_b32 v4, 16, v4
  v_mad_u32_u24 v68, v4, s84, v70
  v_add_u32 v4, 0x199a00, v8
  v_lshrrev_b32 v4, 16, v4
  v_mad_u32_u24 v69, v4, s84, v70
  v_add_u32 v69, 0x1000, v69
  v_add_u32 v4, 0x14000, v67
  v_cndmask_b32_e64 v70, v67, v4, s[54:55]
  s_mov_b32 s58, 0xff00ff00
  s_mov_b32 s59, 0xff00ff00
  s_mov_b32 s60, 0xff00ff
  s_mov_b32 s61, 0xff00ff
  s_mov_b32 s62, 0
  s_mov_b32 s63, 0xffffffff
  s_mov_b32 s98, 0x3ea52b5c
  v_mov_b32 v8, 0xf149f2ca
  s_lshr_b32 s99, s22, 1
  s_or_b32 s99, s99, s23
  s_mov_b32 s100, 0xf000000
  s_mov_b32 s101, 0xf000ff00
  v_cndmask_b32_e64 v80, v8, 0, s[100:101]
  s_mov_b32 s100, 0xf000ff
  s_mov_b32 s101, 0xf0000
  v_cndmask_b32_e64 v76, v8, 0, s[100:101]
  s_cmp_eq_u32 s99, 0
  s_cselect_b32 s100, 0xf000ff, s100
  s_cselect_b32 s101, 0, s101
  v_cndmask_b32_e64 v72, v8, 0, s[100:101]
  s_mov_b32 s100, 0x1f000100
  s_mov_b32 s101, 0xe000fe00
  v_cndmask_b32_e64 v81, v8, 0, s[100:101]
  s_mov_b32 s100, 0xe000fe
  s_mov_b32 s101, 0x1f0001
  v_cndmask_b32_e64 v77, v8, 0, s[100:101]
  s_cmp_eq_u32 s99, 0
  s_cselect_b32 s100, 0xe000fe, s100
  s_cselect_b32 s101, 0, s101
  v_cndmask_b32_e64 v73, v8, 0, s[100:101]
  s_mov_b32 s100, 0x3f000300
  s_mov_b32 s101, 0xc000fc00
  v_cndmask_b32_e64 v82, v8, 0, s[100:101]
  s_mov_b32 s100, 0xc000fc
  s_mov_b32 s101, 0x3f0003
  v_cndmask_b32_e64 v78, v8, 0, s[100:101]
  s_cmp_eq_u32 s99, 0
  s_cselect_b32 s100, 0xc000fc, s100
  s_cselect_b32 s101, 0, s101
  v_cndmask_b32_e64 v74, v8, 0, s[100:101]
  s_mov_b32 s100, 0x7f000700
  s_mov_b32 s101, 0x8000f800
  v_cndmask_b32_e64 v83, v8, 0, s[100:101]
  s_mov_b32 s100, 0x8000f8
  s_mov_b32 s101, 0x7f0007
  v_cndmask_b32_e64 v79, v8, 0, s[100:101]
  s_cmp_eq_u32 s99, 0
  s_cselect_b32 s100, 0x8000f8, s100
  s_cselect_b32 s101, 0, s101
  v_cndmask_b32_e64 v75, v8, 0, s[100:101]
  v_mov_b32 v84, 0x3f803f80
  v_mov_b32 v85, 0x3f803f80
  v_mov_b32 v86, 0x3f803f80
  v_mov_b32 v87, 0x3f803f80
  v_add_u32 v8, s82, v6
  s_add_u32 s26, s82, 0x1400
  v_add_u32 v71, s26, v7
  s_lshl_b32 s26, s22, 10
  s_add_u32 s26, s26, 0x1e000
  v_add_u32 v88, s26, v6
  v_lshrrev_b32 v4, 3, v2
  v_mul_u32_u24 v4, 0x2800, v4
  v_or_b32 v5, 8, v1
  v_lshl_add_u32 v4, v5, 3, v4
  v_add_u32 v89, 0x1fe00, v4
  v_lshrrev_b32 v4, 5, v1
  v_mul_u32_u24 v4, 0x2800, v4
  v_or_b32 v5, 32, v1
  v_lshl_add_u32 v4, v5, 3, v4
  v_add_u32 v90, 0x1fe00, v4
  s_lshl_b32 s26, s22, 9
  v_add_u32 v91, s26, v89
  v_add_u32 v92, s26, v90
  s_and_b32 s26, s22, 1
  s_mul_i32 s26, s26, 0x2800
  s_cmp_lt_u32 s22, 2
  s_cselect_b32 s27, 0x1fe00, 0
  s_cselect_b32 s100, 0, 0x1f400
  s_add_u32 s26, s26, s27
  s_add_u32 s26, s26, s100
  v_add_u32 v93, s26, v7
  v_add_u32 v94, 0x1f000, v6
  s_mul_i32 s75, s77, 0x780
  s_add_u32 s75, s75, s81
  s_add_u32 s75, s75, 0x500
  s_add_u32 m0, s74, 0xa000
  s_nop 0
  buffer_load_dwordx4 v10, s[32:35], s75 offen lds
  buffer_load_dwordx4 v11, s[32:35], s75 offen offset:1024 lds
  buffer_load_dwordx4 v12, s[32:35], s75 offen offset:2048 lds
  buffer_load_dwordx4 v13, s[32:35], s75 offen offset:3072 lds
  s_add_u32 m0, s74, 0xb000
  s_nop 0
  buffer_load_dwordx4 v14, s[32:35], s75 offen lds
  s_waitcnt vmcnt(19)
  s_barrier
  v_mov_b32 v96, -1
  v_mov_b32 v97, -1
  v_mov_b32 v98, -1
  v_mov_b32 v99, -1
  buffer_store_dwordx4 v[96:99], v6, s[36:39], s94 offen sc1
  buffer_store_dwordx4 v[96:99], v6, s[36:39], s94 offen offset:1024 sc1
  buffer_store_dwordx2 v[96:97], v7, s[36:39], s96 offen sc1
  buffer_store_dwordx4 v[96:99], v6, s[36:39], s95 offen sc1
  buffer_store_dwordx4 v[96:99], v6, s[36:39], s95 offen offset:1024 sc1
  buffer_store_dwordx2 v[96:97], v7, s[36:39], s97 offen sc1
  s_waitcnt vmcnt(23)
  ds_read_b128 a[0:3], v32
  ds_read_b128 a[4:7], v33
  s_waitcnt vmcnt(21)
  ds_read_b128 a[80:83], v32 offset:2048
  ds_read_b128 a[84:87], v33 offset:2048
  s_waitcnt vmcnt(16)
  ds_read_b128 a[160:163], v31 offset:8192
  ds_read_b64_tr_b16 v[34:35], v9
  ds_read_b64_tr_b16 v[36:37], v9 offset:1280
  ds_read_b64_tr_b16 v[38:39], v9 offset:32
  ds_read_b64_tr_b16 v[40:41], v9 offset:1312
  ds_read_b64_tr_b16 v[42:43], v9 offset:64
  ds_read_b64_tr_b16 v[44:45], v9 offset:1344
  ds_read_b64_tr_b16 v[46:47], v9 offset:96
  ds_read_b64_tr_b16 v[48:49], v9 offset:1376
  ds_read_b64_tr_b16 v[50:51], v9 offset:128
  ds_read_b64_tr_b16 v[52:53], v9 offset:1408
  ds_read_b64_tr_b16 v[54:55], v25
  ds_read_b64_tr_b16 v[56:57], v25 offset:1280
  s_waitcnt lgkmcnt(10)
  v_mfma_f32_16x16x32_bf16 v[100:103], v[34:37], a[0:3], 0
  ds_read_b64_tr_b16 v[58:59], v25 offset:32
  s_mul_i32 s75, s77, 0x780
  s_add_u32 s75, s75, s81
  v_mfma_f32_16x16x32_bf16 v[104:107], v[34:37], a[80:83], 0
  ds_read_b64_tr_b16 v[60:61], v25 offset:1312
  ds_read_b128 a[8:11], v32 offset:4096
  ds_read_b128 a[12:15], v33 offset:4096
  s_add_u32 m0, s74, 0xf000
  v_mfma_f32_16x16x32_bf16 a[180:183], v[34:37], a[160:163], 0
  s_waitcnt lgkmcnt(12)
  v_mfma_f32_16x16x32_bf16 v[108:111], v[38:41], a[0:3], 0
  ds_read_b64_tr_b16 v[34:35], v25 offset:64
  v_mfma_f32_16x16x32_bf16 v[112:115], v[38:41], a[80:83], 0
  ds_read_b64_tr_b16 v[36:37], v25 offset:1344
  ds_read_b128 a[88:91], v32 offset:6144
  ds_read_b128 a[92:95], v33 offset:6144
  v_mfma_f32_16x16x32_bf16 a[184:187], v[38:41], a[160:163], 0
  s_waitcnt lgkmcnt(14)
  s_add_u32 m0, s82, 0
  v_mfma_f32_16x16x32_bf16 v[116:119], v[42:45], a[0:3], 0
  ds_read_b64_tr_b16 v[38:39], v25 offset:96
  buffer_load_dwordx4 v15, s[28:31], s77 offen lds
  v_mfma_f32_16x16x32_bf16 v[120:123], v[42:45], a[80:83], 0
  ds_read_b64_tr_b16 v[40:41], v25 offset:1376
  v_mfma_f32_16x16x32_bf16 a[188:191], v[42:45], a[160:163], 0
  s_waitcnt lgkmcnt(14)
  v_mfma_f32_16x16x32_bf16 v[124:127], v[46:49], a[0:3], 0
  ds_read_b64_tr_b16 v[42:43], v25 offset:128
  v_mfma_f32_16x16x32_bf16 v[128:131], v[46:49], a[80:83], 0
  ds_read_b64_tr_b16 v[44:45], v25 offset:1408
  buffer_load_dwordx4 v16, s[28:31], s77 offen offset:1024 lds
  v_mfma_f32_16x16x32_bf16 a[192:195], v[46:49], a[160:163], 0
  s_waitcnt lgkmcnt(14)
  s_add_u32 m0, s82, 0x800
  v_mfma_f32_16x16x32_bf16 v[132:135], v[50:53], a[0:3], 0
  ds_read_b64_tr_b16 v[46:47], v27
  v_mfma_f32_16x16x32_bf16 v[136:139], v[50:53], a[80:83], 0
  ds_read_b64_tr_b16 v[48:49], v27 offset:1280
  v_mfma_f32_16x16x32_bf16 a[196:199], v[50:53], a[160:163], 0
  s_waitcnt lgkmcnt(14)
  buffer_load_dwordx4 v17, s[28:31], s77 offen lds
  v_mfma_f32_16x16x32_bf16 v[100:103], v[54:57], a[4:7], v[100:103]
  ds_read_b64_tr_b16 v[50:51], v27 offset:32
  v_mfma_f32_16x16x32_bf16 v[104:107], v[54:57], a[84:87], v[104:107]
  s_waitcnt lgkmcnt(13)
  ds_read_b64_tr_b16 v[52:53], v27 offset:1312
  v_mfma_f32_16x16x32_bf16 v[108:111], v[58:61], a[4:7], v[108:111]
  ds_read_b64_tr_b16 v[54:55], v27 offset:64
  v_mfma_f32_16x16x32_bf16 v[112:115], v[58:61], a[84:87], v[112:115]
  s_waitcnt lgkmcnt(11)
  ds_read_b64_tr_b16 v[56:57], v27 offset:1344
  buffer_load_dwordx4 v18, s[28:31], s77 offen offset:1024 lds
  v_mfma_f32_16x16x32_bf16 v[116:119], v[34:37], a[4:7], v[116:119]
  ds_read_b64_tr_b16 v[58:59], v27 offset:96
  s_add_u32 m0, s82, 0x1000
  v_mfma_f32_16x16x32_bf16 v[120:123], v[34:37], a[84:87], v[120:123]
  s_waitcnt lgkmcnt(9)
  ds_read_b64_tr_b16 v[60:61], v27 offset:1376
  v_mfma_f32_16x16x32_bf16 v[124:127], v[38:41], a[4:7], v[124:127]
  ds_read_b64_tr_b16 v[34:35], v27 offset:128
  v_mfma_f32_16x16x32_bf16 v[128:131], v[38:41], a[84:87], v[128:131]
  s_waitcnt lgkmcnt(9)
  ds_read_b64_tr_b16 v[36:37], v27 offset:1408
  buffer_load_dwordx4 v23, s[28:31], s77 offen lds
  v_mfma_f32_16x16x32_bf16 v[132:135], v[42:45], a[4:7], v[132:135]
  ds_read_b64_tr_b16 v[38:39], v29
  s_add_u32 m0, s82, 0x1800
  v_mfma_f32_16x16x32_bf16 v[136:139], v[42:45], a[84:87], v[136:139]
  s_waitcnt lgkmcnt(9)
  ds_read_b64_tr_b16 v[40:41], v29 offset:1280
  v_mfma_f32_16x16x32_bf16 v[100:103], v[46:49], a[8:11], v[100:103]
  ds_read_b64_tr_b16 v[42:43], v29 offset:32
  v_mfma_f32_16x16x32_bf16 v[104:107], v[46:49], a[88:91], v[104:107]
  s_waitcnt lgkmcnt(9)
  ds_read_b64_tr_b16 v[44:45], v29 offset:1312
  buffer_load_dwordx4 v19, s[28:31], s77 offen lds
  v_mfma_f32_16x16x32_bf16 v[108:111], v[50:53], a[8:11], v[108:111]
  ds_read_b64_tr_b16 v[46:47], v29 offset:64
  v_mfma_f32_16x16x32_bf16 v[112:115], v[50:53], a[88:91], v[112:115]
  s_waitcnt lgkmcnt(9)
  ds_read_b64_tr_b16 v[48:49], v29 offset:1344
  v_mfma_f32_16x16x32_bf16 v[116:119], v[54:57], a[8:11], v[116:119]
  ds_read_b64_tr_b16 v[50:51], v29 offset:96
  v_mfma_f32_16x16x32_bf16 v[120:123], v[54:57], a[88:91], v[120:123]
  s_waitcnt lgkmcnt(9)
  ds_read_b64_tr_b16 v[52:53], v29 offset:1376
  buffer_load_dwordx4 v20, s[28:31], s77 offen offset:1024 lds
  v_mfma_f32_16x16x32_bf16 v[124:127], v[58:61], a[8:11], v[124:127]
  ds_read_b64_tr_b16 v[54:55], v29 offset:128
  s_add_u32 m0, s82, 0x2000
  v_mfma_f32_16x16x32_bf16 v[128:131], v[58:61], a[88:91], v[128:131]
  s_waitcnt lgkmcnt(9)
  ds_read_b64_tr_b16 v[56:57], v29 offset:1408
  v_mfma_f32_16x16x32_bf16 v[132:135], v[34:37], a[8:11], v[132:135]
  s_waitcnt vmcnt(18)
  s_barrier
  ds_read_b64_tr_b16 v[58:59], v9 offset:20480
  v_mfma_f32_16x16x32_bf16 v[136:139], v[34:37], a[88:91], v[136:139]
  s_waitcnt lgkmcnt(9)
  ds_read_b64_tr_b16 v[60:61], v9 offset:21760
  buffer_load_dwordx4 v21, s[28:31], s77 offen lds
  v_mfma_f32_16x16x32_bf16 v[100:103], v[38:41], a[12:15], v[100:103]
  ds_read_b64_tr_b16 v[34:35], v9 offset:20512
  v_mfma_f32_16x16x32_bf16 v[104:107], v[38:41], a[92:95], v[104:107]
  s_waitcnt lgkmcnt(9)
  ds_read_b64_tr_b16 v[36:37], v9 offset:21792
  v_mfma_f32_16x16x32_bf16 v[108:111], v[42:45], a[12:15], v[108:111]
  ds_read_b64_tr_b16 v[38:39], v9 offset:20544
  v_mfma_f32_16x16x32_bf16 v[112:115], v[42:45], a[92:95], v[112:115]
  s_waitcnt lgkmcnt(9)
  ds_read_b64_tr_b16 v[40:41], v9 offset:21824
  buffer_load_dwordx4 v22, s[28:31], s77 offen offset:1024 lds
  v_mfma_f32_16x16x32_bf16 v[116:119], v[46:49], a[12:15], v[116:119]
  ds_read_b64_tr_b16 v[42:43], v9 offset:20576
  s_add_u32 m0, s74, 0xf000
  v_mfma_f32_16x16x32_bf16 v[120:123], v[46:49], a[92:95], v[120:123]
  s_waitcnt lgkmcnt(9)
  ds_read_b64_tr_b16 v[44:45], v9 offset:21856
  v_mfma_f32_16x16x32_bf16 v[124:127], v[50:53], a[12:15], v[124:127]
  ds_read_b64_tr_b16 v[46:47], v9 offset:20608
  v_mfma_f32_16x16x32_bf16 v[128:131], v[50:53], a[92:95], v[128:131]
  s_waitcnt lgkmcnt(9)
  ds_read_b64_tr_b16 v[48:49], v9 offset:21888
  buffer_load_dwordx4 v10, s[32:35], s75 offen lds
  v_mfma_f32_16x16x32_bf16 v[132:135], v[54:57], a[12:15], v[132:135]
  ds_read_b64_tr_b16 v[50:51], v25 offset:20480
  v_mfma_f32_16x16x32_bf16 v[136:139], v[54:57], a[92:95], v[136:139]
  s_waitcnt lgkmcnt(9)
  ds_read_b64_tr_b16 v[52:53], v25 offset:21760
  v_mfma_f32_16x16x32_bf16 v[140:143], v[58:61], a[0:3], 0
  ds_read_b64_tr_b16 v[54:55], v25 offset:20512
  v_mfma_f32_16x16x32_bf16 v[144:147], v[58:61], a[80:83], 0
  s_waitcnt lgkmcnt(9)
  ds_read_b64_tr_b16 v[56:57], v25 offset:21792
  v_mfma_f32_16x16x32_bf16 v[148:151], v[34:37], a[0:3], 0
  ds_read_b64_tr_b16 v[58:59], v25 offset:20544
  v_mfma_f32_16x16x32_bf16 v[152:155], v[34:37], a[80:83], 0
  s_waitcnt lgkmcnt(9)
  ds_read_b64_tr_b16 v[60:61], v25 offset:21824
  buffer_load_dwordx4 v11, s[32:35], s75 offen offset:1024 lds
  v_mfma_f32_16x16x32_bf16 v[156:159], v[38:41], a[0:3], 0
  ds_read_b64_tr_b16 v[34:35], v25 offset:20576
  v_mfma_f32_16x16x32_bf16 v[160:163], v[38:41], a[80:83], 0
  s_waitcnt lgkmcnt(9)
  ds_read_b64_tr_b16 v[36:37], v25 offset:21856
  v_mfma_f32_16x16x32_bf16 v[164:167], v[42:45], a[0:3], 0
  ds_read_b64_tr_b16 v[38:39], v25 offset:20608
  v_mfma_f32_16x16x32_bf16 v[168:171], v[42:45], a[80:83], 0
  s_waitcnt lgkmcnt(9)
  ds_read_b64_tr_b16 v[40:41], v25 offset:21888
  v_mfma_f32_16x16x32_bf16 v[172:175], v[46:49], a[0:3], 0
  ds_read_b64_tr_b16 v[42:43], v27 offset:20480
  v_mfma_f32_16x16x32_bf16 v[176:179], v[46:49], a[80:83], 0
  s_waitcnt lgkmcnt(9)
  ds_read_b64_tr_b16 v[44:45], v27 offset:21760
  buffer_load_dwordx4 v12, s[32:35], s75 offen offset:2048 lds
  v_mfma_f32_16x16x32_bf16 v[140:143], v[50:53], a[4:7], v[140:143]
  ds_read_b64_tr_b16 v[46:47], v27 offset:20512
  v_mfma_f32_16x16x32_bf16 v[144:147], v[50:53], a[84:87], v[144:147]
  s_waitcnt lgkmcnt(9)
  ds_read_b64_tr_b16 v[48:49], v27 offset:21792
  v_mfma_f32_16x16x32_bf16 v[148:151], v[54:57], a[4:7], v[148:151]
  ds_read_b64_tr_b16 v[50:51], v27 offset:20544
  v_mfma_f32_16x16x32_bf16 v[152:155], v[54:57], a[84:87], v[152:155]
  s_waitcnt lgkmcnt(9)
  ds_read_b64_tr_b16 v[52:53], v27 offset:21824
  v_mfma_f32_16x16x32_bf16 v[156:159], v[58:61], a[4:7], v[156:159]
  ds_read_b64_tr_b16 v[54:55], v27 offset:20576
  v_mfma_f32_16x16x32_bf16 v[160:163], v[58:61], a[84:87], v[160:163]
  s_waitcnt lgkmcnt(9)
  ds_read_b64_tr_b16 v[56:57], v27 offset:21856
  buffer_load_dwordx4 v13, s[32:35], s75 offen offset:3072 lds
  v_mfma_f32_16x16x32_bf16 v[164:167], v[34:37], a[4:7], v[164:167]
  ds_read_b64_tr_b16 v[58:59], v27 offset:20608
  s_add_u32 m0, s74, 0x10000
  v_mfma_f32_16x16x32_bf16 v[168:171], v[34:37], a[84:87], v[168:171]
  s_waitcnt lgkmcnt(9)
  ds_read_b64_tr_b16 v[60:61], v27 offset:21888
  v_mfma_f32_16x16x32_bf16 v[172:175], v[38:41], a[4:7], v[172:175]
  ds_read_b64_tr_b16 v[34:35], v29 offset:20480
  v_mfma_f32_16x16x32_bf16 v[176:179], v[38:41], a[84:87], v[176:179]
  s_waitcnt lgkmcnt(9)
  ds_read_b64_tr_b16 v[36:37], v29 offset:21760
  v_mfma_f32_16x16x32_bf16 v[140:143], v[42:45], a[8:11], v[140:143]
  ds_read_b64_tr_b16 v[38:39], v29 offset:20512
  v_mfma_f32_16x16x32_bf16 v[144:147], v[42:45], a[88:91], v[144:147]
  s_waitcnt lgkmcnt(9)
  ds_read_b64_tr_b16 v[40:41], v29 offset:21792
  buffer_load_dwordx4 v14, s[32:35], s75 offen lds
  v_mfma_f32_16x16x32_bf16 v[148:151], v[46:49], a[8:11], v[148:151]
  ds_read_b64_tr_b16 v[42:43], v29 offset:20544
  s_mul_i32 s75, s78, 0x780
  s_add_u32 s75, s75, s81
  v_mfma_f32_16x16x32_bf16 v[152:155], v[46:49], a[88:91], v[152:155]
  s_waitcnt lgkmcnt(9)
  ds_read_b64_tr_b16 v[44:45], v29 offset:21824
  s_add_u32 s75, s75, 0x500
  s_add_u32 m0, s74, 0x14000
  v_mfma_f32_16x16x32_bf16 v[156:159], v[50:53], a[8:11], v[156:159]
  ds_read_b64_tr_b16 v[46:47], v29 offset:20576
  v_mfma_f32_16x16x32_bf16 v[160:163], v[50:53], a[88:91], v[160:163]
  s_waitcnt lgkmcnt(9)
  ds_read_b64_tr_b16 v[48:49], v29 offset:21856
  v_mfma_f32_16x16x32_bf16 v[164:167], v[54:57], a[8:11], v[164:167]
  ds_read_b64_tr_b16 v[50:51], v29 offset:20608
  v_mfma_f32_16x16x32_bf16 v[168:171], v[54:57], a[88:91], v[168:171]
  s_waitcnt lgkmcnt(9)
  ds_read_b64_tr_b16 v[52:53], v29 offset:21888
  buffer_load_dwordx4 v10, s[32:35], s75 offen lds
  v_mfma_f32_16x16x32_bf16 v[172:175], v[58:61], a[8:11], v[172:175]
  s_waitcnt vmcnt(21)
  s_barrier
  s_waitcnt vmcnt(13)
  ds_read_b128 a[16:19], v32
  ds_read_b128 a[20:23], v33
  s_waitcnt vmcnt(11)
  ds_read_b128 a[96:99], v32 offset:2048
  ds_read_b128 a[100:103], v33 offset:2048
  s_waitcnt vmcnt(10)
  ds_read_b128 a[164:167], v31 offset:4096
  ds_read_b64_tr_b16 v[54:55], v9 offset:40960
  v_mfma_f32_16x16x32_bf16 v[176:179], v[58:61], a[88:91], v[176:179]
  s_waitcnt lgkmcnt(14)
  ds_read_b64_tr_b16 v[56:57], v9 offset:42240
  v_mfma_f32_16x16x32_bf16 v[140:143], v[34:37], a[12:15], v[140:143]
  ds_read_b64_tr_b16 v[58:59], v9 offset:40992
  v_mfma_f32_16x16x32_bf16 v[144:147], v[34:37], a[92:95], v[144:147]
  s_waitcnt lgkmcnt(14)
  ds_read_b64_tr_b16 v[60:61], v9 offset:42272
  v_mfma_f32_16x16x32_bf16 v[148:151], v[38:41], a[12:15], v[148:151]
  ds_read_b64_tr_b16 v[34:35], v9 offset:41024
  v_mfma_f32_16x16x32_bf16 v[152:155], v[38:41], a[92:95], v[152:155]
  s_waitcnt lgkmcnt(14)
  ds_read_b64_tr_b16 v[36:37], v9 offset:42304
  buffer_load_dwordx4 v11, s[32:35], s75 offen offset:1024 lds
  v_mfma_f32_16x16x32_bf16 v[156:159], v[42:45], a[12:15], v[156:159]
  ds_read_b64_tr_b16 v[38:39], v9 offset:41056
  v_mfma_f32_16x16x32_bf16 v[160:163], v[42:45], a[92:95], v[160:163]
  s_waitcnt lgkmcnt(14)
  ds_read_b64_tr_b16 v[40:41], v9 offset:42336
  v_mfma_f32_16x16x32_bf16 v[164:167], v[46:49], a[12:15], v[164:167]
  ds_read_b64_tr_b16 v[42:43], v9 offset:41088
  v_mfma_f32_16x16x32_bf16 v[168:171], v[46:49], a[92:95], v[168:171]
  s_waitcnt lgkmcnt(14)
  ds_read_b64_tr_b16 v[44:45], v9 offset:42368
  v_mfma_f32_16x16x32_bf16 v[172:175], v[50:53], a[12:15], v[172:175]
  ds_read_b64_tr_b16 v[46:47], v25 offset:40960
  v_mfma_f32_16x16x32_bf16 v[176:179], v[50:53], a[92:95], v[176:179]
  s_waitcnt lgkmcnt(9)
  ds_read_b64_tr_b16 v[48:49], v25 offset:42240
  buffer_load_dwordx4 v12, s[32:35], s75 offen offset:2048 lds
  v_mfma_f32_16x16x32_bf16 v[100:103], v[54:57], a[16:19], v[100:103]
  ds_read_b64_tr_b16 v[50:51], v25 offset:40992
  v_mfma_f32_16x16x32_bf16 v[104:107], v[54:57], a[96:99], v[104:107]
  ds_read_b64_tr_b16 v[52:53], v25 offset:42272
  v_mfma_f32_16x16x32_bf16 a[180:183], v[54:57], a[164:167], a[180:183]
  s_waitcnt lgkmcnt(10)
  v_mfma_f32_16x16x32_bf16 v[108:111], v[58:61], a[16:19], v[108:111]
  ds_read_b64_tr_b16 v[54:55], v25 offset:41024
  v_mfma_f32_16x16x32_bf16 v[112:115], v[58:61], a[96:99], v[112:115]
  ds_read_b64_tr_b16 v[56:57], v25 offset:42304
  v_mfma_f32_16x16x32_bf16 a[184:187], v[58:61], a[164:167], a[184:187]
  s_waitcnt lgkmcnt(10)
  buffer_load_dwordx4 v13, s[32:35], s75 offen offset:3072 lds
  v_mfma_f32_16x16x32_bf16 v[116:119], v[34:37], a[16:19], v[116:119]
  ds_read_b64_tr_b16 v[58:59], v25 offset:41056
  s_add_u32 m0, s74, 0x15000
  v_mfma_f32_16x16x32_bf16 v[120:123], v[34:37], a[96:99], v[120:123]
  ds_read_b64_tr_b16 v[60:61], v25 offset:42336
  v_mfma_f32_16x16x32_bf16 a[188:191], v[34:37], a[164:167], a[188:191]
  s_waitcnt lgkmcnt(10)
  v_mfma_f32_16x16x32_bf16 v[124:127], v[38:41], a[16:19], v[124:127]
  ds_read_b64_tr_b16 v[34:35], v25 offset:41088
  v_mfma_f32_16x16x32_bf16 v[128:131], v[38:41], a[96:99], v[128:131]
  ds_read_b64_tr_b16 v[36:37], v25 offset:42368
  v_mfma_f32_16x16x32_bf16 a[192:195], v[38:41], a[164:167], a[192:195]
  s_waitcnt lgkmcnt(10)
  buffer_load_dwordx4 v14, s[32:35], s75 offen lds
  v_mfma_f32_16x16x32_bf16 v[132:135], v[42:45], a[16:19], v[132:135]
  s_waitcnt vmcnt(12)
  ds_read_b128 a[24:27], v32 offset:6144
  ds_read_b128 a[28:31], v33 offset:6144
  s_waitcnt vmcnt(10)
  ds_read_b128 a[104:107], v32 offset:8192
  ds_read_b128 a[108:111], v33 offset:8192
  ds_read_b64_tr_b16 v[38:39], v27 offset:40960
  s_add_u32 m0, s82, 0
  v_mfma_f32_16x16x32_bf16 v[136:139], v[42:45], a[96:99], v[136:139]
  ds_read_b64_tr_b16 v[40:41], v27 offset:42240
  v_mfma_f32_16x16x32_bf16 a[196:199], v[42:45], a[164:167], a[196:199]
  s_waitcnt lgkmcnt(14)
  v_mfma_f32_16x16x32_bf16 v[100:103], v[46:49], a[20:23], v[100:103]
  ds_read_b64_tr_b16 v[42:43], v27 offset:40992
  v_mfma_f32_16x16x32_bf16 v[104:107], v[46:49], a[100:103], v[104:107]
  s_waitcnt lgkmcnt(13)
  ds_read_b64_tr_b16 v[44:45], v27 offset:42272
  v_mfma_f32_16x16x32_bf16 v[108:111], v[50:53], a[20:23], v[108:111]
  ds_read_b64_tr_b16 v[46:47], v27 offset:41024
  buffer_load_dwordx4 v15, s[28:31], s78 offen lds
  v_mfma_f32_16x16x32_bf16 v[112:115], v[50:53], a[100:103], v[112:115]
  s_waitcnt lgkmcnt(13)
  ds_read_b64_tr_b16 v[48:49], v27 offset:42304
  v_mfma_f32_16x16x32_bf16 v[116:119], v[54:57], a[20:23], v[116:119]
  ds_read_b64_tr_b16 v[50:51], v27 offset:41056
  v_mfma_f32_16x16x32_bf16 v[120:123], v[54:57], a[100:103], v[120:123]
  s_waitcnt lgkmcnt(13)
  ds_read_b64_tr_b16 v[52:53], v27 offset:42336
  v_mfma_f32_16x16x32_bf16 v[124:127], v[58:61], a[20:23], v[124:127]
  ds_read_b64_tr_b16 v[54:55], v27 offset:41088
  buffer_load_dwordx4 v16, s[28:31], s78 offen offset:1024 lds
  v_mfma_f32_16x16x32_bf16 v[128:131], v[58:61], a[100:103], v[128:131]
  s_waitcnt lgkmcnt(13)
  ds_read_b64_tr_b16 v[56:57], v27 offset:42368
  s_add_u32 m0, s82, 0x800
  v_mfma_f32_16x16x32_bf16 v[132:135], v[34:37], a[20:23], v[132:135]
  ds_read_b64_tr_b16 v[58:59], v29 offset:40960
  v_mfma_f32_16x16x32_bf16 v[136:139], v[34:37], a[100:103], v[136:139]
  s_waitcnt lgkmcnt(9)
  ds_read_b64_tr_b16 v[60:61], v29 offset:42240
  v_mfma_f32_16x16x32_bf16 v[100:103], v[38:41], a[24:27], v[100:103]
  ds_read_b64_tr_b16 v[34:35], v29 offset:40992
  buffer_load_dwordx4 v17, s[28:31], s78 offen lds
  v_mfma_f32_16x16x32_bf16 v[104:107], v[38:41], a[104:107], v[104:107]
  s_waitcnt lgkmcnt(9)
  ds_read_b64_tr_b16 v[36:37], v29 offset:42272
  v_mfma_f32_16x16x32_bf16 v[108:111], v[42:45], a[24:27], v[108:111]
  ds_read_b64_tr_b16 v[38:39], v29 offset:41024
  v_mfma_f32_16x16x32_bf16 v[112:115], v[42:45], a[104:107], v[112:115]
  s_waitcnt lgkmcnt(9)
  ds_read_b64_tr_b16 v[40:41], v29 offset:42304
  v_mfma_f32_16x16x32_bf16 v[116:119], v[46:49], a[24:27], v[116:119]
  ds_read_b64_tr_b16 v[42:43], v29 offset:41056
  buffer_load_dwordx4 v18, s[28:31], s78 offen offset:1024 lds
  v_mfma_f32_16x16x32_bf16 v[120:123], v[46:49], a[104:107], v[120:123]
  s_waitcnt lgkmcnt(9)
  ds_read_b64_tr_b16 v[44:45], v29 offset:42336
  s_add_u32 m0, s82, 0x1000
  v_mfma_f32_16x16x32_bf16 v[124:127], v[50:53], a[24:27], v[124:127]
  ds_read_b64_tr_b16 v[46:47], v29 offset:41088
  v_mfma_f32_16x16x32_bf16 v[128:131], v[50:53], a[104:107], v[128:131]
  s_waitcnt lgkmcnt(9)
  ds_read_b64_tr_b16 v[48:49], v29 offset:42368
  v_mfma_f32_16x16x32_bf16 v[132:135], v[54:57], a[24:27], v[132:135]
  s_waitcnt vmcnt(9)
  s_barrier
  ds_read_b64_tr_b16 v[50:51], v24
  buffer_load_dwordx4 v23, s[28:31], s78 offen lds
  v_mfma_f32_16x16x32_bf16 v[136:139], v[54:57], a[104:107], v[136:139]
  s_waitcnt lgkmcnt(9)
  ds_read_b64_tr_b16 v[52:53], v24 offset:1280
  s_add_u32 m0, s82, 0x1800
  v_mfma_f32_16x16x32_bf16 v[100:103], v[58:61], a[28:31], v[100:103]
  ds_read_b64_tr_b16 v[54:55], v24 offset:32
  v_mfma_f32_16x16x32_bf16 v[104:107], v[58:61], a[108:111], v[104:107]
  s_waitcnt lgkmcnt(9)
  ds_read_b64_tr_b16 v[56:57], v24 offset:1312
  v_mfma_f32_16x16x32_bf16 v[108:111], v[34:37], a[28:31], v[108:111]
  ds_read_b64_tr_b16 v[58:59], v24 offset:64
  buffer_load_dwordx4 v19, s[28:31], s78 offen lds
  v_mfma_f32_16x16x32_bf16 v[112:115], v[34:37], a[108:111], v[112:115]
  s_waitcnt lgkmcnt(9)
  ds_read_b64_tr_b16 v[60:61], v24 offset:1344
  v_mfma_f32_16x16x32_bf16 v[116:119], v[38:41], a[28:31], v[116:119]
  ds_read_b64_tr_b16 v[34:35], v24 offset:96
  v_mfma_f32_16x16x32_bf16 v[120:123], v[38:41], a[108:111], v[120:123]
  s_waitcnt lgkmcnt(9)
  ds_read_b64_tr_b16 v[36:37], v24 offset:1376
  v_mfma_f32_16x16x32_bf16 v[124:127], v[42:45], a[28:31], v[124:127]
  ds_read_b64_tr_b16 v[38:39], v24 offset:128
  buffer_load_dwordx4 v20, s[28:31], s78 offen offset:1024 lds
  v_mfma_f32_16x16x32_bf16 v[128:131], v[42:45], a[108:111], v[128:131]
  s_waitcnt lgkmcnt(9)
  ds_read_b64_tr_b16 v[40:41], v24 offset:1408
  s_add_u32 m0, s82, 0x2000
  v_mfma_f32_16x16x32_bf16 v[132:135], v[46:49], a[28:31], v[132:135]
  ds_read_b64_tr_b16 v[42:43], v26
  v_mfma_f32_16x16x32_bf16 v[136:139], v[46:49], a[108:111], v[136:139]
  s_waitcnt lgkmcnt(9)
  ds_read_b64_tr_b16 v[44:45], v26 offset:1280
  v_mfma_f32_16x16x32_bf16 v[140:143], v[50:53], a[16:19], v[140:143]
  ds_read_b64_tr_b16 v[46:47], v26 offset:32
  buffer_load_dwordx4 v21, s[28:31], s78 offen lds
  v_mfma_f32_16x16x32_bf16 v[144:147], v[50:53], a[96:99], v[144:147]
  s_waitcnt lgkmcnt(9)
  ds_read_b64_tr_b16 v[48:49], v26 offset:1312
  v_mfma_f32_16x16x32_bf16 v[148:151], v[54:57], a[16:19], v[148:151]
  ds_read_b64_tr_b16 v[50:51], v26 offset:64
  v_mfma_f32_16x16x32_bf16 v[152:155], v[54:57], a[96:99], v[152:155]
  s_waitcnt lgkmcnt(9)
  ds_read_b64_tr_b16 v[52:53], v26 offset:1344
  v_mfma_f32_16x16x32_bf16 v[156:159], v[58:61], a[16:19], v[156:159]
  ds_read_b64_tr_b16 v[54:55], v26 offset:96
  buffer_load_dwordx4 v22, s[28:31], s78 offen offset:1024 lds
  v_mfma_f32_16x16x32_bf16 v[160:163], v[58:61], a[96:99], v[160:163]
  s_waitcnt lgkmcnt(9)
  ds_read_b64_tr_b16 v[56:57], v26 offset:1376
  s_mul_i32 s75, s78, 0x780
  s_add_u32 s75, s75, s81
  v_mfma_f32_16x16x32_bf16 v[164:167], v[34:37], a[16:19], v[164:167]
  ds_read_b64_tr_b16 v[58:59], v26 offset:128
  s_add_u32 m0, s74, 0x19000
  v_mfma_f32_16x16x32_bf16 v[168:171], v[34:37], a[96:99], v[168:171]
  s_waitcnt lgkmcnt(9)
  ds_read_b64_tr_b16 v[60:61], v26 offset:1408
  v_mfma_f32_16x16x32_bf16 v[172:175], v[38:41], a[16:19], v[172:175]
  ds_read_b64_tr_b16 v[34:35], v28
  buffer_load_dwordx4 v10, s[32:35], s75 offen lds
  v_mfma_f32_16x16x32_bf16 v[176:179], v[38:41], a[96:99], v[176:179]
  s_waitcnt lgkmcnt(9)
  ds_read_b64_tr_b16 v[36:37], v28 offset:1280
  v_mfma_f32_16x16x32_bf16 v[140:143], v[42:45], a[20:23], v[140:143]
  ds_read_b64_tr_b16 v[38:39], v28 offset:32
  v_mfma_f32_16x16x32_bf16 v[144:147], v[42:45], a[100:103], v[144:147]
  s_waitcnt lgkmcnt(9)
  ds_read_b64_tr_b16 v[40:41], v28 offset:1312
  v_mfma_f32_16x16x32_bf16 v[148:151], v[46:49], a[20:23], v[148:151]
  ds_read_b64_tr_b16 v[42:43], v28 offset:64
  v_mfma_f32_16x16x32_bf16 v[152:155], v[46:49], a[100:103], v[152:155]
  s_waitcnt lgkmcnt(9)
  ds_read_b64_tr_b16 v[44:45], v28 offset:1344
  v_mfma_f32_16x16x32_bf16 v[156:159], v[50:53], a[20:23], v[156:159]
  ds_read_b64_tr_b16 v[46:47], v28 offset:96
  buffer_load_dwordx4 v11, s[32:35], s75 offen offset:1024 lds
  v_mfma_f32_16x16x32_bf16 v[160:163], v[50:53], a[100:103], v[160:163]
  s_waitcnt lgkmcnt(9)
  ds_read_b64_tr_b16 v[48:49], v28 offset:1376
  v_mfma_f32_16x16x32_bf16 v[164:167], v[54:57], a[20:23], v[164:167]
  ds_read_b64_tr_b16 v[50:51], v28 offset:128
  v_mfma_f32_16x16x32_bf16 v[168:171], v[54:57], a[100:103], v[168:171]
  s_waitcnt lgkmcnt(9)
  ds_read_b64_tr_b16 v[52:53], v28 offset:1408
  v_mfma_f32_16x16x32_bf16 v[172:175], v[58:61], a[20:23], v[172:175]
  ds_read_b64_tr_b16 v[54:55], v30
  v_mfma_f32_16x16x32_bf16 v[176:179], v[58:61], a[100:103], v[176:179]
  s_waitcnt lgkmcnt(9)
  ds_read_b64_tr_b16 v[56:57], v30 offset:1280
  v_mfma_f32_16x16x32_bf16 v[140:143], v[34:37], a[24:27], v[140:143]
  ds_read_b64_tr_b16 v[58:59], v30 offset:32
  buffer_load_dwordx4 v12, s[32:35], s75 offen offset:2048 lds
  v_mfma_f32_16x16x32_bf16 v[144:147], v[34:37], a[104:107], v[144:147]
  s_waitcnt lgkmcnt(9)
  ds_read_b64_tr_b16 v[60:61], v30 offset:1312
  v_mfma_f32_16x16x32_bf16 v[148:151], v[38:41], a[24:27], v[148:151]
  ds_read_b64_tr_b16 v[34:35], v30 offset:64
  v_mfma_f32_16x16x32_bf16 v[152:155], v[38:41], a[104:107], v[152:155]
  s_waitcnt lgkmcnt(9)
  ds_read_b64_tr_b16 v[36:37], v30 offset:1344
  v_mfma_f32_16x16x32_bf16 v[156:159], v[42:45], a[24:27], v[156:159]
  ds_read_b64_tr_b16 v[38:39], v30 offset:96
  v_mfma_f32_16x16x32_bf16 v[160:163], v[42:45], a[104:107], v[160:163]
  s_waitcnt lgkmcnt(9)
  ds_read_b64_tr_b16 v[40:41], v30 offset:1376
  v_mfma_f32_16x16x32_bf16 v[164:167], v[46:49], a[24:27], v[164:167]
  ds_read_b64_tr_b16 v[42:43], v30 offset:128
  buffer_load_dwordx4 v13, s[32:35], s75 offen offset:3072 lds
  v_mfma_f32_16x16x32_bf16 v[168:171], v[46:49], a[104:107], v[168:171]
  s_waitcnt lgkmcnt(9)
  ds_read_b64_tr_b16 v[44:45], v30 offset:1408
  s_add_u32 m0, s74, 0x1a000
  v_mfma_f32_16x16x32_bf16 v[172:175], v[50:53], a[24:27], v[172:175]
  s_waitcnt vmcnt(13)
  s_barrier
  v_mov_b32 v96, 1
  s_waitcnt vmcnt(11)
  ds_read_b128 a[32:35], v32
  ds_read_b128 a[36:39], v33
  s_waitcnt vmcnt(9)
  ds_read_b128 a[112:115], v32 offset:2048
  ds_read_b128 a[116:119], v33 offset:2048
  s_waitcnt vmcnt(8)
  ds_read_b128 a[168:171], v31 offset:4096
  ds_read_b64_tr_b16 v[46:47], v24 offset:20480
  v_mfma_f32_16x16x32_bf16 v[176:179], v[50:53], a[104:107], v[176:179]
  s_waitcnt lgkmcnt(14)
  ds_read_b64_tr_b16 v[48:49], v24 offset:21760
  v_mfma_f32_16x16x32_bf16 v[140:143], v[54:57], a[28:31], v[140:143]
  ds_read_b64_tr_b16 v[50:51], v24 offset:20512
  v_mfma_f32_16x16x32_bf16 v[144:147], v[54:57], a[108:111], v[144:147]
  s_waitcnt lgkmcnt(14)
  ds_read_b64_tr_b16 v[52:53], v24 offset:21792
  v_mfma_f32_16x16x32_bf16 v[148:151], v[58:61], a[28:31], v[148:151]
  ds_read_b64_tr_b16 v[54:55], v24 offset:20544
  buffer_load_dwordx4 v14, s[32:35], s75 offen lds
  v_mfma_f32_16x16x32_bf16 v[152:155], v[58:61], a[108:111], v[152:155]
  s_waitcnt lgkmcnt(14)
  ds_read_b64_tr_b16 v[56:57], v24 offset:21824
  s_mul_i32 s75, s79, 0x780
  s_add_u32 s75, s75, s81
  v_mfma_f32_16x16x32_bf16 v[156:159], v[34:37], a[28:31], v[156:159]
  ds_read_b64_tr_b16 v[58:59], v24 offset:20576
  s_add_u32 s75, s75, 0x500
  s_add_u32 m0, s74, 0
  v_mfma_f32_16x16x32_bf16 v[160:163], v[34:37], a[108:111], v[160:163]
  s_waitcnt lgkmcnt(14)
  ds_read_b64_tr_b16 v[60:61], v24 offset:21856
  v_mfma_f32_16x16x32_bf16 v[164:167], v[38:41], a[28:31], v[164:167]
  ds_read_b64_tr_b16 v[34:35], v24 offset:20608
  v_mfma_f32_16x16x32_bf16 v[168:171], v[38:41], a[108:111], v[168:171]
  s_waitcnt lgkmcnt(14)
  ds_read_b64_tr_b16 v[36:37], v24 offset:21888
  v_mfma_f32_16x16x32_bf16 v[172:175], v[42:45], a[28:31], v[172:175]
  ds_read_b64_tr_b16 v[38:39], v26 offset:20480
  buffer_load_dwordx4 v10, s[32:35], s75 offen lds
  v_mfma_f32_16x16x32_bf16 v[176:179], v[42:45], a[108:111], v[176:179]
  s_waitcnt lgkmcnt(9)
  ds_read_b64_tr_b16 v[40:41], v26 offset:21760
  v_mfma_f32_16x16x32_bf16 v[100:103], v[46:49], a[32:35], v[100:103]
  ds_read_b64_tr_b16 v[42:43], v26 offset:20512
  v_mfma_f32_16x16x32_bf16 v[104:107], v[46:49], a[112:115], v[104:107]
  ds_read_b64_tr_b16 v[44:45], v26 offset:21792
  v_mfma_f32_16x16x32_bf16 a[180:183], v[46:49], a[168:171], a[180:183]
  s_waitcnt lgkmcnt(10)
  v_mfma_f32_16x16x32_bf16 v[108:111], v[50:53], a[32:35], v[108:111]
  ds_read_b64_tr_b16 v[46:47], v26 offset:20544
  v_mfma_f32_16x16x32_bf16 v[112:115], v[50:53], a[112:115], v[112:115]
  ds_read_b64_tr_b16 v[48:49], v26 offset:21824
  buffer_load_dwordx4 v11, s[32:35], s75 offen offset:1024 lds
  v_mfma_f32_16x16x32_bf16 a[184:187], v[50:53], a[168:171], a[184:187]
  s_waitcnt lgkmcnt(10)
  v_mfma_f32_16x16x32_bf16 v[116:119], v[54:57], a[32:35], v[116:119]
  ds_read_b64_tr_b16 v[50:51], v26 offset:20576
  v_mfma_f32_16x16x32_bf16 v[120:123], v[54:57], a[112:115], v[120:123]
  ds_read_b64_tr_b16 v[52:53], v26 offset:21856
  v_mfma_f32_16x16x32_bf16 a[188:191], v[54:57], a[168:171], a[188:191]
  s_waitcnt lgkmcnt(10)
  v_mfma_f32_16x16x32_bf16 v[124:127], v[58:61], a[32:35], v[124:127]
  ds_read_b64_tr_b16 v[54:55], v26 offset:20608
  v_mfma_f32_16x16x32_bf16 v[128:131], v[58:61], a[112:115], v[128:131]
  ds_read_b64_tr_b16 v[56:57], v26 offset:21888
  buffer_load_dwordx4 v12, s[32:35], s75 offen offset:2048 lds
  v_mfma_f32_16x16x32_bf16 a[192:195], v[58:61], a[168:171], a[192:195]
  s_waitcnt lgkmcnt(10)
  v_mfma_f32_16x16x32_bf16 v[132:135], v[34:37], a[32:35], v[132:135]
  s_waitcnt vmcnt(10)
  ds_read_b128 a[40:43], v32 offset:6144
  ds_read_b128 a[44:47], v33 offset:6144
  s_waitcnt vmcnt(8)
  ds_read_b128 a[120:123], v32 offset:8192
  ds_read_b128 a[124:127], v33 offset:8192
  ds_read_b64_tr_b16 v[58:59], v28 offset:20480
  v_mfma_f32_16x16x32_bf16 v[136:139], v[34:37], a[112:115], v[136:139]
  ds_read_b64_tr_b16 v[60:61], v28 offset:21760
  v_mfma_f32_16x16x32_bf16 a[196:199], v[34:37], a[168:171], a[196:199]
  s_waitcnt lgkmcnt(14)
  v_mfma_f32_16x16x32_bf16 v[100:103], v[38:41], a[36:39], v[100:103]
  ds_read_b64_tr_b16 v[34:35], v28 offset:20512
  v_mfma_f32_16x16x32_bf16 v[104:107], v[38:41], a[116:119], v[104:107]
  s_waitcnt lgkmcnt(13)
  ds_read_b64_tr_b16 v[36:37], v28 offset:21792
  buffer_load_dwordx4 v13, s[32:35], s75 offen offset:3072 lds
  v_mfma_f32_16x16x32_bf16 v[108:111], v[42:45], a[36:39], v[108:111]
  ds_read_b64_tr_b16 v[38:39], v28 offset:20544
  s_add_u32 m0, s74, 0x1000
  v_mfma_f32_16x16x32_bf16 v[112:115], v[42:45], a[116:119], v[112:115]
  s_waitcnt lgkmcnt(13)
  ds_read_b64_tr_b16 v[40:41], v28 offset:21824
  v_mfma_f32_16x16x32_bf16 v[116:119], v[46:49], a[36:39], v[116:119]
  ds_read_b64_tr_b16 v[42:43], v28 offset:20576
  v_mfma_f32_16x16x32_bf16 v[120:123], v[46:49], a[116:119], v[120:123]
  s_waitcnt lgkmcnt(13)
  ds_read_b64_tr_b16 v[44:45], v28 offset:21856
  v_mfma_f32_16x16x32_bf16 v[124:127], v[50:53], a[36:39], v[124:127]
  ds_read_b64_tr_b16 v[46:47], v28 offset:20608
  v_mfma_f32_16x16x32_bf16 v[128:131], v[50:53], a[116:119], v[128:131]
  s_waitcnt lgkmcnt(13)
  ds_read_b64_tr_b16 v[48:49], v28 offset:21888
  buffer_load_dwordx4 v14, s[32:35], s75 offen lds
  v_mfma_f32_16x16x32_bf16 v[132:135], v[54:57], a[36:39], v[132:135]
  ds_read_b64_tr_b16 v[50:51], v30 offset:20480
  s_add_u32 m0, s82, 0
  v_mfma_f32_16x16x32_bf16 v[136:139], v[54:57], a[116:119], v[136:139]
  s_waitcnt lgkmcnt(9)
  ds_read_b64_tr_b16 v[52:53], v30 offset:21760
  v_mfma_f32_16x16x32_bf16 v[100:103], v[58:61], a[40:43], v[100:103]
  ds_read_b64_tr_b16 v[54:55], v30 offset:20512
  v_mfma_f32_16x16x32_bf16 v[104:107], v[58:61], a[120:123], v[104:107]
  s_waitcnt lgkmcnt(9)
  ds_read_b64_tr_b16 v[56:57], v30 offset:21792
  v_mfma_f32_16x16x32_bf16 v[108:111], v[34:37], a[40:43], v[108:111]
  ds_read_b64_tr_b16 v[58:59], v30 offset:20544
  v_mfma_f32_16x16x32_bf16 v[112:115], v[34:37], a[120:123], v[112:115]
  s_waitcnt lgkmcnt(9)
  ds_read_b64_tr_b16 v[60:61], v30 offset:21824
  buffer_load_dwordx4 v15, s[28:31], s79 offen lds
  v_mfma_f32_16x16x32_bf16 v[116:119], v[38:41], a[40:43], v[116:119]
  ds_read_b64_tr_b16 v[34:35], v30 offset:20576
  v_mfma_f32_16x16x32_bf16 v[120:123], v[38:41], a[120:123], v[120:123]
  s_waitcnt lgkmcnt(9)
  ds_read_b64_tr_b16 v[36:37], v30 offset:21856
  v_mfma_f32_16x16x32_bf16 v[124:127], v[42:45], a[40:43], v[124:127]
  ds_read_b64_tr_b16 v[38:39], v30 offset:20608
  v_mfma_f32_16x16x32_bf16 v[128:131], v[42:45], a[120:123], v[128:131]
  s_waitcnt lgkmcnt(9)
  ds_read_b64_tr_b16 v[40:41], v30 offset:21888
  buffer_load_dwordx4 v16, s[28:31], s79 offen offset:1024 lds
  v_mfma_f32_16x16x32_bf16 v[132:135], v[46:49], a[40:43], v[132:135]
  s_waitcnt vmcnt(7)
  s_barrier
  ds_read_b64_tr_b16 v[42:43], v24 offset:40960
  s_add_u32 m0, s82, 0x800
  v_mfma_f32_16x16x32_bf16 v[136:139], v[46:49], a[120:123], v[136:139]
  s_waitcnt lgkmcnt(9)
  ds_read_b64_tr_b16 v[44:45], v24 offset:42240
  v_mfma_f32_16x16x32_bf16 v[100:103], v[50:53], a[44:47], v[100:103]
  ds_read_b64_tr_b16 v[46:47], v24 offset:40992
  v_mfma_f32_16x16x32_bf16 v[104:107], v[50:53], a[124:127], v[104:107]
  s_waitcnt lgkmcnt(9)
  ds_read_b64_tr_b16 v[48:49], v24 offset:42272
  buffer_load_dwordx4 v17, s[28:31], s79 offen lds
  v_mfma_f32_16x16x32_bf16 v[108:111], v[54:57], a[44:47], v[108:111]
  ds_read_b64_tr_b16 v[50:51], v24 offset:41024
  v_mfma_f32_16x16x32_bf16 v[112:115], v[54:57], a[124:127], v[112:115]
  s_waitcnt lgkmcnt(9)
  ds_read_b64_tr_b16 v[52:53], v24 offset:42304
  v_mfma_f32_16x16x32_bf16 v[116:119], v[58:61], a[44:47], v[116:119]
  ds_read_b64_tr_b16 v[54:55], v24 offset:41056
  v_mfma_f32_16x16x32_bf16 v[120:123], v[58:61], a[124:127], v[120:123]
  s_waitcnt lgkmcnt(9)
  ds_read_b64_tr_b16 v[56:57], v24 offset:42336
  buffer_load_dwordx4 v18, s[28:31], s79 offen offset:1024 lds
  v_mfma_f32_16x16x32_bf16 v[124:127], v[34:37], a[44:47], v[124:127]
  ds_read_b64_tr_b16 v[58:59], v24 offset:41088
  s_add_u32 m0, s82, 0x1000
  v_mfma_f32_16x16x32_bf16 v[128:131], v[34:37], a[124:127], v[128:131]
  s_waitcnt lgkmcnt(9)
  ds_read_b64_tr_b16 v[60:61], v24 offset:42368
  v_mfma_f32_16x16x32_bf16 v[132:135], v[38:41], a[44:47], v[132:135]
  ds_read_b64_tr_b16 v[34:35], v26 offset:40960
  v_mfma_f32_16x16x32_bf16 v[136:139], v[38:41], a[124:127], v[136:139]
  s_waitcnt lgkmcnt(9)
  ds_read_b64_tr_b16 v[36:37], v26 offset:42240
  buffer_load_dwordx4 v23, s[28:31], s79 offen lds
  v_mfma_f32_16x16x32_bf16 v[140:143], v[42:45], a[32:35], v[140:143]
  ds_read_b64_tr_b16 v[38:39], v26 offset:40992
  s_add_u32 m0, s82, 0x1800
  v_mfma_f32_16x16x32_bf16 v[144:147], v[42:45], a[112:115], v[144:147]
  s_waitcnt lgkmcnt(9)
  ds_read_b64_tr_b16 v[40:41], v26 offset:42272
  v_mfma_f32_16x16x32_bf16 v[148:151], v[46:49], a[32:35], v[148:151]
  ds_read_b64_tr_b16 v[42:43], v26 offset:41024
  v_mfma_f32_16x16x32_bf16 v[152:155], v[46:49], a[112:115], v[152:155]
  s_waitcnt lgkmcnt(9)
  ds_read_b64_tr_b16 v[44:45], v26 offset:42304
  buffer_load_dwordx4 v19, s[28:31], s79 offen lds
  v_mfma_f32_16x16x32_bf16 v[156:159], v[50:53], a[32:35], v[156:159]
  ds_read_b64_tr_b16 v[46:47], v26 offset:41056
  v_mfma_f32_16x16x32_bf16 v[160:163], v[50:53], a[112:115], v[160:163]
  s_waitcnt lgkmcnt(9)
  ds_read_b64_tr_b16 v[48:49], v26 offset:42336
  v_mfma_f32_16x16x32_bf16 v[164:167], v[54:57], a[32:35], v[164:167]
  ds_read_b64_tr_b16 v[50:51], v26 offset:41088
  v_mfma_f32_16x16x32_bf16 v[168:171], v[54:57], a[112:115], v[168:171]
  s_waitcnt lgkmcnt(9)
  ds_read_b64_tr_b16 v[52:53], v26 offset:42368
  buffer_load_dwordx4 v20, s[28:31], s79 offen offset:1024 lds
  v_mfma_f32_16x16x32_bf16 v[172:175], v[58:61], a[32:35], v[172:175]
  ds_read_b64_tr_b16 v[54:55], v28 offset:40960
  s_add_u32 m0, s82, 0x2000
  v_mfma_f32_16x16x32_bf16 v[176:179], v[58:61], a[112:115], v[176:179]
  s_waitcnt lgkmcnt(9)
  ds_read_b64_tr_b16 v[56:57], v28 offset:42240
  v_mfma_f32_16x16x32_bf16 v[140:143], v[34:37], a[36:39], v[140:143]
  ds_read_b64_tr_b16 v[58:59], v28 offset:40992
  v_mfma_f32_16x16x32_bf16 v[144:147], v[34:37], a[116:119], v[144:147]
  s_waitcnt lgkmcnt(9)
  ds_read_b64_tr_b16 v[60:61], v28 offset:42272
  buffer_load_dwordx4 v21, s[28:31], s79 offen lds
  v_mfma_f32_16x16x32_bf16 v[148:151], v[38:41], a[36:39], v[148:151]
  ds_read_b64_tr_b16 v[34:35], v28 offset:41024
  v_mfma_f32_16x16x32_bf16 v[152:155], v[38:41], a[116:119], v[152:155]
  s_waitcnt lgkmcnt(9)
  ds_read_b64_tr_b16 v[36:37], v28 offset:42304
  v_mfma_f32_16x16x32_bf16 v[156:159], v[42:45], a[36:39], v[156:159]
  ds_read_b64_tr_b16 v[38:39], v28 offset:41056
  v_mfma_f32_16x16x32_bf16 v[160:163], v[42:45], a[116:119], v[160:163]
  s_waitcnt lgkmcnt(9)
  ds_read_b64_tr_b16 v[40:41], v28 offset:42336
  buffer_load_dwordx4 v22, s[28:31], s79 offen offset:1024 lds
  v_mfma_f32_16x16x32_bf16 v[164:167], v[46:49], a[36:39], v[164:167]
  ds_read_b64_tr_b16 v[42:43], v28 offset:41088
  s_mul_i32 s75, s79, 0x780
  s_add_u32 s75, s75, s81
  v_mfma_f32_16x16x32_bf16 v[168:171], v[46:49], a[116:119], v[168:171]
  s_waitcnt lgkmcnt(9)
  ds_read_b64_tr_b16 v[44:45], v28 offset:42368
  s_add_u32 m0, s74, 0x5000
  v_mfma_f32_16x16x32_bf16 v[172:175], v[50:53], a[36:39], v[172:175]
  ds_read_b64_tr_b16 v[46:47], v30 offset:40960
  v_mfma_f32_16x16x32_bf16 v[176:179], v[50:53], a[116:119], v[176:179]
  s_waitcnt lgkmcnt(9)
  ds_read_b64_tr_b16 v[48:49], v30 offset:42240
  buffer_load_dwordx4 v10, s[32:35], s75 offen lds
  v_mfma_f32_16x16x32_bf16 v[140:143], v[54:57], a[40:43], v[140:143]
  ds_read_b64_tr_b16 v[50:51], v30 offset:40992
  v_mfma_f32_16x16x32_bf16 v[144:147], v[54:57], a[120:123], v[144:147]
  s_waitcnt lgkmcnt(9)
  ds_read_b64_tr_b16 v[52:53], v30 offset:42272
  v_mfma_f32_16x16x32_bf16 v[148:151], v[58:61], a[40:43], v[148:151]
  ds_read_b64_tr_b16 v[54:55], v30 offset:41024
  v_mfma_f32_16x16x32_bf16 v[152:155], v[58:61], a[120:123], v[152:155]
  s_waitcnt lgkmcnt(9)
  ds_read_b64_tr_b16 v[56:57], v30 offset:42304
  v_mfma_f32_16x16x32_bf16 v[156:159], v[34:37], a[40:43], v[156:159]
  ds_read_b64_tr_b16 v[58:59], v30 offset:41056
  v_mfma_f32_16x16x32_bf16 v[160:163], v[34:37], a[120:123], v[160:163]
  s_waitcnt lgkmcnt(9)
  ds_read_b64_tr_b16 v[60:61], v30 offset:42336
  buffer_load_dwordx4 v11, s[32:35], s75 offen offset:1024 lds
  v_mfma_f32_16x16x32_bf16 v[164:167], v[38:41], a[40:43], v[164:167]
  ds_read_b64_tr_b16 v[34:35], v30 offset:41088
  v_mfma_f32_16x16x32_bf16 v[168:171], v[38:41], a[120:123], v[168:171]
  s_waitcnt lgkmcnt(9)
  ds_read_b64_tr_b16 v[36:37], v30 offset:42368
  v_mfma_f32_16x16x32_bf16 v[172:175], v[42:45], a[40:43], v[172:175]
  s_waitcnt vmcnt(11)
  s_barrier
  s_waitcnt vmcnt(9)
  ds_read_b128 a[48:51], v32
  ds_read_b128 a[52:55], v33
  s_waitcnt vmcnt(7)
  ds_read_b128 a[128:131], v32 offset:2048
  ds_read_b128 a[132:135], v33 offset:2048
  s_waitcnt vmcnt(6)
  ds_read_b128 a[172:175], v31 offset:4096
  ds_read_b64_tr_b16 v[38:39], v9
  v_mfma_f32_16x16x32_bf16 v[176:179], v[42:45], a[120:123], v[176:179]
  s_waitcnt lgkmcnt(14)
  ds_read_b64_tr_b16 v[40:41], v9 offset:1280
  v_mfma_f32_16x16x32_bf16 v[140:143], v[46:49], a[44:47], v[140:143]
  ds_read_b64_tr_b16 v[42:43], v9 offset:32
  v_mfma_f32_16x16x32_bf16 v[144:147], v[46:49], a[124:127], v[144:147]
  s_waitcnt lgkmcnt(14)
  ds_read_b64_tr_b16 v[44:45], v9 offset:1312
  buffer_load_dwordx4 v12, s[32:35], s75 offen offset:2048 lds
  v_mfma_f32_16x16x32_bf16 v[148:151], v[50:53], a[44:47], v[148:151]
  ds_read_b64_tr_b16 v[46:47], v9 offset:64
  v_mfma_f32_16x16x32_bf16 v[152:155], v[50:53], a[124:127], v[152:155]
  s_waitcnt lgkmcnt(14)
  ds_read_b64_tr_b16 v[48:49], v9 offset:1344
  v_mfma_f32_16x16x32_bf16 v[156:159], v[54:57], a[44:47], v[156:159]
  ds_read_b64_tr_b16 v[50:51], v9 offset:96
  v_mfma_f32_16x16x32_bf16 v[160:163], v[54:57], a[124:127], v[160:163]
  s_waitcnt lgkmcnt(14)
  ds_read_b64_tr_b16 v[52:53], v9 offset:1376
  v_mfma_f32_16x16x32_bf16 v[164:167], v[58:61], a[44:47], v[164:167]
  ds_read_b64_tr_b16 v[54:55], v9 offset:128
  v_mfma_f32_16x16x32_bf16 v[168:171], v[58:61], a[124:127], v[168:171]
  s_waitcnt lgkmcnt(14)
  ds_read_b64_tr_b16 v[56:57], v9 offset:1408
  buffer_load_dwordx4 v13, s[32:35], s75 offen offset:3072 lds
  v_mfma_f32_16x16x32_bf16 v[172:175], v[34:37], a[44:47], v[172:175]
  ds_read_b64_tr_b16 v[58:59], v25
  s_add_u32 m0, s74, 0x6000
  v_mfma_f32_16x16x32_bf16 v[176:179], v[34:37], a[124:127], v[176:179]
  s_waitcnt lgkmcnt(9)
  ds_read_b64_tr_b16 v[60:61], v25 offset:1280
  v_mfma_f32_16x16x32_bf16 v[100:103], v[38:41], a[48:51], v[100:103]
  ds_read_b64_tr_b16 v[34:35], v25 offset:32
  v_mfma_f32_16x16x32_bf16 v[104:107], v[38:41], a[128:131], v[104:107]
  ds_read_b64_tr_b16 v[36:37], v25 offset:1312
  v_mfma_f32_16x16x32_bf16 a[180:183], v[38:41], a[172:175], a[180:183]
  s_waitcnt lgkmcnt(10)
  v_mfma_f32_16x16x32_bf16 v[108:111], v[42:45], a[48:51], v[108:111]
  ds_read_b64_tr_b16 v[38:39], v25 offset:64
  buffer_load_dwordx4 v14, s[32:35], s75 offen lds
  v_mfma_f32_16x16x32_bf16 v[112:115], v[42:45], a[128:131], v[112:115]
  ds_read_b64_tr_b16 v[40:41], v25 offset:1344
  s_mul_i32 s75, s80, 0x780
  s_add_u32 s75, s75, s81
  v_mfma_f32_16x16x32_bf16 a[184:187], v[42:45], a[172:175], a[184:187]
  s_waitcnt lgkmcnt(10)
  s_add_u32 s75, s75, 0x500
  s_add_u32 m0, s74, 0xa000
  v_mfma_f32_16x16x32_bf16 v[116:119], v[46:49], a[48:51], v[116:119]
  ds_read_b64_tr_b16 v[42:43], v25 offset:96
  v_mfma_f32_16x16x32_bf16 v[120:123], v[46:49], a[128:131], v[120:123]
  ds_read_b64_tr_b16 v[44:45], v25 offset:1376
  v_mfma_f32_16x16x32_bf16 a[188:191], v[46:49], a[172:175], a[188:191]
  s_waitcnt lgkmcnt(10)
  v_mfma_f32_16x16x32_bf16 v[124:127], v[50:53], a[48:51], v[124:127]
  ds_read_b64_tr_b16 v[46:47], v25 offset:128
  buffer_load_dwordx4 v10, s[32:35], s75 offen lds
  v_mfma_f32_16x16x32_bf16 v[128:131], v[50:53], a[128:131], v[128:131]
  ds_read_b64_tr_b16 v[48:49], v25 offset:1408
  v_mfma_f32_16x16x32_bf16 a[192:195], v[50:53], a[172:175], a[192:195]
  s_waitcnt lgkmcnt(10)
  v_mfma_f32_16x16x32_bf16 v[132:135], v[54:57], a[48:51], v[132:135]
  s_waitcnt vmcnt(8)
  ds_read_b128 a[56:59], v32 offset:6144
  ds_read_b128 a[60:63], v33 offset:6144
  s_waitcnt vmcnt(6)
  ds_read_b128 a[136:139], v32 offset:8192
  ds_read_b128 a[140:143], v33 offset:8192
  ds_read_b64_tr_b16 v[50:51], v27
  v_mfma_f32_16x16x32_bf16 v[136:139], v[54:57], a[128:131], v[136:139]
  ds_read_b64_tr_b16 v[52:53], v27 offset:1280
  v_mfma_f32_16x16x32_bf16 a[196:199], v[54:57], a[172:175], a[196:199]
  s_waitcnt lgkmcnt(14)
  v_mfma_f32_16x16x32_bf16 v[100:103], v[58:61], a[52:55], v[100:103]
  ds_read_b64_tr_b16 v[54:55], v27 offset:32
  buffer_load_dwordx4 v11, s[32:35], s75 offen offset:1024 lds
  v_mfma_f32_16x16x32_bf16 v[104:107], v[58:61], a[132:135], v[104:107]
  s_waitcnt lgkmcnt(13)
  ds_read_b64_tr_b16 v[56:57], v27 offset:1312
  v_mfma_f32_16x16x32_bf16 v[108:111], v[34:37], a[52:55], v[108:111]
  ds_read_b64_tr_b16 v[58:59], v27 offset:64
  v_mfma_f32_16x16x32_bf16 v[112:115], v[34:37], a[132:135], v[112:115]
  s_waitcnt lgkmcnt(13)
  ds_read_b64_tr_b16 v[60:61], v27 offset:1344
  v_mfma_f32_16x16x32_bf16 v[116:119], v[38:41], a[52:55], v[116:119]
  ds_read_b64_tr_b16 v[34:35], v27 offset:96
  v_mfma_f32_16x16x32_bf16 v[120:123], v[38:41], a[132:135], v[120:123]
  s_waitcnt lgkmcnt(13)
  ds_read_b64_tr_b16 v[36:37], v27 offset:1376
  v_mfma_f32_16x16x32_bf16 v[124:127], v[42:45], a[52:55], v[124:127]
  ds_read_b64_tr_b16 v[38:39], v27 offset:128
  buffer_load_dwordx4 v12, s[32:35], s75 offen offset:2048 lds
  v_mfma_f32_16x16x32_bf16 v[128:131], v[42:45], a[132:135], v[128:131]
  s_waitcnt lgkmcnt(13)
  ds_read_b64_tr_b16 v[40:41], v27 offset:1408
  v_mfma_f32_16x16x32_bf16 v[132:135], v[46:49], a[52:55], v[132:135]
  ds_read_b64_tr_b16 v[42:43], v29
  v_mfma_f32_16x16x32_bf16 v[136:139], v[46:49], a[132:135], v[136:139]
  s_waitcnt lgkmcnt(9)
  ds_read_b64_tr_b16 v[44:45], v29 offset:1280
  v_mfma_f32_16x16x32_bf16 v[100:103], v[50:53], a[56:59], v[100:103]
  ds_read_b64_tr_b16 v[46:47], v29 offset:32
  v_mfma_f32_16x16x32_bf16 v[104:107], v[50:53], a[136:139], v[104:107]
  s_waitcnt lgkmcnt(9)
  ds_read_b64_tr_b16 v[48:49], v29 offset:1312
  v_mfma_f32_16x16x32_bf16 v[108:111], v[54:57], a[56:59], v[108:111]
  ds_read_b64_tr_b16 v[50:51], v29 offset:64
  buffer_load_dwordx4 v13, s[32:35], s75 offen offset:3072 lds
  v_mfma_f32_16x16x32_bf16 v[112:115], v[54:57], a[136:139], v[112:115]
  s_waitcnt lgkmcnt(9)
  ds_read_b64_tr_b16 v[52:53], v29 offset:1344
  s_add_u32 m0, s74, 0xb000
  v_mfma_f32_16x16x32_bf16 v[116:119], v[58:61], a[56:59], v[116:119]
  ds_read_b64_tr_b16 v[54:55], v29 offset:96
  v_mfma_f32_16x16x32_bf16 v[120:123], v[58:61], a[136:139], v[120:123]
  s_waitcnt lgkmcnt(9)
  ds_read_b64_tr_b16 v[56:57], v29 offset:1376
  v_mfma_f32_16x16x32_bf16 v[124:127], v[34:37], a[56:59], v[124:127]
  ds_read_b64_tr_b16 v[58:59], v29 offset:128
  v_mfma_f32_16x16x32_bf16 v[128:131], v[34:37], a[136:139], v[128:131]
  s_waitcnt lgkmcnt(9)
  ds_read_b64_tr_b16 v[60:61], v29 offset:1408
  v_mfma_f32_16x16x32_bf16 v[132:135], v[38:41], a[56:59], v[132:135]
  s_waitcnt vmcnt(4)
  s_barrier
  ds_read_b64_tr_b16 v[34:35], v9 offset:20480
  buffer_load_dwordx4 v14, s[32:35], s75 offen lds
  v_mfma_f32_16x16x32_bf16 v[136:139], v[38:41], a[136:139], v[136:139]
  s_waitcnt lgkmcnt(9)
  ds_read_b64_tr_b16 v[36:37], v9 offset:21760
  s_add_u32 m0, s82, 0
  v_mfma_f32_16x16x32_bf16 v[100:103], v[42:45], a[60:63], v[100:103]
  ds_read_b64_tr_b16 v[38:39], v9 offset:20512
  v_mfma_f32_16x16x32_bf16 v[104:107], v[42:45], a[140:143], v[104:107]
  s_waitcnt lgkmcnt(9)
  ds_read_b64_tr_b16 v[40:41], v9 offset:21792
  v_mfma_f32_16x16x32_bf16 v[108:111], v[46:49], a[60:63], v[108:111]
  ds_read_b64_tr_b16 v[42:43], v9 offset:20544
  v_mfma_f32_16x16x32_bf16 v[112:115], v[46:49], a[140:143], v[112:115]
  s_waitcnt lgkmcnt(9)
  ds_read_b64_tr_b16 v[44:45], v9 offset:21824
  v_mfma_f32_16x16x32_bf16 v[116:119], v[50:53], a[60:63], v[116:119]
  ds_read_b64_tr_b16 v[46:47], v9 offset:20576
  buffer_load_dwordx4 v15, s[28:31], s80 offen lds
  v_mfma_f32_16x16x32_bf16 v[120:123], v[50:53], a[140:143], v[120:123]
  s_waitcnt lgkmcnt(9)
  ds_read_b64_tr_b16 v[48:49], v9 offset:21856
  v_mfma_f32_16x16x32_bf16 v[124:127], v[54:57], a[60:63], v[124:127]
  ds_read_b64_tr_b16 v[50:51], v9 offset:20608
  v_mfma_f32_16x16x32_bf16 v[128:131], v[54:57], a[140:143], v[128:131]
  s_waitcnt lgkmcnt(9)
  ds_read_b64_tr_b16 v[52:53], v9 offset:21888
  v_mfma_f32_16x16x32_bf16 v[132:135], v[58:61], a[60:63], v[132:135]
  ds_read_b64_tr_b16 v[54:55], v25 offset:20480
  buffer_load_dwordx4 v16, s[28:31], s80 offen offset:1024 lds
  v_mfma_f32_16x16x32_bf16 v[136:139], v[58:61], a[140:143], v[136:139]
  s_waitcnt lgkmcnt(9)
  ds_read_b64_tr_b16 v[56:57], v25 offset:21760
  s_add_u32 m0, s82, 0x800
  v_mfma_f32_16x16x32_bf16 v[140:143], v[34:37], a[48:51], v[140:143]
  ds_read_b64_tr_b16 v[58:59], v25 offset:20512
  v_mfma_f32_16x16x32_bf16 v[144:147], v[34:37], a[128:131], v[144:147]
  s_waitcnt lgkmcnt(9)
  ds_read_b64_tr_b16 v[60:61], v25 offset:21792
  v_mfma_f32_16x16x32_bf16 v[148:151], v[38:41], a[48:51], v[148:151]
  ds_read_b64_tr_b16 v[34:35], v25 offset:20544
  buffer_load_dwordx4 v17, s[28:31], s80 offen lds
  v_mfma_f32_16x16x32_bf16 v[152:155], v[38:41], a[128:131], v[152:155]
  s_waitcnt lgkmcnt(9)
  ds_read_b64_tr_b16 v[36:37], v25 offset:21824
  v_mfma_f32_16x16x32_bf16 v[156:159], v[42:45], a[48:51], v[156:159]
  ds_read_b64_tr_b16 v[38:39], v25 offset:20576
  v_mfma_f32_16x16x32_bf16 v[160:163], v[42:45], a[128:131], v[160:163]
  s_waitcnt lgkmcnt(9)
  ds_read_b64_tr_b16 v[40:41], v25 offset:21856
  v_mfma_f32_16x16x32_bf16 v[164:167], v[46:49], a[48:51], v[164:167]
  ds_read_b64_tr_b16 v[42:43], v25 offset:20608
  buffer_load_dwordx4 v18, s[28:31], s80 offen offset:1024 lds
  v_mfma_f32_16x16x32_bf16 v[168:171], v[46:49], a[128:131], v[168:171]
  s_waitcnt lgkmcnt(9)
  ds_read_b64_tr_b16 v[44:45], v25 offset:21888
  s_add_u32 m0, s82, 0x1000
  v_mfma_f32_16x16x32_bf16 v[172:175], v[50:53], a[48:51], v[172:175]
  ds_read_b64_tr_b16 v[46:47], v27 offset:20480
  v_mfma_f32_16x16x32_bf16 v[176:179], v[50:53], a[128:131], v[176:179]
  s_waitcnt lgkmcnt(9)
  ds_read_b64_tr_b16 v[48:49], v27 offset:21760
  v_mfma_f32_16x16x32_bf16 v[140:143], v[54:57], a[52:55], v[140:143]
  ds_read_b64_tr_b16 v[50:51], v27 offset:20512
  buffer_load_dwordx4 v23, s[28:31], s80 offen lds
  v_mfma_f32_16x16x32_bf16 v[144:147], v[54:57], a[132:135], v[144:147]
  s_waitcnt lgkmcnt(9)
  ds_read_b64_tr_b16 v[52:53], v27 offset:21792
  s_add_u32 m0, s82, 0x1800
  v_mfma_f32_16x16x32_bf16 v[148:151], v[58:61], a[52:55], v[148:151]
  ds_read_b64_tr_b16 v[54:55], v27 offset:20544
  v_mfma_f32_16x16x32_bf16 v[152:155], v[58:61], a[132:135], v[152:155]
  s_waitcnt lgkmcnt(9)
  ds_read_b64_tr_b16 v[56:57], v27 offset:21824
  v_mfma_f32_16x16x32_bf16 v[156:159], v[34:37], a[52:55], v[156:159]
  ds_read_b64_tr_b16 v[58:59], v27 offset:20576
  buffer_load_dwordx4 v19, s[28:31], s80 offen lds
  v_mfma_f32_16x16x32_bf16 v[160:163], v[34:37], a[132:135], v[160:163]
  s_waitcnt lgkmcnt(9)
  ds_read_b64_tr_b16 v[60:61], v27 offset:21856
  v_mfma_f32_16x16x32_bf16 v[164:167], v[38:41], a[52:55], v[164:167]
  ds_read_b64_tr_b16 v[34:35], v27 offset:20608
  v_mfma_f32_16x16x32_bf16 v[168:171], v[38:41], a[132:135], v[168:171]
  s_waitcnt lgkmcnt(9)
  ds_read_b64_tr_b16 v[36:37], v27 offset:21888
  v_mfma_f32_16x16x32_bf16 v[172:175], v[42:45], a[52:55], v[172:175]
  ds_read_b64_tr_b16 v[38:39], v29 offset:20480
  buffer_load_dwordx4 v20, s[28:31], s80 offen offset:1024 lds
  v_mfma_f32_16x16x32_bf16 v[176:179], v[42:45], a[132:135], v[176:179]
  s_waitcnt lgkmcnt(9)
  ds_read_b64_tr_b16 v[40:41], v29 offset:21760
  s_add_u32 m0, s82, 0x2000
  v_mfma_f32_16x16x32_bf16 v[140:143], v[46:49], a[56:59], v[140:143]
  ds_read_b64_tr_b16 v[42:43], v29 offset:20512
  v_mfma_f32_16x16x32_bf16 v[144:147], v[46:49], a[136:139], v[144:147]
  s_waitcnt lgkmcnt(9)
  ds_read_b64_tr_b16 v[44:45], v29 offset:21792
  v_mfma_f32_16x16x32_bf16 v[148:151], v[50:53], a[56:59], v[148:151]
  ds_read_b64_tr_b16 v[46:47], v29 offset:20544
  buffer_load_dwordx4 v21, s[28:31], s80 offen lds
  v_mfma_f32_16x16x32_bf16 v[152:155], v[50:53], a[136:139], v[152:155]
  s_waitcnt lgkmcnt(9)
  ds_read_b64_tr_b16 v[48:49], v29 offset:21824
  v_mfma_f32_16x16x32_bf16 v[156:159], v[54:57], a[56:59], v[156:159]
  ds_read_b64_tr_b16 v[50:51], v29 offset:20576
  v_mfma_f32_16x16x32_bf16 v[160:163], v[54:57], a[136:139], v[160:163]
  s_waitcnt lgkmcnt(9)
  ds_read_b64_tr_b16 v[52:53], v29 offset:21856
  v_mfma_f32_16x16x32_bf16 v[164:167], v[58:61], a[56:59], v[164:167]
  ds_read_b64_tr_b16 v[54:55], v29 offset:20608
  buffer_load_dwordx4 v22, s[28:31], s80 offen offset:1024 lds
  v_mfma_f32_16x16x32_bf16 v[168:171], v[58:61], a[136:139], v[168:171]
  s_waitcnt lgkmcnt(9)
  ds_read_b64_tr_b16 v[56:57], v29 offset:21888
  s_mul_i32 s75, s80, 0x780
  s_add_u32 s75, s75, s81
  v_mfma_f32_16x16x32_bf16 v[172:175], v[34:37], a[56:59], v[172:175]
  s_waitcnt vmcnt(9)
  s_barrier
  s_waitcnt vmcnt(7)
  ds_read_b128 a[64:67], v32
  ds_read_b128 a[68:71], v33
  s_waitcnt vmcnt(5)
  ds_read_b128 a[144:147], v32 offset:2048
  ds_read_b128 a[148:151], v33 offset:2048
  s_waitcnt vmcnt(4)
  ds_read_b128 a[176:179], v31 offset:4096
  ds_read_b64_tr_b16 v[58:59], v9 offset:40960
  s_add_u32 m0, s74, 0xf000
  v_mfma_f32_16x16x32_bf16 v[176:179], v[34:37], a[136:139], v[176:179]
  s_waitcnt lgkmcnt(14)
  ds_read_b64_tr_b16 v[60:61], v9 offset:42240
  v_mfma_f32_16x16x32_bf16 v[140:143], v[38:41], a[60:63], v[140:143]
  ds_read_b64_tr_b16 v[34:35], v9 offset:40992
  v_mfma_f32_16x16x32_bf16 v[144:147], v[38:41], a[140:143], v[144:147]
  s_waitcnt lgkmcnt(14)
  ds_read_b64_tr_b16 v[36:37], v9 offset:42272
  v_mfma_f32_16x16x32_bf16 v[148:151], v[42:45], a[60:63], v[148:151]
  ds_read_b64_tr_b16 v[38:39], v9 offset:41024
  buffer_load_dwordx4 v10, s[32:35], s75 offen lds
  v_mfma_f32_16x16x32_bf16 v[152:155], v[42:45], a[140:143], v[152:155]
  s_waitcnt lgkmcnt(14)
  ds_read_b64_tr_b16 v[40:41], v9 offset:42304
  v_mfma_f32_16x16x32_bf16 v[156:159], v[46:49], a[60:63], v[156:159]
  ds_read_b64_tr_b16 v[42:43], v9 offset:41056
  v_mfma_f32_16x16x32_bf16 v[160:163], v[46:49], a[140:143], v[160:163]
  s_waitcnt lgkmcnt(14)
  ds_read_b64_tr_b16 v[44:45], v9 offset:42336
  v_mfma_f32_16x16x32_bf16 v[164:167], v[50:53], a[60:63], v[164:167]
  ds_read_b64_tr_b16 v[46:47], v9 offset:41088
  v_mfma_f32_16x16x32_bf16 v[168:171], v[50:53], a[140:143], v[168:171]
  s_waitcnt lgkmcnt(14)
  ds_read_b64_tr_b16 v[48:49], v9 offset:42368
  v_mfma_f32_16x16x32_bf16 v[172:175], v[54:57], a[60:63], v[172:175]
  ds_read_b64_tr_b16 v[50:51], v25 offset:40960
  buffer_load_dwordx4 v11, s[32:35], s75 offen offset:1024 lds
  v_mfma_f32_16x16x32_bf16 v[176:179], v[54:57], a[140:143], v[176:179]
  s_waitcnt lgkmcnt(9)
  ds_read_b64_tr_b16 v[52:53], v25 offset:42240
  v_mfma_f32_16x16x32_bf16 v[100:103], v[58:61], a[64:67], v[100:103]
  ds_read_b64_tr_b16 v[54:55], v25 offset:40992
  v_mfma_f32_16x16x32_bf16 v[104:107], v[58:61], a[144:147], v[104:107]
  ds_read_b64_tr_b16 v[56:57], v25 offset:42272
  v_mfma_f32_16x16x32_bf16 a[180:183], v[58:61], a[176:179], a[180:183]
  s_waitcnt lgkmcnt(10)
  v_mfma_f32_16x16x32_bf16 v[108:111], v[34:37], a[64:67], v[108:111]
  ds_read_b64_tr_b16 v[58:59], v25 offset:41024
  v_mfma_f32_16x16x32_bf16 v[112:115], v[34:37], a[144:147], v[112:115]
  ds_read_b64_tr_b16 v[60:61], v25 offset:42304
  buffer_load_dwordx4 v12, s[32:35], s75 offen offset:2048 lds
  v_mfma_f32_16x16x32_bf16 a[184:187], v[34:37], a[176:179], a[184:187]
  s_waitcnt lgkmcnt(10)
  v_mfma_f32_16x16x32_bf16 v[116:119], v[38:41], a[64:67], v[116:119]
  ds_read_b64_tr_b16 v[34:35], v25 offset:41056
  v_mfma_f32_16x16x32_bf16 v[120:123], v[38:41], a[144:147], v[120:123]
  ds_read_b64_tr_b16 v[36:37], v25 offset:42336
  v_mfma_f32_16x16x32_bf16 a[188:191], v[38:41], a[176:179], a[188:191]
  s_waitcnt lgkmcnt(10)
  v_mfma_f32_16x16x32_bf16 v[124:127], v[42:45], a[64:67], v[124:127]
  ds_read_b64_tr_b16 v[38:39], v25 offset:41088
  v_mfma_f32_16x16x32_bf16 v[128:131], v[42:45], a[144:147], v[128:131]
  ds_read_b64_tr_b16 v[40:41], v25 offset:42368
  buffer_load_dwordx4 v13, s[32:35], s75 offen offset:3072 lds
  v_mfma_f32_16x16x32_bf16 a[192:195], v[42:45], a[176:179], a[192:195]
  s_waitcnt lgkmcnt(10)
  s_add_u32 m0, s74, 0x10000
  v_mfma_f32_16x16x32_bf16 v[132:135], v[46:49], a[64:67], v[132:135]
  s_waitcnt vmcnt(6)
  ds_read_b128 a[72:75], v32 offset:6144
  ds_read_b128 a[76:79], v33 offset:6144
  s_waitcnt vmcnt(4)
  ds_read_b128 a[152:155], v32 offset:8192
  ds_read_b128 a[156:159], v33 offset:8192
  ds_read_b64_tr_b16 v[42:43], v27 offset:40960
  v_mfma_f32_16x16x32_bf16 v[136:139], v[46:49], a[144:147], v[136:139]
  ds_read_b64_tr_b16 v[44:45], v27 offset:42240
  v_mfma_f32_16x16x32_bf16 a[196:199], v[46:49], a[176:179], a[196:199]
  s_waitcnt lgkmcnt(14)
  v_mfma_f32_16x16x32_bf16 v[100:103], v[50:53], a[68:71], v[100:103]
  ds_read_b64_tr_b16 v[46:47], v27 offset:40992
  v_mfma_f32_16x16x32_bf16 v[104:107], v[50:53], a[148:151], v[104:107]
  s_waitcnt lgkmcnt(13)
  ds_read_b64_tr_b16 v[48:49], v27 offset:42272
  buffer_load_dwordx4 v14, s[32:35], s75 offen lds
  v_mfma_f32_16x16x32_bf16 v[108:111], v[54:57], a[68:71], v[108:111]
  ds_read_b64_tr_b16 v[50:51], v27 offset:41024
  s_mul_i32 s75, s76, 0x780
  s_add_u32 s75, s75, s81
  v_mfma_f32_16x16x32_bf16 v[112:115], v[54:57], a[148:151], v[112:115]
  s_waitcnt lgkmcnt(13)
  ds_read_b64_tr_b16 v[52:53], v27 offset:42304
  s_add_u32 s75, s75, 0xa00
  s_add_u32 m0, s74, 0x14000
  v_mfma_f32_16x16x32_bf16 v[116:119], v[58:61], a[68:71], v[116:119]
  ds_read_b64_tr_b16 v[54:55], v27 offset:41056
  v_mfma_f32_16x16x32_bf16 v[120:123], v[58:61], a[148:151], v[120:123]
  s_waitcnt lgkmcnt(13)
  ds_read_b64_tr_b16 v[56:57], v27 offset:42336
  v_mfma_f32_16x16x32_bf16 v[124:127], v[34:37], a[68:71], v[124:127]
  ds_read_b64_tr_b16 v[58:59], v27 offset:41088
  v_mfma_f32_16x16x32_bf16 v[128:131], v[34:37], a[148:151], v[128:131]
  s_waitcnt lgkmcnt(13)
  ds_read_b64_tr_b16 v[60:61], v27 offset:42368
  buffer_load_dwordx4 v10, s[32:35], s75 offen lds
  v_mfma_f32_16x16x32_bf16 v[132:135], v[38:41], a[68:71], v[132:135]
  ds_read_b64_tr_b16 v[34:35], v29 offset:40960
  v_mfma_f32_16x16x32_bf16 v[136:139], v[38:41], a[148:151], v[136:139]
  s_waitcnt lgkmcnt(9)
  ds_read_b64_tr_b16 v[36:37], v29 offset:42240
  v_mfma_f32_16x16x32_bf16 v[100:103], v[42:45], a[72:75], v[100:103]
  ds_read_b64_tr_b16 v[38:39], v29 offset:40992
  v_mfma_f32_16x16x32_bf16 v[104:107], v[42:45], a[152:155], v[104:107]
  s_waitcnt lgkmcnt(9)
  ds_read_b64_tr_b16 v[40:41], v29 offset:42272
  v_mfma_f32_16x16x32_bf16 v[108:111], v[46:49], a[72:75], v[108:111]
  ds_read_b64_tr_b16 v[42:43], v29 offset:41024
  v_mfma_f32_16x16x32_bf16 v[112:115], v[46:49], a[152:155], v[112:115]
  s_waitcnt lgkmcnt(9)
  ds_read_b64_tr_b16 v[44:45], v29 offset:42304
  buffer_load_dwordx4 v11, s[32:35], s75 offen offset:1024 lds
  v_mfma_f32_16x16x32_bf16 v[116:119], v[50:53], a[72:75], v[116:119]
  ds_read_b64_tr_b16 v[46:47], v29 offset:41056
  v_mfma_f32_16x16x32_bf16 v[120:123], v[50:53], a[152:155], v[120:123]
  s_waitcnt lgkmcnt(9)
  ds_read_b64_tr_b16 v[48:49], v29 offset:42336
  v_mfma_f32_16x16x32_bf16 v[124:127], v[54:57], a[72:75], v[124:127]
  ds_read_b64_tr_b16 v[50:51], v29 offset:41088
  v_mfma_f32_16x16x32_bf16 v[128:131], v[54:57], a[152:155], v[128:131]
  s_waitcnt lgkmcnt(9)
  ds_read_b64_tr_b16 v[52:53], v29 offset:42368
  v_mfma_f32_16x16x32_bf16 v[132:135], v[58:61], a[72:75], v[132:135]
  s_waitcnt vmcnt(2)
  s_barrier
  ds_read_b64_tr_b16 v[54:55], v24
  v_mfma_f32_16x16x32_bf16 v[136:139], v[58:61], a[152:155], v[136:139]
  s_waitcnt lgkmcnt(9)
  ds_read_b64_tr_b16 v[56:57], v24 offset:1280
  buffer_load_dwordx4 v12, s[32:35], s75 offen offset:2048 lds
  v_mfma_f32_16x16x32_bf16 v[100:103], v[34:37], a[76:79], v[100:103]
  ds_read_b64_tr_b16 v[58:59], v24 offset:32
  v_mfma_f32_16x16x32_bf16 v[104:107], v[34:37], a[156:159], v[104:107]
  s_waitcnt lgkmcnt(9)
  ds_read_b64_tr_b16 v[60:61], v24 offset:1312
  v_mfma_f32_16x16x32_bf16 v[108:111], v[38:41], a[76:79], v[108:111]
  ds_read_b64_tr_b16 v[34:35], v24 offset:64
  v_mfma_f32_16x16x32_bf16 v[112:115], v[38:41], a[156:159], v[112:115]
  s_waitcnt lgkmcnt(9)
  ds_read_b64_tr_b16 v[36:37], v24 offset:1344
  v_mfma_f32_16x16x32_bf16 v[116:119], v[42:45], a[76:79], v[116:119]
  ds_read_b64_tr_b16 v[38:39], v24 offset:96
  v_mfma_f32_16x16x32_bf16 v[120:123], v[42:45], a[156:159], v[120:123]
  s_waitcnt lgkmcnt(9)
  ds_read_b64_tr_b16 v[40:41], v24 offset:1376
  buffer_load_dwordx4 v13, s[32:35], s75 offen offset:3072 lds
  v_mfma_f32_16x16x32_bf16 v[124:127], v[46:49], a[76:79], v[124:127]
  ds_read_b64_tr_b16 v[42:43], v24 offset:128
  s_add_u32 m0, s74, 0x15000
  v_mfma_f32_16x16x32_bf16 v[128:131], v[46:49], a[156:159], v[128:131]
  s_waitcnt lgkmcnt(9)
  ds_read_b64_tr_b16 v[44:45], v24 offset:1408
  v_mfma_f32_16x16x32_bf16 v[132:135], v[50:53], a[76:79], v[132:135]
  ds_read_b64_tr_b16 v[46:47], v26
  v_mfma_f32_16x16x32_bf16 v[136:139], v[50:53], a[156:159], v[136:139]
  s_waitcnt lgkmcnt(9)
  ds_read_b64_tr_b16 v[48:49], v26 offset:1280
  v_mfma_f32_16x16x32_bf16 v[140:143], v[54:57], a[64:67], v[140:143]
  ds_read_b64_tr_b16 v[50:51], v26 offset:32
  v_mfma_f32_16x16x32_bf16 v[144:147], v[54:57], a[144:147], v[144:147]
  s_waitcnt lgkmcnt(9)
  ds_read_b64_tr_b16 v[52:53], v26 offset:1312
  buffer_load_dwordx4 v14, s[32:35], s75 offen lds
  ds_write_b128 v8, a[180:183]
  ds_write_b128 v8, a[184:187] offset:1024
  v_mfma_f32_16x16x32_bf16 v[148:151], v[58:61], a[64:67], v[148:151]
  ds_read_b64_tr_b16 v[54:55], v26 offset:64
  s_mul_i32 s75, s77, 0x780
  s_add_u32 s75, s75, s81
  ds_write_b128 v8, a[188:191] offset:2048
  ds_write_b128 v8, a[192:195] offset:3072
  v_mfma_f32_16x16x32_bf16 v[152:155], v[58:61], a[144:147], v[152:155]
  s_waitcnt lgkmcnt(13)
  ds_read_b64_tr_b16 v[56:57], v26 offset:1344
  s_add_u32 s75, s75, 0xa00
  s_add_u32 m0, s74, 0x19000
  ds_write_b128 v8, a[196:199] offset:4096
  v_cvt_pk_bf16_f32 v190, v104, v105
  v_cvt_pk_bf16_f32 v191, v106, v107
  v_mfma_f32_16x16x32_bf16 v[156:159], v[34:37], a[64:67], v[156:159]
  ds_read_b64_tr_b16 v[58:59], v26 offset:96
  v_cvt_pk_bf16_f32 v192, v112, v113
  v_cvt_pk_bf16_f32 v193, v114, v115
  v_mfma_f32_16x16x32_bf16 v[160:163], v[34:37], a[144:147], v[160:163]
  s_waitcnt lgkmcnt(14)
  ds_read_b64_tr_b16 v[60:61], v26 offset:1376
  v_cvt_pk_bf16_f32 v194, v120, v121
  v_cvt_pk_bf16_f32 v195, v122, v123
  v_mfma_f32_16x16x32_bf16 v[164:167], v[38:41], a[64:67], v[164:167]
  ds_read_b64_tr_b16 v[34:35], v26 offset:128
  v_cvt_pk_bf16_f32 v196, v128, v129
  v_cvt_pk_bf16_f32 v197, v130, v131
  v_mfma_f32_16x16x32_bf16 v[168:171], v[38:41], a[144:147], v[168:171]
  s_waitcnt lgkmcnt(14)
  ds_read_b64_tr_b16 v[36:37], v26 offset:1408
  buffer_load_dwordx4 v10, s[32:35], s75 offen lds
  v_cvt_pk_bf16_f32 v198, v136, v137
  v_cvt_pk_bf16_f32 v199, v138, v139
  v_mfma_f32_16x16x32_bf16 v[172:175], v[42:45], a[64:67], v[172:175]
  ds_read_b64_tr_b16 v[38:39], v28
  ds_write_b64 v71, v[190:191]
  ds_write_b64 v71, v[192:193] offset:512
  v_mfma_f32_16x16x32_bf16 v[176:179], v[42:45], a[144:147], v[176:179]
  s_waitcnt lgkmcnt(15)
  ds_read_b64_tr_b16 v[40:41], v28 offset:1280
  ds_write_b64 v71, v[194:195] offset:1024
  ds_write_b64 v71, v[196:197] offset:1536
  v_mfma_f32_16x16x32_bf16 v[140:143], v[46:49], a[68:71], v[140:143]
  ds_read_b64_tr_b16 v[42:43], v28 offset:32
  ds_write_b64 v71, v[198:199] offset:2048
  v_cvt_pk_bf16_f32 v180, v100, v101
  v_cvt_pk_bf16_f32 v181, v102, v103
  v_mfma_f32_16x16x32_bf16 v[144:147], v[46:49], a[148:151], v[144:147]
  s_waitcnt lgkmcnt(15)
  ds_read_b64_tr_b16 v[44:45], v28 offset:1312
  v_cvt_pk_bf16_f32 v200, v100, v101
  v_cvt_pk_bf16_f32 v201, v102, v103
  v_mfma_f32_16x16x32_bf16 v[148:151], v[50:53], a[68:71], v[148:151]
  ds_read_b64_tr_b16 v[46:47], v28 offset:64
  v_cvt_pk_bf16_f32 v182, v108, v109
  v_cvt_pk_bf16_f32 v183, v110, v111
  v_mfma_f32_16x16x32_bf16 v[152:155], v[50:53], a[148:151], v[152:155]
  s_waitcnt lgkmcnt(15)
  ds_read_b64_tr_b16 v[48:49], v28 offset:1344
  buffer_load_dwordx4 v11, s[32:35], s75 offen offset:1024 lds
  v_cvt_pk_bf16_f32 v202, v108, v109
  v_cvt_pk_bf16_f32 v203, v110, v111
  v_mfma_f32_16x16x32_bf16 v[156:159], v[54:57], a[68:71], v[156:159]
  ds_read_b64_tr_b16 v[50:51], v28 offset:96
  v_cvt_pk_bf16_f32 v184, v116, v117
  v_cvt_pk_bf16_f32 v185, v118, v119
  v_mfma_f32_16x16x32_bf16 v[160:163], v[54:57], a[148:151], v[160:163]
  s_waitcnt lgkmcnt(14)
  ds_read_b64_tr_b16 v[52:53], v28 offset:1376
  v_cvt_pk_bf16_f32 v204, v116, v117
  v_cvt_pk_bf16_f32 v205, v118, v119
  v_mfma_f32_16x16x32_bf16 v[164:167], v[58:61], a[68:71], v[164:167]
  ds_read_b64_tr_b16 v[54:55], v28 offset:128
  v_cvt_pk_bf16_f32 v186, v124, v125
  v_cvt_pk_bf16_f32 v187, v126, v127
  v_mfma_f32_16x16x32_bf16 v[168:171], v[58:61], a[148:151], v[168:171]
  s_waitcnt lgkmcnt(14)
  ds_read_b64_tr_b16 v[56:57], v28 offset:1408
  v_cvt_pk_bf16_f32 v206, v124, v125
  v_cvt_pk_bf16_f32 v207, v126, v127
  v_mfma_f32_16x16x32_bf16 v[172:175], v[34:37], a[68:71], v[172:175]
  ds_read_b64_tr_b16 v[58:59], v30
  v_cvt_pk_bf16_f32 v188, v132, v133
  v_cvt_pk_bf16_f32 v189, v134, v135
  v_mfma_f32_16x16x32_bf16 v[176:179], v[34:37], a[148:151], v[176:179]
  s_waitcnt lgkmcnt(12)
  ds_read_b64_tr_b16 v[60:61], v30 offset:1280
  buffer_load_dwordx4 v12, s[32:35], s75 offen offset:2048 lds
  v_cvt_pk_bf16_f32 v208, v132, v133
  v_cvt_pk_bf16_f32 v209, v134, v135
  v_mfma_f32_16x16x32_bf16 v[140:143], v[38:41], a[72:75], v[140:143]
  ds_read_b64_tr_b16 v[34:35], v30 offset:32
  v_cndmask_b32_e64 v210, v190, v180, s[58:59]
  v_cndmask_b32_e64 v211, v191, v181, s[58:59]
  v_mfma_f32_16x16x32_bf16 v[144:147], v[38:41], a[152:155], v[144:147]
  s_waitcnt lgkmcnt(9)
  ds_read_b64_tr_b16 v[36:37], v30 offset:1312
  v_cndmask_b32_e64 v212, v192, v182, s[58:59]
  v_cndmask_b32_e64 v213, v193, v183, s[58:59]
  v_mfma_f32_16x16x32_bf16 v[148:151], v[42:45], a[72:75], v[148:151]
  ds_read_b64_tr_b16 v[38:39], v30 offset:64
  v_cndmask_b32_e64 v214, v194, v184, s[58:59]
  v_cndmask_b32_e64 v215, v195, v185, s[58:59]
  v_mfma_f32_16x16x32_bf16 v[152:155], v[42:45], a[152:155], v[152:155]
  s_waitcnt lgkmcnt(9)
  ds_read_b64_tr_b16 v[40:41], v30 offset:1344
  v_cndmask_b32_e64 v216, v196, v186, s[58:59]
  v_cndmask_b32_e64 v217, v197, v187, s[58:59]
  v_mfma_f32_16x16x32_bf16 v[156:159], v[46:49], a[72:75], v[156:159]
  ds_read_b64_tr_b16 v[42:43], v30 offset:96
  v_cndmask_b32_e64 v218, v198, v188, s[58:59]
  v_cndmask_b32_e64 v219, v199, v189, s[58:59]
  v_mfma_f32_16x16x32_bf16 v[160:163], v[46:49], a[152:155], v[160:163]
  s_waitcnt lgkmcnt(9)
  ds_read_b64_tr_b16 v[44:45], v30 offset:1376
  buffer_load_dwordx4 v13, s[32:35], s75 offen offset:3072 lds
  v_mfma_f32_16x16x32_bf16 v[164:167], v[50:53], a[72:75], v[164:167]
  ds_read_b64_tr_b16 v[46:47], v30 offset:128
  s_add_u32 m0, s74, 0x1a000
  v_mfma_f32_16x16x32_bf16 v[168:171], v[50:53], a[152:155], v[168:171]
  s_waitcnt lgkmcnt(9)
  ds_read_b64_tr_b16 v[48:49], v30 offset:1408
  v_mfma_f32_16x16x32_bf16 v[172:175], v[54:57], a[72:75], v[172:175]
  s_waitcnt vmcnt(4)
  s_barrier
  ds_read_b64_tr_b16 v[50:51], v24 offset:20480
  ds_read_b128 v[16:19], v88
  ds_read_b128 v[20:23], v88 offset:10240
  ds_read_b128 v[100:103], v88 offset:20480
  ds_read_b128 v[104:107], v88 offset:30720
  v_mfma_f32_16x16x32_bf16 v[176:179], v[54:57], a[152:155], v[176:179]
  s_waitcnt lgkmcnt(13)
  ds_read_b64_tr_b16 v[52:53], v24 offset:21760
  v_mfma_f32_16x16x32_bf16 v[140:143], v[58:61], a[76:79], v[140:143]
  ds_read_b64_tr_b16 v[54:55], v24 offset:20512
  v_mfma_f32_16x16x32_bf16 v[144:147], v[58:61], a[156:159], v[144:147]
  s_waitcnt lgkmcnt(13)
  ds_read_b64_tr_b16 v[56:57], v24 offset:21792
  buffer_load_dwordx4 v14, s[32:35], s75 offen lds
  v_mfma_f32_16x16x32_bf16 v[148:151], v[34:37], a[76:79], v[148:151]
  ds_read_b64_tr_b16 v[58:59], v24 offset:20544
  s_mul_i32 s75, s78, 0x780
  s_add_u32 s75, s75, s81
  v_mfma_f32_16x16x32_bf16 v[152:155], v[34:37], a[156:159], v[152:155]
  s_waitcnt lgkmcnt(13)
  ds_read_b64_tr_b16 v[60:61], v24 offset:21824
  s_add_u32 s75, s75, 0xa00
  s_add_u32 m0, s74, 0
  s_waitcnt lgkmcnt(5)
  v_add_f32 v16, v16, v20
  v_add_f32 v17, v17, v21
  v_mfma_f32_16x16x32_bf16 v[156:159], v[38:41], a[76:79], v[156:159]
  ds_read_b64_tr_b16 v[34:35], v24 offset:20576
  v_add_f32 v18, v18, v22
  v_add_f32 v19, v19, v23
  v_mfma_f32_16x16x32_bf16 v[160:163], v[38:41], a[156:159], v[160:163]
  ds_read_b64_tr_b16 v[36:37], v24 offset:21856
  v_add_f32 v100, v100, v104
  v_add_f32 v101, v101, v105
  v_mfma_f32_16x16x32_bf16 v[164:167], v[42:45], a[76:79], v[164:167]
  ds_read_b64_tr_b16 v[38:39], v24 offset:20608
  v_add_f32 v102, v102, v106
  v_add_f32 v103, v103, v107
  v_mfma_f32_16x16x32_bf16 v[168:171], v[42:45], a[156:159], v[168:171]
  ds_read_b64_tr_b16 v[40:41], v24 offset:21888
  buffer_load_dwordx4 v10, s[32:35], s75 offen lds
  v_add_f32 v16, v16, v100
  v_add_f32 v17, v17, v101
  v_mfma_f32_16x16x32_bf16 v[172:175], v[46:49], a[76:79], v[172:175]
  ds_read_b64_tr_b16 v[42:43], v26 offset:20480
  v_add_f32 v18, v18, v102
  v_add_f32 v19, v19, v103
  v_mfma_f32_16x16x32_bf16 v[176:179], v[46:49], a[156:159], v[176:179]
  s_waitcnt lgkmcnt(9)
  ds_read_b64_tr_b16 v[44:45], v26 offset:21760
  v_cvt_pk_bf16_f32 v32, v16, v17
  v_cvt_pk_bf16_f32 v33, v18, v19
  v_mfma_f32_16x16x32_bf16 v[16:19], a[0:3], v[50:53], 0
  ds_read_b64_tr_b16 v[46:47], v26 offset:20512
  ds_write_b64 v91, v[32:33]
  ds_read_b128 v[20:23], v94
  ds_read_b128 v[100:103], v94 offset:10240
  ds_read_b128 v[104:107], v94 offset:20480
  ds_read_b128 v[108:111], v94 offset:30720
  v_mfma_f32_16x16x32_bf16 v[112:115], a[80:83], v[50:53], 0
  ds_read_b64_tr_b16 v[48:49], v26 offset:21792
  v_mfma_f32_16x16x32_bf16 a[180:183], a[160:163], v[50:53], 0
  s_waitcnt lgkmcnt(15)
  v_mfma_f32_16x16x32_bf16 v[116:119], a[0:3], v[54:57], 0
  ds_read_b64_tr_b16 v[50:51], v26 offset:20544
  buffer_load_dwordx4 v11, s[32:35], s75 offen offset:1024 lds
  v_mfma_f32_16x16x32_bf16 v[120:123], a[80:83], v[54:57], 0
  ds_read_b64_tr_b16 v[52:53], v26 offset:21824
  v_mfma_f32_16x16x32_bf16 a[184:187], a[160:163], v[54:57], 0
  s_waitcnt lgkmcnt(15)
  s_waitcnt lgkmcnt(3)
  v_add_f32 v20, v20, v100
  v_add_f32 v21, v21, v101
  v_mfma_f32_16x16x32_bf16 v[124:127], a[0:3], v[58:61], 0
  ds_read_b64_tr_b16 v[54:55], v26 offset:20576
  v_add_f32 v22, v22, v102
  v_add_f32 v23, v23, v103
  v_mfma_f32_16x16x32_bf16 v[128:131], a[80:83], v[58:61], 0
  ds_read_b64_tr_b16 v[56:57], v26 offset:21856
  v_add_f32 v104, v104, v108
  v_add_f32 v105, v105, v109
  v_mfma_f32_16x16x32_bf16 a[188:191], a[160:163], v[58:61], 0
  v_add_f32 v106, v106, v110
  v_add_f32 v107, v107, v111
  v_mfma_f32_16x16x32_bf16 v[132:135], a[0:3], v[34:37], 0
  ds_read_b64_tr_b16 v[58:59], v26 offset:20608
  buffer_load_dwordx4 v12, s[32:35], s75 offen offset:2048 lds
  v_add_f32 v20, v20, v104
  v_add_f32 v21, v21, v105
  v_mfma_f32_16x16x32_bf16 v[136:139], a[80:83], v[34:37], 0
  ds_read_b64_tr_b16 v[60:61], v26 offset:21888
  v_add_f32 v22, v22, v106
  v_add_f32 v23, v23, v107
  v_mfma_f32_16x16x32_bf16 a[192:195], a[160:163], v[34:37], 0
  v_cvt_pk_bf16_f32 v220, v20, v21
  v_cvt_pk_bf16_f32 v221, v22, v23
  v_mfma_f32_16x16x32_bf16 v[20:23], a[0:3], v[38:41], 0
  ds_read_b64_tr_b16 v[34:35], v28 offset:20480
  ds_write_b64 v89, v[220:221] offset:2048
  v_cvt_pk_bf16_f32 v222, v144, v145
  v_cvt_pk_bf16_f32 v223, v146, v147
  v_mfma_f32_16x16x32_bf16 v[102:105], a[80:83], v[38:41], 0
  ds_read_b64_tr_b16 v[36:37], v28 offset:21760
  v_cvt_pk_bf16_f32 v236, v176, v177
  v_cvt_pk_bf16_f32 v237, v178, v179
  v_mfma_f32_16x16x32_bf16 a[196:199], a[160:163], v[38:41], 0
  v_cvt_pk_bf16_f32 v100, v152, v153
  v_cvt_pk_bf16_f32 v101, v154, v155
  v_mfma_f32_16x16x32_bf16 v[16:19], a[4:7], v[42:45], v[16:19]
  ds_read_b64_tr_b16 v[38:39], v28 offset:20512
  buffer_load_dwordx4 v13, s[32:35], s75 offen offset:3072 lds
  v_cndmask_b32_e64 v224, v100, 0, s[52:53]
  v_cndmask_b32_e64 v226, 0, v100, s[52:53]
  v_mfma_f32_16x16x32_bf16 v[112:115], a[84:87], v[42:45], v[112:115]
  s_waitcnt lgkmcnt(10)
  ds_read_b64_tr_b16 v[40:41], v28 offset:21792
  s_add_u32 m0, s74, 0x1000
  v_cndmask_b32_e64 v225, v101, 0, s[52:53]
  v_cndmask_b32_e64 v227, 0, v101, s[52:53]
  v_mfma_f32_16x16x32_bf16 v[116:119], a[4:7], v[46:49], v[116:119]
  ds_read_b64_tr_b16 v[42:43], v28 offset:20544
  v_cvt_pk_bf16_f32 v100, v160, v161
  v_cvt_pk_bf16_f32 v101, v162, v163
  v_mfma_f32_16x16x32_bf16 v[120:123], a[84:87], v[46:49], v[120:123]
  s_waitcnt lgkmcnt(10)
  ds_read_b64_tr_b16 v[44:45], v28 offset:21824
  v_cndmask_b32_e64 v228, v100, 0, s[54:55]
  v_cndmask_b32_e64 v230, 0, v100, s[54:55]
  v_mfma_f32_16x16x32_bf16 v[124:127], a[4:7], v[50:53], v[124:127]
  ds_read_b64_tr_b16 v[46:47], v28 offset:20576
  v_cndmask_b32_e64 v229, v101, 0, s[54:55]
  v_cndmask_b32_e64 v231, 0, v101, s[54:55]
  v_mfma_f32_16x16x32_bf16 v[128:131], a[84:87], v[50:53], v[128:131]
  s_waitcnt lgkmcnt(10)
  ds_read_b64_tr_b16 v[48:49], v28 offset:21856
  v_cvt_pk_bf16_f32 v100, v168, v169
  v_cvt_pk_bf16_f32 v101, v170, v171
  v_mfma_f32_16x16x32_bf16 v[132:135], a[4:7], v[54:57], v[132:135]
  ds_read_b64_tr_b16 v[50:51], v28 offset:20608
  buffer_load_dwordx4 v14, s[32:35], s75 offen lds
  v_cndmask_b32_e64 v232, v100, 0, s[56:57]
  v_cndmask_b32_e64 v234, 0, v100, s[56:57]
  v_mfma_f32_16x16x32_bf16 v[136:139], a[84:87], v[54:57], v[136:139]
  s_waitcnt lgkmcnt(10)
  ds_read_b64_tr_b16 v[52:53], v28 offset:21888
  v_cndmask_b32_e64 v233, v101, 0, s[56:57]
  v_cndmask_b32_e64 v235, 0, v101, s[56:57]
  v_mfma_f32_16x16x32_bf16 v[20:23], a[4:7], v[58:61], v[20:23]
  ds_read_b64_tr_b16 v[54:55], v30 offset:20480
  v_mfma_f32_16x16x32_bf16 v[106:109], v[210:213], v[222:225], v[76:79]
  v_mfma_f32_16x16x32_bf16 v[102:105], a[84:87], v[58:61], v[102:105]
  s_waitcnt lgkmcnt(9)
  ds_read_b64_tr_b16 v[56:57], v30 offset:21760
  v_mfma_f32_16x16x32_bf16 v[144:147], v[190:193], v[222:225], v[80:83]
  v_mfma_f32_16x16x32_bf16 v[16:19], a[8:11], v[34:37], v[16:19]
  ds_read_b64_tr_b16 v[58:59], v30 offset:20512
  v_mfma_f32_16x16x32_bf16 v[152:155], v[212:215], v[226:229], v[76:79]
  v_mfma_f32_16x16x32_bf16 v[112:115], a[88:91], v[34:37], v[112:115]
  s_waitcnt lgkmcnt(9)
  ds_read_b64_tr_b16 v[60:61], v30 offset:21792
  v_mfma_f32_16x16x32_bf16 v[160:163], v[192:195], v[226:229], v[80:83]
  v_mfma_f32_16x16x32_bf16 v[116:119], a[8:11], v[38:41], v[116:119]
  ds_read_b64_tr_b16 v[34:35], v30 offset:20544
  buffer_atomic_add v96, v62, s[44:47], 0 offen sc1
  v_mfma_f32_16x16x32_bf16 v[96:99], v[214:217], v[230:233], v[76:79]
  v_mfma_f32_16x16x32_bf16 v[120:123], a[88:91], v[38:41], v[120:123]
  s_waitcnt lgkmcnt(9)
  ds_read_b64_tr_b16 v[36:37], v30 offset:21824
  s_mul_i32 s75, s79, 0x780
  s_add_u32 s75, s75, s81
  v_mfma_f32_16x16x32_bf16 v[168:171], v[194:197], v[230:233], v[80:83]
  v_mfma_f32_16x16x32_bf16 v[124:127], a[8:11], v[42:45], v[124:127]
  ds_read_b64_tr_b16 v[38:39], v30 offset:20576
  s_add_u32 s75, s75, 0xa00
  s_add_u32 m0, s74, 0x5000
  v_mfma_f32_16x16x32_bf16 v[176:179], v[216:219], v[234:237], v[76:79]
  v_mfma_f32_16x16x32_bf16 v[128:131], a[88:91], v[42:45], v[128:131]
  s_waitcnt lgkmcnt(9)
  ds_read_b64_tr_b16 v[40:41], v30 offset:21856
  v_mfma_f32_16x16x32_bf16 v[238:241], v[196:199], v[234:237], v[80:83]
  v_mfma_f32_16x16x32_bf16 v[132:135], a[8:11], v[46:49], v[132:135]
  ds_read_b64_tr_b16 v[42:43], v30 offset:20608
  v_cvt_pk_bf16_f32 v222, v140, v141
  v_cvt_pk_bf16_f32 v223, v142, v143
  v_mfma_f32_16x16x32_bf16 v[136:139], a[88:91], v[46:49], v[136:139]
  s_waitcnt lgkmcnt(9)
  ds_read_b64_tr_b16 v[44:45], v30 offset:21888
  v_cvt_pk_bf16_f32 v236, v172, v173
  v_cvt_pk_bf16_f32 v237, v174, v175
  v_mfma_f32_16x16x32_bf16 v[20:23], a[8:11], v[50:53], v[20:23]
  s_waitcnt vmcnt(6)
  s_barrier
  ds_read_b64_tr_b16 v[46:47], v24 offset:40960
  buffer_load_dwordx4 v10, s[32:35], s75 offen lds
  v_cvt_pk_bf16_f32 v100, v148, v149
  v_cvt_pk_bf16_f32 v101, v150, v151
  v_mfma_f32_16x16x32_bf16 v[102:105], a[88:91], v[50:53], v[102:105]
  s_waitcnt lgkmcnt(9)
  ds_read_b64_tr_b16 v[48:49], v24 offset:42240
  v_cndmask_b32_e64 v224, v100, 0, s[52:53]
  v_cndmask_b32_e64 v226, 0, v100, s[52:53]
  v_mfma_f32_16x16x32_bf16 v[16:19], a[12:15], v[54:57], v[16:19]
  ds_read_b64_tr_b16 v[50:51], v24 offset:40992
  v_cndmask_b32_e64 v225, v101, 0, s[52:53]
  v_cndmask_b32_e64 v227, 0, v101, s[52:53]
  v_mfma_f32_16x16x32_bf16 v[112:115], a[92:95], v[54:57], v[112:115]
  s_waitcnt lgkmcnt(9)
  ds_read_b64_tr_b16 v[52:53], v24 offset:42272
  v_cvt_pk_bf16_f32 v100, v156, v157
  v_cvt_pk_bf16_f32 v101, v158, v159
  v_mfma_f32_16x16x32_bf16 v[116:119], a[12:15], v[58:61], v[116:119]
  ds_read_b64_tr_b16 v[54:55], v24 offset:41024
  v_cndmask_b32_e64 v228, v100, 0, s[54:55]
  v_cndmask_b32_e64 v230, 0, v100, s[54:55]
  v_mfma_f32_16x16x32_bf16 v[120:123], a[92:95], v[58:61], v[120:123]
  s_waitcnt lgkmcnt(9)
  ds_read_b64_tr_b16 v[56:57], v24 offset:42304
  v_cndmask_b32_e64 v229, v101, 0, s[54:55]
  v_cndmask_b32_e64 v231, 0, v101, s[54:55]
  v_mfma_f32_16x16x32_bf16 v[124:127], a[12:15], v[34:37], v[124:127]
  ds_read_b64_tr_b16 v[58:59], v24 offset:41056
  buffer_load_dwordx4 v11, s[32:35], s75 offen offset:1024 lds
  v_cvt_pk_bf16_f32 v100, v164, v165
  v_cvt_pk_bf16_f32 v101, v166, v167
  v_mfma_f32_16x16x32_bf16 v[128:131], a[92:95], v[34:37], v[128:131]
  s_waitcnt lgkmcnt(9)
  ds_read_b64_tr_b16 v[60:61], v24 offset:42336
  v_cndmask_b32_e64 v232, v100, 0, s[56:57]
  v_cndmask_b32_e64 v234, 0, v100, s[56:57]
  v_mfma_f32_16x16x32_bf16 v[132:135], a[12:15], v[38:41], v[132:135]
  ds_read_b64_tr_b16 v[34:35], v24 offset:41088
  v_cndmask_b32_e64 v233, v101, 0, s[56:57]
  v_cndmask_b32_e64 v235, 0, v101, s[56:57]
  v_mfma_f32_16x16x32_bf16 v[136:139], a[92:95], v[38:41], v[136:139]
  s_waitcnt lgkmcnt(9)
  ds_read_b64_tr_b16 v[36:37], v24 offset:42368
  s_mov_b64 exec, s[58:59]
  ds_read_b64 v[200:201], v93
  ds_read_b64 v[202:203], v93 offset:512
  ds_read_b64 v[204:205], v93 offset:1024
  ds_read_b64 v[206:207], v93 offset:1536
  ds_read_b64 v[208:209], v93 offset:2048
  s_mov_b64 exec, -1
  v_mfma_f32_16x16x32_bf16 v[20:23], a[12:15], v[42:45], v[20:23]
  ds_read_b64_tr_b16 v[38:39], v26 offset:40960
  v_max_f32 v106, v106, v144
  v_max_f32 v107, v107, v145
  v_mfma_f32_16x16x32_bf16 v[102:105], a[92:95], v[42:45], v[102:105]
  s_waitcnt lgkmcnt(14)
  ds_read_b64_tr_b16 v[40:41], v26 offset:42240
  v_max_f32 v108, v108, v146
  v_max_f32 v109, v109, v147
  v_mfma_f32_16x16x32_bf16 v[16:19], a[16:19], v[46:49], v[16:19]
  ds_read_b64_tr_b16 v[42:43], v26 offset:40992
  buffer_load_dwordx4 v12, s[32:35], s75 offen offset:2048 lds
  v_max3_f32 v15, v106, v107, v108
  v_max_f32 v15, v15, v109
  v_mfma_f32_16x16x32_bf16 v[112:115], a[96:99], v[46:49], v[112:115]
  ds_read_b64_tr_b16 v[44:45], v26 offset:42272
  v_max_f32 v152, v152, v160
  v_max_f32 v153, v153, v161
  v_mfma_f32_16x16x32_bf16 a[180:183], a[164:167], v[46:49], a[180:183]
  s_waitcnt lgkmcnt(15)
  v_max_f32 v154, v154, v162
  v_max_f32 v155, v155, v163
  v_mfma_f32_16x16x32_bf16 v[116:119], a[16:19], v[50:53], v[116:119]
  ds_read_b64_tr_b16 v[46:47], v26 offset:41024
  v_max3_f32 v31, v152, v153, v154
  v_max_f32 v31, v31, v155
  v_mfma_f32_16x16x32_bf16 v[120:123], a[96:99], v[50:53], v[120:123]
  ds_read_b64_tr_b16 v[48:49], v26 offset:42304
  v_max_f32 v96, v96, v168
  v_max_f32 v97, v97, v169
  v_mfma_f32_16x16x32_bf16 a[184:187], a[164:167], v[50:53], a[184:187]
  s_waitcnt lgkmcnt(15)
  v_max_f32 v98, v98, v170
  v_max_f32 v99, v99, v171
  v_mfma_f32_16x16x32_bf16 v[124:127], a[16:19], v[54:57], v[124:127]
  ds_read_b64_tr_b16 v[50:51], v26 offset:41056
  buffer_load_dwordx4 v13, s[32:35], s75 offen offset:3072 lds
  v_max3_f32 v32, v96, v97, v98
  v_max_f32 v32, v32, v99
  v_mfma_f32_16x16x32_bf16 v[128:131], a[96:99], v[54:57], v[128:131]
  ds_read_b64_tr_b16 v[52:53], v26 offset:42336
  s_add_u32 m0, s74, 0x6000
  v_max_f32 v176, v176, v238
  v_max_f32 v177, v177, v239
  v_mfma_f32_16x16x32_bf16 a[188:191], a[164:167], v[54:57], a[188:191]
  s_waitcnt lgkmcnt(15)
  v_max_f32 v178, v178, v240
  v_max_f32 v179, v179, v241
  v_mfma_f32_16x16x32_bf16 v[132:135], a[16:19], v[58:61], v[132:135]
  ds_read_b64_tr_b16 v[54:55], v26 offset:41088
  v_max3_f32 v33, v176, v177, v178
  v_max_f32 v33, v33, v179
  v_mfma_f32_16x16x32_bf16 v[136:139], a[96:99], v[58:61], v[136:139]
  ds_read_b64_tr_b16 v[56:57], v26 offset:42368
  v_permlane32_swap_b32 v15, v32
  v_permlane32_swap_b32 v31, v33
  v_mfma_f32_16x16x32_bf16 a[192:195], a[164:167], v[58:61], a[192:195]
  s_waitcnt lgkmcnt(15)
  v_max_f32 v15, v15, v32
  v_max_f32 v31, v31, v33
  v_mfma_f32_16x16x32_bf16 v[20:23], a[16:19], v[34:37], v[20:23]
  ds_read_b64_tr_b16 v[58:59], v28 offset:40960
  buffer_load_dwordx4 v14, s[32:35], s75 offen lds
  v_permlane16_swap_b32 v15, v31
  v_mfma_f32_16x16x32_bf16 v[102:105], a[96:99], v[34:37], v[102:105]
  ds_read_b64_tr_b16 v[60:61], v28 offset:42240
  s_mul_i32 s75, s80, 0x780
  s_add_u32 s75, s75, s81
  v_max_f32 v15, v15, v31
  v_mul_f32_e64 v31, -v15, s98
  v_mul_f32_e64 v15, -v15, s98
  v_mfma_f32_16x16x32_bf16 a[196:199], a[164:167], v[34:37], a[196:199]
  s_waitcnt lgkmcnt(10)
  s_add_u32 s75, s75, 0xa00
  s_add_u32 m0, s74, 0xa000
  v_permlane16_swap_b32 v15, v31
  v_mfma_f32_16x16x32_bf16 v[16:19], a[20:23], v[38:41], v[16:19]
  ds_read_b64_tr_b16 v[34:35], v28 offset:40992
  v_mov_b32 v32, v15
  v_mov_b32 v33, v31
  v_mfma_f32_16x16x32_bf16 v[112:115], a[100:103], v[38:41], v[112:115]
  s_waitcnt lgkmcnt(9)
  ds_read_b64_tr_b16 v[36:37], v28 offset:42272
  v_permlane32_swap_b32 v15, v32
  v_permlane32_swap_b32 v31, v33
  v_mfma_f32_16x16x32_bf16 v[116:119], a[20:23], v[42:45], v[116:119]
  ds_read_b64_tr_b16 v[38:39], v28 offset:41024
  v_mov_b64 v[140:141], 0
  v_mov_b64 v[142:143], 0
  v_mfma_f32_16x16x32_bf16 v[120:123], a[100:103], v[42:45], v[120:123]
  s_waitcnt lgkmcnt(9)
  ds_read_b64_tr_b16 v[40:41], v28 offset:42304
  buffer_load_dwordx4 v10, s[32:35], s75 offen lds
  v_fma_f32 v106, v106, s98, v15
  v_fma_f32 v107, v107, s98, v15
  v_mfma_f32_16x16x32_bf16 v[124:127], a[20:23], v[46:49], v[124:127]
  ds_read_b64_tr_b16 v[42:43], v28 offset:41056
  v_fma_f32 v108, v108, s98, v15
  v_fma_f32 v109, v109, s98, v15
  v_mfma_f32_16x16x32_bf16 v[128:131], a[100:103], v[46:49], v[128:131]
  s_waitcnt lgkmcnt(9)
  ds_read_b64_tr_b16 v[44:45], v28 offset:42336
  v_exp_f32 v106, v106
  v_mfma_f32_16x16x32_bf16 v[132:135], a[20:23], v[50:53], v[132:135]
  ds_read_b64_tr_b16 v[46:47], v28 offset:41088
  v_exp_f32 v107, v107
  v_mfma_f32_16x16x32_bf16 v[136:139], a[100:103], v[50:53], v[136:139]
  s_waitcnt lgkmcnt(9)
  ds_read_b64_tr_b16 v[48:49], v28 offset:42368
  v_exp_f32 v108, v108
  v_mfma_f32_16x16x32_bf16 v[20:23], a[20:23], v[54:57], v[20:23]
  ds_read_b64_tr_b16 v[50:51], v30 offset:40960
  v_exp_f32 v109, v109
  v_mfma_f32_16x16x32_bf16 v[102:105], a[100:103], v[54:57], v[102:105]
  s_waitcnt lgkmcnt(9)
  ds_read_b64_tr_b16 v[52:53], v30 offset:42240
  buffer_load_dwordx4 v11, s[32:35], s75 offen offset:1024 lds
  v_mov_b64 v[144:145], 0
  v_mov_b64 v[146:147], 0
  v_mfma_f32_16x16x32_bf16 v[16:19], a[24:27], v[58:61], v[16:19]
  ds_read_b64_tr_b16 v[54:55], v30 offset:40992
  v_fma_f32 v152, v152, s98, v31
  v_fma_f32 v153, v153, s98, v31
  v_mfma_f32_16x16x32_bf16 v[112:115], a[104:107], v[58:61], v[112:115]
  s_waitcnt lgkmcnt(9)
  ds_read_b64_tr_b16 v[56:57], v30 offset:42272
  v_fma_f32 v154, v154, s98, v31
  v_fma_f32 v155, v155, s98, v31
  v_mfma_f32_16x16x32_bf16 v[116:119], a[24:27], v[34:37], v[116:119]
  ds_read_b64_tr_b16 v[58:59], v30 offset:41024
  v_exp_f32 v152, v152
  v_mfma_f32_16x16x32_bf16 v[120:123], a[104:107], v[34:37], v[120:123]
  s_waitcnt lgkmcnt(9)
  ds_read_b64_tr_b16 v[60:61], v30 offset:42304
  v_exp_f32 v153, v153
  v_mfma_f32_16x16x32_bf16 v[124:127], a[24:27], v[38:41], v[124:127]
  ds_read_b64_tr_b16 v[34:35], v30 offset:41056
  v_exp_f32 v154, v154
  v_mfma_f32_16x16x32_bf16 v[128:131], a[104:107], v[38:41], v[128:131]
  s_waitcnt lgkmcnt(9)
  ds_read_b64_tr_b16 v[36:37], v30 offset:42336
  buffer_load_dwordx4 v12, s[32:35], s75 offen offset:2048 lds
  v_exp_f32 v155, v155
  v_mfma_f32_16x16x32_bf16 v[132:135], a[24:27], v[42:45], v[132:135]
  ds_read_b64_tr_b16 v[38:39], v30 offset:41088
  v_mov_b64 v[148:149], 0
  v_mov_b64 v[150:151], 0
  v_mfma_f32_16x16x32_bf16 v[136:139], a[104:107], v[42:45], v[136:139]
  s_waitcnt lgkmcnt(9)
  ds_read_b64_tr_b16 v[40:41], v30 offset:42368
  v_fma_f32 v96, v96, s98, v32
  v_fma_f32 v97, v97, s98, v32
  v_mfma_f32_16x16x32_bf16 v[20:23], a[24:27], v[46:49], v[20:23]
  s_waitcnt vmcnt(9)
  s_barrier
  ds_read_b64_tr_b16 v[42:43], v9
  v_fma_f32 v98, v98, s98, v32
  v_fma_f32 v99, v99, s98, v32
  v_mfma_f32_16x16x32_bf16 v[102:105], a[104:107], v[46:49], v[102:105]
  s_waitcnt lgkmcnt(9)
  ds_read_b64_tr_b16 v[44:45], v9 offset:1280
  v_exp_f32 v96, v96
  v_mfma_f32_16x16x32_bf16 v[16:19], a[28:31], v[50:53], v[16:19]
  ds_read_b64_tr_b16 v[46:47], v9 offset:32
  v_exp_f32 v97, v97
  v_mfma_f32_16x16x32_bf16 v[112:115], a[108:111], v[50:53], v[112:115]
  s_waitcnt lgkmcnt(9)
  ds_read_b64_tr_b16 v[48:49], v9 offset:1312
  buffer_load_dwordx4 v13, s[32:35], s75 offen offset:3072 lds
  v_exp_f32 v98, v98
  v_mfma_f32_16x16x32_bf16 v[116:119], a[28:31], v[54:57], v[116:119]
  ds_read_b64_tr_b16 v[50:51], v9 offset:64
  s_add_u32 m0, s74, 0xb000
  v_exp_f32 v99, v99
  v_mfma_f32_16x16x32_bf16 v[120:123], a[108:111], v[54:57], v[120:123]
  s_waitcnt lgkmcnt(9)
  ds_read_b64_tr_b16 v[52:53], v9 offset:1344
  v_mov_b64 v[156:157], 0
  v_mov_b64 v[158:159], 0
  v_mfma_f32_16x16x32_bf16 v[124:127], a[28:31], v[58:61], v[124:127]
  ds_read_b64_tr_b16 v[54:55], v9 offset:96
  v_fma_f32 v176, v176, s98, v33
  v_fma_f32 v177, v177, s98, v33
  v_mfma_f32_16x16x32_bf16 v[128:131], a[108:111], v[58:61], v[128:131]
  s_waitcnt lgkmcnt(9)
  ds_read_b64_tr_b16 v[56:57], v9 offset:1376
  v_fma_f32 v178, v178, s98, v33
  v_fma_f32 v179, v179, s98, v33
  v_mfma_f32_16x16x32_bf16 v[132:135], a[28:31], v[34:37], v[132:135]
  ds_read_b64_tr_b16 v[58:59], v9 offset:128
  v_exp_f32 v176, v176
  v_mfma_f32_16x16x32_bf16 v[136:139], a[108:111], v[34:37], v[136:139]
  s_waitcnt lgkmcnt(9)
  ds_read_b64_tr_b16 v[60:61], v9 offset:1408
  buffer_load_dwordx4 v14, s[32:35], s75 offen lds
  v_exp_f32 v177, v177
  v_mfma_f32_16x16x32_bf16 v[20:23], a[28:31], v[38:41], v[20:23]
  ds_read_b64_tr_b16 v[34:35], v25
  v_exp_f32 v178, v178
  v_mfma_f32_16x16x32_bf16 v[102:105], a[108:111], v[38:41], v[102:105]
  s_waitcnt lgkmcnt(9)
  ds_read_b64_tr_b16 v[36:37], v25 offset:1280
  v_exp_f32 v179, v179
  v_mfma_f32_16x16x32_bf16 v[16:19], a[32:35], v[42:45], v[16:19]
  ds_read_b64_tr_b16 v[38:39], v25 offset:32
  v_lshrrev_b32 v15, 1, v1
  v_mul_u32_u24 v15, 0x500, v15
  v_and_b32 v31, 1, v1
  v_mul_u32_u24 v31, 0x9c, v31
  v_add_u32 v15, v15, v31
  s_mul_i32 s93, s22, 0x32000
  s_add_u32 s93, s93, 0x14000
  v_lshrrev_b32 v31, 5, v1
  v_mul_u32_u24 v31, 0x14000, v31
  v_add_u32 v31, v15, v31
  s_mul_i32 s21, s73, 0xa0
  s_add_u32 s93, s93, s21
  buffer_load_dword v32, v31, s[40:43], s93 offen
  v_mfma_f32_16x16x32_bf16 v[160:163], v[200:203], v[222:225], v[72:75]
  v_mfma_f32_16x16x32_bf16 v[112:115], a[112:115], v[42:45], v[112:115]
  ds_read_b64_tr_b16 v[40:41], v25 offset:1312
  v_mfma_f32_16x16x32_bf16 v[164:167], v[180:183], v[222:225], v[80:83]
  v_mfma_f32_16x16x32_bf16 a[180:183], a[168:171], v[42:45], a[180:183]
  s_waitcnt lgkmcnt(10)
  v_mfma_f32_16x16x32_bf16 v[168:171], v[202:205], v[226:229], v[72:75]
  v_mfma_f32_16x16x32_bf16 v[116:119], a[32:35], v[46:49], v[116:119]
  ds_read_b64_tr_b16 v[42:43], v25 offset:64
  v_mfma_f32_16x16x32_bf16 v[172:175], v[182:185], v[226:229], v[80:83]
  v_mfma_f32_16x16x32_bf16 v[120:123], a[112:115], v[46:49], v[120:123]
  ds_read_b64_tr_b16 v[44:45], v25 offset:1344
  v_mfma_f32_16x16x32_bf16 v[190:193], v[204:207], v[230:233], v[72:75]
  v_mfma_f32_16x16x32_bf16 a[184:187], a[168:171], v[46:49], a[184:187]
  s_waitcnt lgkmcnt(10)
  v_mfma_f32_16x16x32_bf16 v[194:197], v[184:187], v[230:233], v[80:83]
  v_mfma_f32_16x16x32_bf16 v[124:127], a[32:35], v[50:53], v[124:127]
  ds_read_b64_tr_b16 v[46:47], v25 offset:96
  v_mfma_f32_16x16x32_bf16 v[210:213], v[206:209], v[234:237], v[72:75]
  v_mfma_f32_16x16x32_bf16 v[128:131], a[112:115], v[50:53], v[128:131]
  ds_read_b64_tr_b16 v[48:49], v25 offset:1376
  s_mul_i32 s90, s22, 0x32000
  s_add_u32 s93, s72, 0
  s_and_b32 s21, s93, 1
  s_mul_i32 s21, s21, 0xa000
  s_add_u32 s90, s90, s21
  s_bfe_u32 s21, s93, 0x10001
  s_mul_i32 s21, s21, 0x19000
  s_add_u32 s90, s90, s21
  s_add_u32 m0, s74, 0xf000
  s_nop 0
  buffer_load_dwordx4 v65, s[40:43], s90 offen lds
  v_mfma_f32_16x16x32_bf16 v[214:217], v[186:189], v[234:237], v[80:83]
  v_mfma_f32_16x16x32_bf16 a[188:191], a[168:171], v[50:53], a[188:191]
  s_waitcnt lgkmcnt(10)
  v_mfma_f32_16x16x32_bf16 v[132:135], a[32:35], v[54:57], v[132:135]
  ds_read_b64_tr_b16 v[50:51], v25 offset:128
  s_mov_b64 exec, s[60:61]
  v_cvt_pk_bf16_f32 v140, v106, v107
  v_cvt_pk_bf16_f32 v141, v108, v109
  v_cvt_pk_bf16_f32 v144, v152, v153
  v_cvt_pk_bf16_f32 v145, v154, v155
  s_mov_b64 exec, s[58:59]
  v_cvt_pk_bf16_f32 v142, v106, v107
  v_cvt_pk_bf16_f32 v143, v108, v109
  v_cvt_pk_bf16_f32 v146, v152, v153
  v_cvt_pk_bf16_f32 v147, v154, v155
  s_mov_b64 exec, -1
  v_mfma_f32_16x16x32_bf16 v[136:139], a[112:115], v[54:57], v[136:139]
  ds_read_b64_tr_b16 v[52:53], v25 offset:1408
  s_mov_b64 exec, s[60:61]
  v_cvt_pk_bf16_f32 v148, v96, v97
  v_cvt_pk_bf16_f32 v149, v98, v99
  v_cvt_pk_bf16_f32 v156, v176, v177
  v_cvt_pk_bf16_f32 v157, v178, v179
  s_mov_b64 exec, s[58:59]
  v_cvt_pk_bf16_f32 v150, v96, v97
  v_cvt_pk_bf16_f32 v151, v98, v99
  v_cvt_pk_bf16_f32 v158, v176, v177
  v_cvt_pk_bf16_f32 v159, v178, v179
  s_mov_b64 exec, -1
  v_mfma_f32_16x16x32_bf16 a[192:195], a[168:171], v[54:57], a[192:195]
  s_waitcnt lgkmcnt(10)
  v_mfma_f32_16x16x32_bf16 v[180:183], v[84:87], v[140:143], 0
  v_mfma_f32_16x16x32_bf16 v[20:23], a[32:35], v[58:61], v[20:23]
  ds_read_b64_tr_b16 v[54:55], v27
  v_mfma_f32_16x16x32_bf16 v[184:187], v[84:87], v[144:147], 0
  v_mfma_f32_16x16x32_bf16 v[102:105], a[112:115], v[58:61], v[102:105]
  ds_read_b64_tr_b16 v[56:57], v27 offset:1280
  v_mfma_f32_16x16x32_bf16 v[198:201], v[84:87], v[148:151], 0
  v_mfma_f32_16x16x32_bf16 a[196:199], a[168:171], v[58:61], a[196:199]
  s_waitcnt lgkmcnt(10)
  buffer_load_dwordx4 v66, s[40:43], s90 offen offset:1024 lds
  v_mfma_f32_16x16x32_bf16 v[202:205], v[84:87], v[156:159], 0
  v_mfma_f32_16x16x32_bf16 v[16:19], a[36:39], v[34:37], v[16:19]
  ds_read_b64_tr_b16 v[58:59], v27 offset:32
  v_mfma_f32_16x16x32_bf16 v[112:115], a[116:119], v[34:37], v[112:115]
  s_waitcnt lgkmcnt(9)
  ds_read_b64_tr_b16 v[60:61], v27 offset:1312
  v_mfma_f32_16x16x32_bf16 v[116:119], a[36:39], v[38:41], v[116:119]
  ds_read_b64_tr_b16 v[34:35], v27 offset:64
  v_rcp_f32 v180, v180
  v_mfma_f32_16x16x32_bf16 v[120:123], a[116:119], v[38:41], v[120:123]
  s_waitcnt lgkmcnt(9)
  ds_read_b64_tr_b16 v[36:37], v27 offset:1344
  v_rcp_f32 v184, v184
  v_mfma_f32_16x16x32_bf16 v[124:127], a[36:39], v[42:45], v[124:127]
  ds_read_b64_tr_b16 v[38:39], v27 offset:96
  v_rcp_f32 v198, v198
  v_mfma_f32_16x16x32_bf16 v[128:131], a[116:119], v[42:45], v[128:131]
  s_waitcnt lgkmcnt(9)
  ds_read_b64_tr_b16 v[40:41], v27 offset:1376
  v_rcp_f32 v202, v202
  v_mfma_f32_16x16x32_bf16 v[132:135], a[36:39], v[46:49], v[132:135]
  ds_read_b64_tr_b16 v[42:43], v27 offset:128
  buffer_load_dwordx4 v67, s[40:43], s90 offen offset:2048 lds
  v_mul_f32 v106, v106, v180
  v_mul_f32 v107, v107, v180
  v_mfma_f32_16x16x32_bf16 v[136:139], a[116:119], v[46:49], v[136:139]
  s_waitcnt lgkmcnt(9)
  ds_read_b64_tr_b16 v[44:45], v27 offset:1408
  v_mul_f32 v108, v108, v180
  v_mul_f32 v109, v109, v180
  v_mfma_f32_16x16x32_bf16 v[20:23], a[36:39], v[50:53], v[20:23]
  ds_read_b64_tr_b16 v[46:47], v29
  v_mul_f32 v152, v152, v184
  v_mul_f32 v153, v153, v184
  v_mfma_f32_16x16x32_bf16 v[102:105], a[116:119], v[50:53], v[102:105]
  s_waitcnt lgkmcnt(9)
  ds_read_b64_tr_b16 v[48:49], v29 offset:1280
  v_mul_f32 v154, v154, v184
  v_mul_f32 v155, v155, v184
  v_mfma_f32_16x16x32_bf16 v[16:19], a[40:43], v[54:57], v[16:19]
  ds_read_b64_tr_b16 v[50:51], v29 offset:32
  v_mul_f32 v96, v96, v198
  v_mul_f32 v97, v97, v198
  v_mfma_f32_16x16x32_bf16 v[112:115], a[120:123], v[54:57], v[112:115]
  s_waitcnt lgkmcnt(9)
  ds_read_b64_tr_b16 v[52:53], v29 offset:1312
  v_mul_f32 v98, v98, v198
  v_mul_f32 v99, v99, v198
  v_mfma_f32_16x16x32_bf16 v[116:119], a[40:43], v[58:61], v[116:119]
  ds_read_b64_tr_b16 v[54:55], v29 offset:64
  v_mul_f32 v176, v176, v202
  v_mul_f32 v177, v177, v202
  v_mfma_f32_16x16x32_bf16 v[120:123], a[120:123], v[58:61], v[120:123]
  s_waitcnt lgkmcnt(9)
  ds_read_b64_tr_b16 v[56:57], v29 offset:1344
  buffer_load_dwordx4 v68, s[40:43], s90 offen offset:3072 lds
  v_mul_f32 v178, v178, v202
  v_mul_f32 v179, v179, v202
  v_mfma_f32_16x16x32_bf16 v[124:127], a[40:43], v[34:37], v[124:127]
  ds_read_b64_tr_b16 v[58:59], v29 offset:96
  s_mov_b64 exec, s[60:61]
  v_cvt_pk_bf16_f32 v140, v106, v107
  v_cvt_pk_bf16_f32 v141, v108, v109
  v_cvt_pk_bf16_f32 v144, v152, v153
  v_cvt_pk_bf16_f32 v145, v154, v155
  s_mov_b64 exec, s[58:59]
  v_cvt_pk_bf16_f32 v142, v106, v107
  v_cvt_pk_bf16_f32 v143, v108, v109
  v_cvt_pk_bf16_f32 v146, v152, v153
  v_cvt_pk_bf16_f32 v147, v154, v155
  s_mov_b64 exec, -1
  v_mfma_f32_16x16x32_bf16 v[128:131], a[120:123], v[34:37], v[128:131]
  s_waitcnt lgkmcnt(9)
  ds_read_b64_tr_b16 v[60:61], v29 offset:1376
  s_mov_b64 exec, s[60:61]
  v_cvt_pk_bf16_f32 v148, v96, v97
  v_cvt_pk_bf16_f32 v149, v98, v99
  v_cvt_pk_bf16_f32 v156, v176, v177
  v_cvt_pk_bf16_f32 v157, v178, v179
  s_mov_b64 exec, s[58:59]
  v_cvt_pk_bf16_f32 v150, v96, v97
  v_cvt_pk_bf16_f32 v151, v98, v99
  v_cvt_pk_bf16_f32 v158, v176, v177
  v_cvt_pk_bf16_f32 v159, v178, v179
  s_mov_b64 exec, -1
  v_mfma_f32_16x16x32_bf16 v[132:135], a[40:43], v[38:41], v[132:135]
  ds_read_b64_tr_b16 v[34:35], v29 offset:128
  v_max_f32 v160, v160, v164
  v_max_f32 v161, v161, v165
  v_mfma_f32_16x16x32_bf16 v[136:139], a[120:123], v[38:41], v[136:139]
  s_waitcnt lgkmcnt(9)
  ds_read_b64_tr_b16 v[36:37], v29 offset:1408
  v_max_f32 v162, v162, v166
  v_max_f32 v163, v163, v167
  v_mfma_f32_16x16x32_bf16 v[20:23], a[40:43], v[42:45], v[20:23]
  s_waitcnt vmcnt(10)
  s_barrier
  ds_read_b64_tr_b16 v[38:39], v9 offset:20480
  v_max3_f32 v15, v160, v161, v162
  v_max_f32 v15, v15, v163
  v_mfma_f32_16x16x32_bf16 v[102:105], a[120:123], v[42:45], v[102:105]
  s_waitcnt lgkmcnt(9)
  ds_read_b64_tr_b16 v[40:41], v9 offset:21760
  v_max_f32 v168, v168, v172
  v_max_f32 v169, v169, v173
  v_mfma_f32_16x16x32_bf16 v[16:19], a[44:47], v[46:49], v[16:19]
  ds_read_b64_tr_b16 v[42:43], v9 offset:20512
  s_add_u32 m0, s74, 0x10000
  s_nop 0
  buffer_load_dwordx4 v69, s[40:43], s90 offen lds
  v_max_f32 v170, v170, v174
  v_max_f32 v171, v171, v175
  v_mfma_f32_16x16x32_bf16 v[112:115], a[124:127], v[46:49], v[112:115]
  s_waitcnt lgkmcnt(9)
  ds_read_b64_tr_b16 v[44:45], v9 offset:21792
  v_max3_f32 v31, v168, v169, v170
  v_max_f32 v31, v31, v171
  v_mfma_f32_16x16x32_bf16 v[116:119], a[44:47], v[50:53], v[116:119]
  ds_read_b64_tr_b16 v[46:47], v9 offset:20544
  v_max_f32 v190, v190, v194
  v_max_f32 v191, v191, v195
  v_mfma_f32_16x16x32_bf16 v[120:123], a[124:127], v[50:53], v[120:123]
  s_waitcnt lgkmcnt(9)
  ds_read_b64_tr_b16 v[48:49], v9 offset:21824
  v_max_f32 v192, v192, v196
  v_max_f32 v193, v193, v197
  v_mfma_f32_16x16x32_bf16 v[124:127], a[44:47], v[54:57], v[124:127]
  ds_read_b64_tr_b16 v[50:51], v9 offset:20576
  v_max3_f32 v33, v190, v191, v192
  v_max_f32 v33, v33, v193
  v_mfma_f32_16x16x32_bf16 v[128:131], a[124:127], v[54:57], v[128:131]
  s_waitcnt lgkmcnt(9)
  ds_read_b64_tr_b16 v[52:53], v9 offset:21856
  v_max_f32 v210, v210, v214
  v_max_f32 v211, v211, v215
  v_mfma_f32_16x16x32_bf16 v[132:135], a[44:47], v[58:61], v[132:135]
  ds_read_b64_tr_b16 v[54:55], v9 offset:20608
  v_max_f32 v212, v212, v216
  v_max_f32 v213, v213, v217
  v_mfma_f32_16x16x32_bf16 v[136:139], a[124:127], v[58:61], v[136:139]
  s_waitcnt lgkmcnt(9)
  ds_read_b64_tr_b16 v[56:57], v9 offset:21888
  s_mul_i32 s90, s22, 0x32000
  s_add_u32 s93, s72, 1
  s_and_b32 s21, s93, 1
  s_mul_i32 s21, s21, 0xa000
  s_add_u32 s90, s90, s21
  s_bfe_u32 s21, s93, 0x10001
  s_mul_i32 s21, s21, 0x19000
  s_add_u32 s90, s90, s21
  s_add_u32 m0, s74, 0x14000
  s_nop 0
  buffer_load_dwordx4 v65, s[40:43], s90 offen lds
  v_max3_f32 v72, v210, v211, v212
  v_max_f32 v72, v72, v213
  v_mfma_f32_16x16x32_bf16 v[20:23], a[44:47], v[34:37], v[20:23]
  ds_read_b64_tr_b16 v[58:59], v25 offset:20480
  v_permlane32_swap_b32 v15, v33
  v_permlane32_swap_b32 v31, v72
  v_mfma_f32_16x16x32_bf16 v[102:105], a[124:127], v[34:37], v[102:105]
  s_waitcnt lgkmcnt(9)
  ds_read_b64_tr_b16 v[60:61], v25 offset:21760
  v_max_f32 v15, v15, v33
  v_max_f32 v31, v31, v72
  v_mfma_f32_16x16x32_bf16 v[16:19], a[48:51], v[38:41], v[16:19]
  ds_read_b64_tr_b16 v[34:35], v25 offset:20512
  v_permlane16_swap_b32 v15, v31
  v_mfma_f32_16x16x32_bf16 v[112:115], a[128:131], v[38:41], v[112:115]
  ds_read_b64_tr_b16 v[36:37], v25 offset:21792
  v_max_f32 v15, v15, v31
  v_mul_f32_e64 v31, -v15, s98
  v_mul_f32_e64 v15, -v15, s98
  v_mfma_f32_16x16x32_bf16 a[180:183], a[172:175], v[38:41], a[180:183]
  s_waitcnt lgkmcnt(10)
  v_permlane16_swap_b32 v15, v31
  v_mfma_f32_16x16x32_bf16 v[116:119], a[48:51], v[42:45], v[116:119]
  ds_read_b64_tr_b16 v[38:39], v25 offset:20544
  v_mov_b32 v33, v15
  v_mov_b32 v72, v31
  v_mfma_f32_16x16x32_bf16 v[120:123], a[128:131], v[42:45], v[120:123]
  ds_read_b64_tr_b16 v[40:41], v25 offset:21824
  buffer_load_dwordx4 v66, s[40:43], s90 offen offset:1024 lds
  v_permlane32_swap_b32 v15, v33
  v_permlane32_swap_b32 v31, v72
  v_mfma_f32_16x16x32_bf16 a[184:187], a[172:175], v[42:45], a[184:187]
  s_waitcnt lgkmcnt(10)
  v_mov_b64 v[74:75], 0
  v_mov_b64 v[76:77], 0
  v_mfma_f32_16x16x32_bf16 v[124:127], a[48:51], v[46:49], v[124:127]
  ds_read_b64_tr_b16 v[42:43], v25 offset:20576
  v_fma_f32 v160, v160, s98, v15
  v_fma_f32 v161, v161, s98, v15
  v_mfma_f32_16x16x32_bf16 v[128:131], a[128:131], v[46:49], v[128:131]
  ds_read_b64_tr_b16 v[44:45], v25 offset:21856
  v_fma_f32 v162, v162, s98, v15
  v_fma_f32 v163, v163, s98, v15
  v_mfma_f32_16x16x32_bf16 a[188:191], a[172:175], v[46:49], a[188:191]
  s_waitcnt lgkmcnt(10)
  v_exp_f32 v160, v160
  v_mfma_f32_16x16x32_bf16 v[132:135], a[48:51], v[50:53], v[132:135]
  ds_read_b64_tr_b16 v[46:47], v25 offset:20608
  v_exp_f32 v161, v161
  v_mfma_f32_16x16x32_bf16 v[136:139], a[128:131], v[50:53], v[136:139]
  ds_read_b64_tr_b16 v[48:49], v25 offset:21888
  v_exp_f32 v162, v162
  v_mfma_f32_16x16x32_bf16 a[192:195], a[172:175], v[50:53], a[192:195]
  s_waitcnt lgkmcnt(10)
  buffer_load_dwordx4 v67, s[40:43], s90 offen offset:2048 lds
  v_exp_f32 v163, v163
  v_mfma_f32_16x16x32_bf16 v[20:23], a[48:51], v[54:57], v[20:23]
  ds_read_b64_tr_b16 v[50:51], v27 offset:20480
  v_mov_b64 v[78:79], 0
  v_mov_b64 v[80:81], 0
  v_mfma_f32_16x16x32_bf16 v[102:105], a[128:131], v[54:57], v[102:105]
  ds_read_b64_tr_b16 v[52:53], v27 offset:21760
  v_fma_f32 v168, v168, s98, v31
  v_fma_f32 v169, v169, s98, v31
  v_mfma_f32_16x16x32_bf16 a[196:199], a[172:175], v[54:57], a[196:199]
  s_waitcnt lgkmcnt(10)
  v_fma_f32 v170, v170, s98, v31
  v_fma_f32 v171, v171, s98, v31
  v_mfma_f32_16x16x32_bf16 v[16:19], a[52:55], v[58:61], v[16:19]
  ds_read_b64_tr_b16 v[54:55], v27 offset:20512
  v_exp_f32 v168, v168
  v_mfma_f32_16x16x32_bf16 v[112:115], a[132:135], v[58:61], v[112:115]
  s_waitcnt lgkmcnt(9)
  ds_read_b64_tr_b16 v[56:57], v27 offset:21792
  v_exp_f32 v169, v169
  v_mfma_f32_16x16x32_bf16 v[116:119], a[52:55], v[34:37], v[116:119]
  ds_read_b64_tr_b16 v[58:59], v27 offset:20544
  v_exp_f32 v170, v170
  v_mfma_f32_16x16x32_bf16 v[120:123], a[132:135], v[34:37], v[120:123]
  s_waitcnt lgkmcnt(9)
  ds_read_b64_tr_b16 v[60:61], v27 offset:21824
  buffer_load_dwordx4 v68, s[40:43], s90 offen offset:3072 lds
  v_exp_f32 v171, v171
  v_mfma_f32_16x16x32_bf16 v[124:127], a[52:55], v[38:41], v[124:127]
  ds_read_b64_tr_b16 v[34:35], v27 offset:20576
  v_mov_b64 v[96:97], 0
  v_mov_b64 v[98:99], 0
  v_mfma_f32_16x16x32_bf16 v[128:131], a[132:135], v[38:41], v[128:131]
  s_waitcnt lgkmcnt(9)
  ds_read_b64_tr_b16 v[36:37], v27 offset:21856
  v_fma_f32 v190, v190, s98, v33
  v_fma_f32 v191, v191, s98, v33
  v_mfma_f32_16x16x32_bf16 v[132:135], a[52:55], v[42:45], v[132:135]
  ds_read_b64_tr_b16 v[38:39], v27 offset:20608
  v_fma_f32 v192, v192, s98, v33
  v_fma_f32 v193, v193, s98, v33
  v_mfma_f32_16x16x32_bf16 v[136:139], a[132:135], v[42:45], v[136:139]
  s_waitcnt lgkmcnt(9)
  ds_read_b64_tr_b16 v[40:41], v27 offset:21888
  v_exp_f32 v190, v190
  v_mfma_f32_16x16x32_bf16 v[20:23], a[52:55], v[46:49], v[20:23]
  ds_read_b64_tr_b16 v[42:43], v29 offset:20480
  v_exp_f32 v191, v191
  v_mfma_f32_16x16x32_bf16 v[102:105], a[132:135], v[46:49], v[102:105]
  s_waitcnt lgkmcnt(9)
  ds_read_b64_tr_b16 v[44:45], v29 offset:21760
  v_exp_f32 v192, v192
  v_mfma_f32_16x16x32_bf16 v[16:19], a[56:59], v[50:53], v[16:19]
  ds_read_b64_tr_b16 v[46:47], v29 offset:20512
  s_add_u32 m0, s74, 0x15000
  s_nop 0
  buffer_load_dwordx4 v69, s[40:43], s90 offen lds
  v_exp_f32 v193, v193
  v_mfma_f32_16x16x32_bf16 v[112:115], a[136:139], v[50:53], v[112:115]
  s_waitcnt lgkmcnt(9)
  ds_read_b64_tr_b16 v[48:49], v29 offset:21792
  v_mov_b64 v[106:107], 0
  v_mov_b64 v[108:109], 0
  v_mfma_f32_16x16x32_bf16 v[116:119], a[56:59], v[54:57], v[116:119]
  ds_read_b64_tr_b16 v[50:51], v29 offset:20544
  v_fma_f32 v210, v210, s98, v72
  v_fma_f32 v211, v211, s98, v72
  v_mfma_f32_16x16x32_bf16 v[120:123], a[136:139], v[54:57], v[120:123]
  s_waitcnt lgkmcnt(9)
  ds_read_b64_tr_b16 v[52:53], v29 offset:21824
  v_fma_f32 v212, v212, s98, v72
  v_fma_f32 v213, v213, s98, v72
  v_mfma_f32_16x16x32_bf16 v[124:127], a[56:59], v[58:61], v[124:127]
  ds_read_b64_tr_b16 v[54:55], v29 offset:20576
  v_exp_f32 v210, v210
  v_mfma_f32_16x16x32_bf16 v[128:131], a[136:139], v[58:61], v[128:131]
  s_waitcnt lgkmcnt(9)
  ds_read_b64_tr_b16 v[56:57], v29 offset:21856
  v_exp_f32 v211, v211
  v_mfma_f32_16x16x32_bf16 v[132:135], a[56:59], v[34:37], v[132:135]
  ds_read_b64_tr_b16 v[58:59], v29 offset:20608
  v_exp_f32 v212, v212
  v_mfma_f32_16x16x32_bf16 v[136:139], a[136:139], v[34:37], v[136:139]
  s_waitcnt lgkmcnt(9)
  ds_read_b64_tr_b16 v[60:61], v29 offset:21888
  s_mul_i32 s90, s22, 0x32000
  s_add_u32 s93, s72, 2
  s_and_b32 s21, s93, 1
  s_mul_i32 s21, s21, 0xa000
  s_add_u32 s90, s90, s21
  s_bfe_u32 s21, s93, 0x10001
  s_mul_i32 s21, s21, 0x19000
  s_add_u32 s90, s90, s21
  s_add_u32 m0, s74, 0x19000
  s_nop 0
  buffer_load_dwordx4 v65, s[40:43], s90 offen lds
  v_exp_f32 v213, v213
  v_mfma_f32_16x16x32_bf16 v[20:23], a[56:59], v[38:41], v[20:23]
  s_waitcnt vmcnt(12)
  s_barrier
  ds_read_b64_tr_b16 v[34:35], v9 offset:40960
  s_mov_b64 exec, s[60:61]
  v_cvt_pk_bf16_f32 v74, v160, v161
  v_cvt_pk_bf16_f32 v75, v162, v163
  v_cvt_pk_bf16_f32 v78, v168, v169
  v_cvt_pk_bf16_f32 v79, v170, v171
  s_mov_b64 exec, s[58:59]
  v_cvt_pk_bf16_f32 v76, v160, v161
  v_cvt_pk_bf16_f32 v77, v162, v163
  v_cvt_pk_bf16_f32 v80, v168, v169
  v_cvt_pk_bf16_f32 v81, v170, v171
  s_mov_b64 exec, -1
  v_mfma_f32_16x16x32_bf16 v[102:105], a[136:139], v[38:41], v[102:105]
  s_waitcnt lgkmcnt(9)
  ds_read_b64_tr_b16 v[36:37], v9 offset:42240
  s_mov_b64 exec, s[60:61]
  v_cvt_pk_bf16_f32 v96, v190, v191
  v_cvt_pk_bf16_f32 v97, v192, v193
  v_cvt_pk_bf16_f32 v106, v210, v211
  v_cvt_pk_bf16_f32 v107, v212, v213
  s_mov_b64 exec, s[58:59]
  v_cvt_pk_bf16_f32 v98, v190, v191
  v_cvt_pk_bf16_f32 v99, v192, v193
  v_cvt_pk_bf16_f32 v108, v210, v211
  v_cvt_pk_bf16_f32 v109, v212, v213
  s_mov_b64 exec, -1
  v_mfma_f32_16x16x32_bf16 v[16:19], a[60:63], v[42:45], v[16:19]
  ds_read_b64_tr_b16 v[38:39], v9 offset:40992
  v_mfma_f32_16x16x32_bf16 v[152:155], v[84:87], v[74:77], 0
  v_mfma_f32_16x16x32_bf16 v[112:115], a[140:143], v[42:45], v[112:115]
  s_waitcnt lgkmcnt(9)
  ds_read_b64_tr_b16 v[40:41], v9 offset:42272
  v_mfma_f32_16x16x32_bf16 v[164:167], v[84:87], v[78:81], 0
  v_mfma_f32_16x16x32_bf16 v[116:119], a[60:63], v[46:49], v[116:119]
  ds_read_b64_tr_b16 v[42:43], v9 offset:41024
  v_mfma_f32_16x16x32_bf16 v[172:175], v[84:87], v[96:99], 0
  v_mfma_f32_16x16x32_bf16 v[120:123], a[140:143], v[46:49], v[120:123]
  s_waitcnt lgkmcnt(9)
  ds_read_b64_tr_b16 v[44:45], v9 offset:42304
  v_mfma_f32_16x16x32_bf16 v[176:179], v[84:87], v[106:109], 0
  v_mfma_f32_16x16x32_bf16 v[124:127], a[60:63], v[50:53], v[124:127]
  ds_read_b64_tr_b16 v[46:47], v9 offset:41056
  buffer_load_dwordx4 v66, s[40:43], s90 offen offset:1024 lds
  v_mfma_f32_16x16x32_bf16 v[128:131], a[140:143], v[50:53], v[128:131]
  s_waitcnt lgkmcnt(9)
  ds_read_b64_tr_b16 v[48:49], v9 offset:42336
  v_mfma_f32_16x16x32_bf16 v[132:135], a[60:63], v[54:57], v[132:135]
  ds_read_b64_tr_b16 v[50:51], v9 offset:41088
  v_rcp_f32 v152, v152
  v_mfma_f32_16x16x32_bf16 v[136:139], a[140:143], v[54:57], v[136:139]
  s_waitcnt lgkmcnt(9)
  ds_read_b64_tr_b16 v[52:53], v9 offset:42368
  v_rcp_f32 v164, v164
  v_mfma_f32_16x16x32_bf16 v[20:23], a[60:63], v[58:61], v[20:23]
  ds_read_b64_tr_b16 v[54:55], v25 offset:40960
  v_rcp_f32 v172, v172
  v_mfma_f32_16x16x32_bf16 v[102:105], a[140:143], v[58:61], v[102:105]
  s_waitcnt lgkmcnt(9)
  ds_read_b64_tr_b16 v[56:57], v25 offset:42240
  v_rcp_f32 v176, v176
  v_mfma_f32_16x16x32_bf16 v[16:19], a[64:67], v[34:37], v[16:19]
  ds_read_b64_tr_b16 v[58:59], v25 offset:40992
  v_mul_f32 v160, v160, v152
  v_mul_f32 v161, v161, v152
  v_mfma_f32_16x16x32_bf16 v[112:115], a[144:147], v[34:37], v[112:115]
  ds_read_b64_tr_b16 v[60:61], v25 offset:42272
  buffer_load_dwordx4 v67, s[40:43], s90 offen offset:2048 lds
  v_mul_f32 v162, v162, v152
  v_mul_f32 v163, v163, v152
  v_mfma_f32_16x16x32_bf16 a[180:183], a[176:179], v[34:37], a[180:183]
  s_waitcnt lgkmcnt(10)
  v_mul_f32 v168, v168, v164
  v_mul_f32 v169, v169, v164
  v_mfma_f32_16x16x32_bf16 v[116:119], a[64:67], v[38:41], v[116:119]
  ds_read_b64_tr_b16 v[34:35], v25 offset:41024
  v_mul_f32 v170, v170, v164
  v_mul_f32 v171, v171, v164
  v_mfma_f32_16x16x32_bf16 v[120:123], a[144:147], v[38:41], v[120:123]
  ds_read_b64_tr_b16 v[36:37], v25 offset:42304
  v_mul_f32 v190, v190, v172
  v_mul_f32 v191, v191, v172
  v_mfma_f32_16x16x32_bf16 a[184:187], a[176:179], v[38:41], a[184:187]
  s_waitcnt lgkmcnt(10)
  v_mul_f32 v192, v192, v172
  v_mul_f32 v193, v193, v172
  v_mfma_f32_16x16x32_bf16 v[124:127], a[64:67], v[42:45], v[124:127]
  ds_read_b64_tr_b16 v[38:39], v25 offset:41056
  v_mul_f32 v210, v210, v176
  v_mul_f32 v211, v211, v176
  v_mfma_f32_16x16x32_bf16 v[128:131], a[144:147], v[42:45], v[128:131]
  ds_read_b64_tr_b16 v[40:41], v25 offset:42336
  v_mul_f32 v212, v212, v176
  v_mul_f32 v213, v213, v176
  v_mfma_f32_16x16x32_bf16 a[188:191], a[176:179], v[42:45], a[188:191]
  s_waitcnt lgkmcnt(10)
  buffer_load_dwordx4 v68, s[40:43], s90 offen offset:3072 lds
  s_mov_b64 exec, s[60:61]
  v_cvt_pk_bf16_f32 v74, v160, v161
  v_cvt_pk_bf16_f32 v75, v162, v163
  v_cvt_pk_bf16_f32 v78, v168, v169
  v_cvt_pk_bf16_f32 v79, v170, v171
  s_mov_b64 exec, s[58:59]
  v_cvt_pk_bf16_f32 v76, v160, v161
  v_cvt_pk_bf16_f32 v77, v162, v163
  v_cvt_pk_bf16_f32 v80, v168, v169
  v_cvt_pk_bf16_f32 v81, v170, v171
  s_mov_b64 exec, -1
  v_mfma_f32_16x16x32_bf16 v[132:135], a[64:67], v[46:49], v[132:135]
  ds_read_b64_tr_b16 v[42:43], v25 offset:41088
  s_mov_b64 exec, s[60:61]
  v_cvt_pk_bf16_f32 v96, v190, v191
  v_cvt_pk_bf16_f32 v97, v192, v193
  v_cvt_pk_bf16_f32 v106, v210, v211
  v_cvt_pk_bf16_f32 v107, v212, v213
  s_mov_b64 exec, s[58:59]
  v_cvt_pk_bf16_f32 v98, v190, v191
  v_cvt_pk_bf16_f32 v99, v192, v193
  v_cvt_pk_bf16_f32 v108, v210, v211
  v_cvt_pk_bf16_f32 v109, v212, v213
  s_mov_b64 exec, -1
  v_mfma_f32_16x16x32_bf16 v[136:139], a[144:147], v[46:49], v[136:139]
  ds_read_b64_tr_b16 v[44:45], v25 offset:42368
  v_mfma_f32_16x16x32_bf16 a[192:195], a[176:179], v[46:49], a[192:195]
  s_waitcnt lgkmcnt(10)
  v_mfma_f32_16x16x32_bf16 v[20:23], a[64:67], v[50:53], v[20:23]
  ds_read_b64_tr_b16 v[46:47], v27 offset:40960
  v_mfma_f32_16x16x32_bf16 v[102:105], a[144:147], v[50:53], v[102:105]
  ds_read_b64_tr_b16 v[48:49], v27 offset:42240
  v_mfma_f32_16x16x32_bf16 a[196:199], a[176:179], v[50:53], a[196:199]
  s_waitcnt lgkmcnt(10)
  v_mfma_f32_16x16x32_bf16 v[16:19], a[68:71], v[54:57], v[16:19]
  ds_read_b64_tr_b16 v[50:51], v27 offset:40992
  s_add_u32 m0, s74, 0x1a000
  s_nop 0
  buffer_load_dwordx4 v69, s[40:43], s90 offen lds
  v_mfma_f32_16x16x32_bf16 v[112:115], a[148:151], v[54:57], v[112:115]
  s_waitcnt lgkmcnt(9)
  ds_read_b64_tr_b16 v[52:53], v27 offset:42272
  buffer_load_dword v64, v63, s[44:47], 0 offen sc1
  ds_write_b128 v8, a[180:183]
  ds_write_b128 v8, a[184:187] offset:1024
  v_mfma_f32_16x16x32_bf16 v[116:119], a[68:71], v[58:61], v[116:119]
  ds_read_b64_tr_b16 v[54:55], v27 offset:41024
  ds_write_b128 v8, a[188:191] offset:2048
  ds_write_b128 v8, a[192:195] offset:3072
  v_mfma_f32_16x16x32_bf16 v[120:123], a[148:151], v[58:61], v[120:123]
  s_waitcnt lgkmcnt(13)
  ds_read_b64_tr_b16 v[56:57], v27 offset:42304
  ds_write_b128 v8, a[196:199] offset:4096
  v_mfma_f32_16x16x32_bf16 v[124:127], a[68:71], v[34:37], v[124:127]
  ds_read_b64_tr_b16 v[58:59], v27 offset:41056
  v_mfma_f32_16x16x32_bf16 v[128:131], a[148:151], v[34:37], v[128:131]
  s_waitcnt lgkmcnt(14)
  ds_read_b64_tr_b16 v[60:61], v27 offset:42336
  v_mfma_f32_16x16x32_bf16 v[132:135], a[68:71], v[38:41], v[132:135]
  ds_read_b64_tr_b16 v[34:35], v27 offset:41088
  s_waitcnt lgkmcnt(9)
  s_waitcnt lgkmcnt(8)
  s_waitcnt lgkmcnt(6)
  s_waitcnt lgkmcnt(5)
  s_waitcnt lgkmcnt(3)
  s_barrier
  v_mfma_f32_16x16x32_bf16 v[136:139], a[148:151], v[38:41], v[136:139]
  ds_read_b64_tr_b16 v[36:37], v27 offset:42368
  s_mul_i32 s90, s22, 0x32000
  s_add_u32 s93, s72, 3
  s_and_b32 s21, s93, 1
  s_mul_i32 s21, s21, 0xa000
  s_add_u32 s90, s90, s21
  s_bfe_u32 s21, s93, 0x10001
  s_mul_i32 s21, s21, 0x19000
  s_add_u32 s90, s90, s21
  s_add_u32 m0, s74, 0
  s_nop 0
  buffer_load_dwordx4 v65, s[40:43], s90 offen lds
  ds_read_b128 v[82:85], v88
  ds_read_b128 v[152:155], v88 offset:10240
  ds_read_b128 v[160:163], v88 offset:20480
  ds_read_b128 v[164:167], v88 offset:30720
  v_mfma_f32_16x16x32_bf16 v[20:23], a[68:71], v[42:45], v[20:23]
  ds_read_b64_tr_b16 v[38:39], v29 offset:40960
  v_mfma_f32_16x16x32_bf16 v[102:105], a[148:151], v[42:45], v[102:105]
  ds_read_b64_tr_b16 v[40:41], v29 offset:42240
  v_mfma_f32_16x16x32_bf16 v[16:19], a[72:75], v[46:49], v[16:19]
  ds_read_b64_tr_b16 v[42:43], v29 offset:40992
  v_mfma_f32_16x16x32_bf16 v[112:115], a[152:155], v[46:49], v[112:115]
  ds_read_b64_tr_b16 v[44:45], v29 offset:42272
  v_mfma_f32_16x16x32_bf16 v[116:119], a[72:75], v[50:53], v[116:119]
  ds_read_b64_tr_b16 v[46:47], v29 offset:41024
  s_waitcnt lgkmcnt(5)
  v_add_f32 v82, v82, v152
  v_add_f32 v83, v83, v153
  v_mfma_f32_16x16x32_bf16 v[120:123], a[152:155], v[50:53], v[120:123]
  ds_read_b64_tr_b16 v[48:49], v29 offset:42304
  v_add_f32 v84, v84, v154
  v_add_f32 v85, v85, v155
  v_mfma_f32_16x16x32_bf16 v[124:127], a[72:75], v[54:57], v[124:127]
  ds_read_b64_tr_b16 v[50:51], v29 offset:41056
  buffer_load_dwordx4 v66, s[40:43], s90 offen offset:1024 lds
  v_add_f32 v160, v160, v164
  v_add_f32 v161, v161, v165
  v_mfma_f32_16x16x32_bf16 v[128:131], a[152:155], v[54:57], v[128:131]
  ds_read_b64_tr_b16 v[52:53], v29 offset:42336
  v_add_f32 v162, v162, v166
  v_add_f32 v163, v163, v167
  v_mfma_f32_16x16x32_bf16 v[132:135], a[72:75], v[58:61], v[132:135]
  ds_read_b64_tr_b16 v[54:55], v29 offset:41088
  v_add_f32 v82, v82, v160
  v_add_f32 v83, v83, v161
  v_mfma_f32_16x16x32_bf16 v[136:139], a[152:155], v[58:61], v[136:139]
  ds_read_b64_tr_b16 v[56:57], v29 offset:42368
  v_add_f32 v84, v84, v162
  v_add_f32 v85, v85, v163
  v_mfma_f32_16x16x32_bf16 v[20:23], a[72:75], v[34:37], v[20:23]
  v_cvt_pk_bf16_f32 v72, v82, v83
  v_cvt_pk_bf16_f32 v73, v84, v85
  v_mfma_f32_16x16x32_bf16 v[102:105], a[152:155], v[34:37], v[102:105]
  s_waitcnt lgkmcnt(8)
  ds_write_b64 v92, v[72:73]
  ds_read_b128 v[82:85], v94
  ds_read_b128 v[152:155], v94 offset:10240
  ds_read_b128 v[160:163], v94 offset:20480
  ds_read_b128 v[164:167], v94 offset:30720
  v_mfma_f32_16x16x32_bf16 v[16:19], a[76:79], v[38:41], v[16:19]
  v_mfma_f32_16x16x32_bf16 v[112:115], a[156:159], v[38:41], v[112:115]
  s_waitcnt lgkmcnt(11)
  buffer_load_dwordx4 v67, s[40:43], s90 offen offset:2048 lds
  v_mfma_f32_16x16x32_bf16 v[116:119], a[76:79], v[42:45], v[116:119]
  v_mfma_f32_16x16x32_bf16 v[120:123], a[156:159], v[42:45], v[120:123]
  s_waitcnt lgkmcnt(9)
  v_mfma_f32_16x16x32_bf16 v[124:127], a[76:79], v[46:49], v[124:127]
  s_waitcnt lgkmcnt(0)
  v_add_f32 v82, v82, v152
  v_add_f32 v83, v83, v153
  v_mfma_f32_16x16x32_bf16 v[128:131], a[156:159], v[46:49], v[128:131]
  v_add_f32 v84, v84, v154
  v_add_f32 v85, v85, v155
  v_mfma_f32_16x16x32_bf16 v[132:135], a[76:79], v[50:53], v[132:135]
  v_add_f32 v160, v160, v164
  v_add_f32 v161, v161, v165
  v_mfma_f32_16x16x32_bf16 v[136:139], a[156:159], v[50:53], v[136:139]
  v_add_f32 v162, v162, v166
  v_add_f32 v163, v163, v167
  v_mfma_f32_16x16x32_bf16 v[20:23], a[76:79], v[54:57], v[20:23]
  buffer_load_dwordx4 v68, s[40:43], s90 offen offset:3072 lds
  v_add_f32 v82, v82, v160
  v_add_f32 v83, v83, v161
  v_mfma_f32_16x16x32_bf16 v[102:105], a[156:159], v[54:57], v[102:105]
  v_add_f32 v84, v84, v162
  v_add_f32 v85, v85, v163
  v_cvt_pk_bf16_f32 v10, v82, v83
  v_cvt_pk_bf16_f32 v11, v84, v85
  ds_write_b64 v90, v[10:11] offset:2048
  v_cvt_pk_bf16_f32 v162, v112, v113
  v_cvt_pk_bf16_f32 v163, v114, v115
  v_cvt_pk_bf16_f32 v166, v120, v121
  v_cvt_pk_bf16_f32 v167, v122, v123
  v_cvt_pk_bf16_f32 v170, v128, v129
  v_cvt_pk_bf16_f32 v171, v130, v131
  v_cvt_pk_bf16_f32 v174, v136, v137
  v_cvt_pk_bf16_f32 v175, v138, v139
  v_cvt_pk_bf16_f32 v178, v102, v103
  v_cvt_pk_bf16_f32 v179, v104, v105
  ds_write_b64 v71, v[162:163]
  ds_write_b64 v71, v[166:167] offset:512
  ds_write_b64 v71, v[170:171] offset:1024
  ds_write_b64 v71, v[174:175] offset:1536
  ds_write_b64 v71, v[178:179] offset:2048
  v_cvt_pk_bf16_f32 v36, v16, v17
  v_cvt_pk_bf16_f32 v37, v18, v19
  v_cvt_pk_bf16_f32 v34, v16, v17
  v_cvt_pk_bf16_f32 v35, v18, v19
  v_cvt_pk_bf16_f32 v40, v116, v117
  v_cvt_pk_bf16_f32 v41, v118, v119
  v_cvt_pk_bf16_f32 v38, v116, v117
  v_cvt_pk_bf16_f32 v39, v118, v119
  v_cvt_pk_bf16_f32 v44, v124, v125
  v_cvt_pk_bf16_f32 v45, v126, v127
  v_cvt_pk_bf16_f32 v42, v124, v125
  v_cvt_pk_bf16_f32 v43, v126, v127
  v_cvt_pk_bf16_f32 v48, v132, v133
  v_cvt_pk_bf16_f32 v49, v134, v135
  v_cvt_pk_bf16_f32 v46, v132, v133
  v_cvt_pk_bf16_f32 v47, v134, v135
  v_cvt_pk_bf16_f32 v52, v20, v21
  v_cvt_pk_bf16_f32 v53, v22, v23
  v_cvt_pk_bf16_f32 v50, v20, v21
  v_cvt_pk_bf16_f32 v51, v22, v23
  s_waitcnt vmcnt(5)
  s_waitcnt lgkmcnt(5)
  s_waitcnt lgkmcnt(4)
  s_waitcnt lgkmcnt(3)
  s_waitcnt lgkmcnt(2)
  s_waitcnt lgkmcnt(1)
  s_waitcnt lgkmcnt(0)
  s_barrier
  s_mov_b64 exec, s[62:63]
  ds_read_b64 v[34:35], v93
  ds_read_b64 v[38:39], v93 offset:512
  ds_read_b64 v[42:43], v93 offset:1024
  ds_read_b64 v[46:47], v93 offset:1536
  ds_read_b64 v[50:51], v93 offset:2048
  s_mov_b64 exec, -1
  v_cndmask_b32_e64 v160, v162, v36, s[62:63]
  v_cndmask_b32_e64 v161, v163, v37, s[62:63]
  v_cndmask_b32_e64 v164, v166, v40, s[62:63]
  v_cndmask_b32_e64 v165, v167, v41, s[62:63]
  v_cndmask_b32_e64 v168, v170, v44, s[62:63]
  v_cndmask_b32_e64 v169, v171, v45, s[62:63]
  v_cndmask_b32_e64 v172, v174, v48, s[62:63]
  v_cndmask_b32_e64 v173, v175, v49, s[62:63]
  v_cndmask_b32_e64 v176, v178, v52, s[62:63]
  v_cndmask_b32_e64 v177, v179, v53, s[62:63]
  v_mfma_f32_16x16x32_bf16 v[10:13], v[160:163], v[140:143], 0
  v_mfma_f32_16x16x32_bf16 v[14:17], v[164:167], v[140:143], 0
  v_mfma_f32_16x16x32_bf16 v[18:21], v[164:167], v[144:147], 0
  v_mfma_f32_16x16x32_bf16 v[22:25], v[168:171], v[144:147], 0
  v_mfma_f32_16x16x32_bf16 v[26:29], v[168:171], v[148:151], 0
  v_mfma_f32_16x16x32_bf16 v[54:57], v[172:175], v[148:151], 0
  v_mfma_f32_16x16x32_bf16 v[58:61], v[172:175], v[156:159], 0
  v_mfma_f32_16x16x32_bf16 v[82:85], v[176:179], v[156:159], 0
  s_waitcnt lgkmcnt(0)
  v_mfma_f32_16x16x32_bf16 v[100:103], v[34:37], v[74:77], 0
  v_mfma_f32_16x16x32_bf16 v[110:113], v[38:41], v[74:77], 0
  v_mfma_f32_16x16x32_bf16 v[114:117], v[38:41], v[78:81], 0
  v_mfma_f32_16x16x32_bf16 v[118:121], v[42:45], v[78:81], 0
  v_mfma_f32_16x16x32_bf16 v[122:125], v[42:45], v[96:99], 0
  v_mfma_f32_16x16x32_bf16 v[126:129], v[46:49], v[96:99], 0
  v_mfma_f32_16x16x32_bf16 v[130:133], v[46:49], v[106:109], 0
  v_mfma_f32_16x16x32_bf16 v[134:137], v[50:53], v[106:109], 0
  v_cvt_pk_bf16_f32 v180, v10, v11
  v_cvt_pk_bf16_f32 v181, v12, v13
  v_cvt_pk_bf16_f32 v30, v14, v15
  v_cvt_pk_bf16_f32 v31, v16, v17
  v_cvt_pk_bf16_f32 v182, v18, v19
  v_cvt_pk_bf16_f32 v183, v20, v21
  v_cndmask_b32_e64 v182, v30, v182, s[52:53]
  v_cndmask_b32_e64 v183, v31, v183, s[52:53]
  v_cvt_pk_bf16_f32 v30, v22, v23
  v_cvt_pk_bf16_f32 v31, v24, v25
  v_cvt_pk_bf16_f32 v184, v26, v27
  v_cvt_pk_bf16_f32 v185, v28, v29
  v_cndmask_b32_e64 v184, v30, v184, s[54:55]
  v_cndmask_b32_e64 v185, v31, v185, s[54:55]
  v_cvt_pk_bf16_f32 v30, v54, v55
  v_cvt_pk_bf16_f32 v31, v56, v57
  v_cvt_pk_bf16_f32 v186, v58, v59
  v_cvt_pk_bf16_f32 v187, v60, v61
  v_cndmask_b32_e64 v186, v30, v186, s[56:57]
  v_cndmask_b32_e64 v187, v31, v187, s[56:57]
  v_cvt_pk_bf16_f32 v188, v82, v83
  v_cvt_pk_bf16_f32 v189, v84, v85
  buffer_store_dwordx4 v[180:183], v6, s[36:39], s95 offen sc1
  buffer_store_dwordx4 v[184:187], v6, s[36:39], s95 offen offset:1024 sc1
  v_lshrrev_b32 v4, 1, v3
  v_lshlrev_b32 v4, 8, v4
  v_lshl_add_u32 v4, v2, 4, v4
  v_and_b32 v5, 1, v3
  v_lshl_add_u32 v9, v5, 3, v4
  buffer_store_dwordx2 v[188:189], v9, s[36:39], s97 offen sc1
  v_cvt_pk_bf16_f32 v190, v100, v101
  v_cvt_pk_bf16_f32 v191, v102, v103
  v_cvt_pk_bf16_f32 v30, v110, v111
  v_cvt_pk_bf16_f32 v31, v112, v113
  v_cvt_pk_bf16_f32 v192, v114, v115
  v_cvt_pk_bf16_f32 v193, v116, v117
  v_cndmask_b32_e64 v192, v30, v192, s[52:53]
  v_cndmask_b32_e64 v193, v31, v193, s[52:53]
  v_cvt_pk_bf16_f32 v30, v118, v119
  v_cvt_pk_bf16_f32 v31, v120, v121
  v_cvt_pk_bf16_f32 v194, v122, v123
  v_cvt_pk_bf16_f32 v195, v124, v125
  v_cndmask_b32_e64 v194, v30, v194, s[54:55]
  v_cndmask_b32_e64 v195, v31, v195, s[54:55]
  v_cvt_pk_bf16_f32 v30, v126, v127
  v_cvt_pk_bf16_f32 v31, v128, v129
  v_cvt_pk_bf16_f32 v196, v130, v131
  v_cvt_pk_bf16_f32 v197, v132, v133
  v_cndmask_b32_e64 v196, v30, v196, s[56:57]
  v_cndmask_b32_e64 v197, v31, v197, s[56:57]
  v_cvt_pk_bf16_f32 v198, v134, v135
  v_cvt_pk_bf16_f32 v199, v136, v137
  buffer_store_dwordx4 v[190:193], v6, s[36:39], s94 offen sc1
  buffer_store_dwordx4 v[194:197], v6, s[36:39], s94 offen offset:1024 sc1
  buffer_store_dwordx2 v[198:199], v9, s[36:39], s96 offen sc1
  s_add_u32 m0, s74, 0x1000
  s_nop 0
  buffer_load_dwordx4 v69, s[40:43], s90 offen lds
  s_mul_i32 s90, s22, 0x32000
  s_add_u32 s90, s90, 0x14000
  s_add_u32 m0, s74, 0x5000
  s_nop 0
  buffer_load_dwordx4 v65, s[40:43], s90 offen lds
  buffer_load_dwordx4 v66, s[40:43], s90 offen offset:1024 lds
  buffer_load_dwordx4 v70, s[40:43], s90 offen offset:2048 lds
  s_add_u32 s90, s90, 0x14000
  buffer_load_dwordx4 v68, s[40:43], s90 offen offset:3072 lds
  s_add_u32 m0, s74, 0x6000
  s_nop 0
  buffer_load_dwordx4 v69, s[40:43], s90 offen lds
  v_lshrrev_b32 v4, 1, v1
  v_mul_u32_u24 v4, 0x1400, v4
  v_and_b32 v5, 1, v1
  v_lshl_add_u32 v4, v5, 9, v4
  v_add_u32 v4, 0x11fc, v4
  v_mov_b32 v12, 0x40000000
  v_cmp_gt_u32 vcc, 8, v1
  s_nop 1
  v_cndmask_b32_e64 v10, v12, v4, vcc
  s_waitcnt vmcnt(16)
  s_mov_b32 s92, 0
L_hsoA_spin:
  v_readfirstlane_b32 s26, v64
  s_nop 2
  s_cmp_ge_u32 s26, 8
  s_nop 0
  s_cbranch_scc1 L_hsoA_done
  s_add_u32 s92, s92, 1
  s_cmp_gt_u32 s92, 0xfa0
  s_cbranch_scc1 L_hsoA_done
  s_sleep 1
  buffer_load_dword v64, v63, s[44:47], 0 offen sc1
  s_waitcnt vmcnt(0)
  s_branch L_hsoA_spin
L_hsoA_done:
  v_mov_b32 v8, -1
  buffer_load_dword v8, v10, s[36:39], s91 offen sc1
  v_lshrrev_b32 v4, 2, v1
  v_mul_u32_u24 v4, 0xa0, v4
  v_and_b32 v5, 3, v1
  s_and_b32 s93, s73, 1
  s_lshl_b32 s93, s93, 5
  s_lshl_b32 s21, s93, 2
  s_sub_u32 s21, 0x80, s21
  v_lshl_add_u32 v62, v5, 3, v4
  v_lshl_add_u32 v4, v5, 4, v4
  v_lshrrev_b32 v5, 1, v5
  v_lshlrev_b32 v5, 3, v5
  v_add3_u32 v13, v4, v5, s93
  v_xor_b32 v31, 8, v13
  v_add_u32 v62, s21, v62
  v_add_u32 v30, 0xf000, v13
  v_add_u32 v33, 0xf000, v31
  v_add_u32 v65, 0xf000, v62
  v_mul_u32_u24 v5, 0x280, v3
  v_add_u32 v90, v5, v13
  v_add_u32 v91, v5, v31
  v_add_u32 v92, v5, v62
  ds_read_b64_tr_b16 v[58:59], v30
  ds_read_b64_tr_b16 v[60:61], v30 offset:2560
  ds_read_b64_tr_b16 v[66:67], v33
  ds_read_b64_tr_b16 v[68:69], v33 offset:2560
  ds_read_b64_tr_b16 v[70:71], v30 offset:64
  ds_read_b64_tr_b16 v[72:73], v30 offset:2624
  ds_read_b64_tr_b16 v[74:75], v33 offset:64
  ds_read_b64_tr_b16 v[76:77], v33 offset:2624
  ds_read_b64_tr_b16 v[78:79], v65
  ds_read_b64_tr_b16 v[80:81], v65 offset:2560
  ds_read_b64_tr_b16 v[82:83], v30 offset:5120
  ds_read_b64_tr_b16 v[84:85], v30 offset:7680
  v_add_u32 v93, 0x1000, v6
  v_add_u32 v94, 0x2000, v6
  v_add_u32 v95, 0x3000, v6
  v_add_u32 v96, 0x4000, v6
  v_add_u32 v97, 0x5000, v6
  v_add_u32 v98, 0x6000, v6
  v_add_u32 v99, 0x7000, v6
  v_add_u32 v100, 0x8000, v6
  v_add_u32 v101, 0x9000, v6
  s_lshl_b32 s26, s72, 7
  s_lshr_b32 s27, s22, 1
  s_lshl_b32 s27, s27, 6
  s_add_u32 s26, s26, s27
  s_and_b32 s27, s22, 1
  s_add_u32 s26, s26, s27
  v_lshl_add_u32 v4, v2, 1, s26
  v_mul_u32_u24 v4, 0xa00, v4
  s_mul_i32 s26, s73, 0xa0
  s_add_u32 s93, s93, s26
  s_add_u32 s21, s21, s26
  v_lshl_add_u32 v5, v3, 4, v4
  v_add_u32 v102, s93, v5
  v_lshl_add_u32 v5, v3, 3, v4
  v_add_u32 v103, s21, v5
  s_mov_b32 s62, 0
  s_mov_b32 s63, 0xffffffff
  s_add_u32 s26, s72, 0
  s_and_b32 s26, s26, 3
  s_lshl_b32 s26, s26, 10
  s_add_u32 s76, s91, s26
  s_add_u32 s26, s72, 1
  s_and_b32 s26, s26, 3
  s_lshl_b32 s26, s26, 10
  s_add_u32 s77, s91, s26
  s_add_u32 s26, s72, 2
  s_and_b32 s26, s26, 3
  s_lshl_b32 s26, s26, 10
  s_add_u32 s78, s91, s26
  s_add_u32 s26, s72, 3
  s_and_b32 s26, s26, 3
  s_lshl_b32 s26, s26, 10
  s_add_u32 s79, s91, s26
  s_add_u32 s80, s91, 0x1000
  s_mov_b32 s92, 0
L_opA:
  v_cmp_eq_u32 vcc, -1, v8
  s_nop 4
  s_cbranch_vccz L_opdA
  s_add_u32 s92, s92, 1
  s_cmp_gt_u32 s92, 0xfa0
  s_cbranch_scc1 L_opdA
  s_sleep 1
  s_and_b32 s26, s92, 3
  s_cbranch_scc1 L_opA
  s_waitcnt vmcnt(40)
  v_cndmask_b32_e64 v11, v12, v10, vcc
  buffer_load_dword v8, v11, s[36:39], s91 offen sc1
  s_nop 0
  s_branch L_opA
L_opdA:
  s_mov_b32 s92, 0
  buffer_load_dwordx4 a[0:3], v6, s[36:39], s76 offen sc1
  buffer_load_dwordx4 a[80:83], v97, s[36:39], s76 offen sc1
  buffer_load_dwordx4 a[20:23], v93, s[36:39], s76 offen offset:1024 sc1
  buffer_load_dwordx4 a[100:103], v98, s[36:39], s76 offen offset:1024 sc1
  buffer_load_dwordx4 a[40:43], v94, s[36:39], s76 offen offset:2048 sc1
  buffer_load_dwordx4 a[120:123], v99, s[36:39], s76 offen offset:2048 sc1
  buffer_load_dwordx4 a[60:63], v95, s[36:39], s76 offen offset:3072 sc1
  buffer_load_dwordx4 a[140:143], v100, s[36:39], s76 offen offset:3072 sc1
  s_mov_b32 s27, 0x14000
  s_waitcnt lgkmcnt(10)
  s_waitcnt vmcnt(7)
  v_mfma_f32_16x16x32_bf16 v[14:17], v[58:61], a[0:3], 0
  ds_read_b64_tr_b16 v[86:87], v33 offset:5120
  buffer_load_dwordx4 a[4:7], v6, s[36:39], s77 offen sc1
  s_waitcnt vmcnt(7)
  v_mfma_f32_16x16x32_bf16 v[38:41], v[58:61], a[80:83], 0
  s_waitcnt lgkmcnt(9)
  ds_read_b64_tr_b16 v[88:89], v33 offset:7680
  v_mfma_f32_16x16x32_bf16 v[18:21], v[66:69], a[0:3], 0
  ds_read_b64_tr_b16 v[58:59], v30 offset:5184
  v_mfma_f32_16x16x32_bf16 v[42:45], v[66:69], a[80:83], 0
  s_waitcnt lgkmcnt(9)
  ds_read_b64_tr_b16 v[60:61], v30 offset:7744
  v_mfma_f32_16x16x32_bf16 v[22:25], v[70:73], a[0:3], 0
  ds_read_b64_tr_b16 v[66:67], v33 offset:5184
  buffer_load_dwordx4 a[84:87], v97, s[36:39], s77 offen sc1
  v_mfma_f32_16x16x32_bf16 v[46:49], v[70:73], a[80:83], 0
  s_waitcnt lgkmcnt(9)
  ds_read_b64_tr_b16 v[68:69], v33 offset:7744
  v_mfma_f32_16x16x32_bf16 v[26:29], v[74:77], a[0:3], 0
  ds_read_b64_tr_b16 v[70:71], v65 offset:5120
  v_mfma_f32_16x16x32_bf16 v[50:53], v[74:77], a[80:83], 0
  s_waitcnt lgkmcnt(9)
  ds_read_b64_tr_b16 v[72:73], v65 offset:7680
  v_mfma_f32_16x16x32_bf16 v[34:37], v[78:81], a[0:3], 0
  ds_read_b64_tr_b16 v[74:75], v30 offset:10240
  v_mfma_f32_16x16x32_bf16 v[54:57], v[78:81], a[80:83], 0
  s_waitcnt lgkmcnt(9)
  ds_read_b64_tr_b16 v[76:77], v30 offset:12800
  s_waitcnt vmcnt(7)
  v_mfma_f32_16x16x32_bf16 v[14:17], v[82:85], a[20:23], v[14:17]
  ds_read_b64_tr_b16 v[78:79], v33 offset:10240
  buffer_load_dwordx4 a[24:27], v93, s[36:39], s77 offen offset:1024 sc1
  s_waitcnt vmcnt(7)
  v_mfma_f32_16x16x32_bf16 v[38:41], v[82:85], a[100:103], v[38:41]
  s_waitcnt lgkmcnt(9)
  ds_read_b64_tr_b16 v[80:81], v33 offset:12800
  v_mfma_f32_16x16x32_bf16 v[18:21], v[86:89], a[20:23], v[18:21]
  ds_read_b64_tr_b16 v[82:83], v30 offset:10304
  v_mfma_f32_16x16x32_bf16 v[42:45], v[86:89], a[100:103], v[42:45]
  s_waitcnt lgkmcnt(9)
  ds_read_b64_tr_b16 v[84:85], v30 offset:12864
  v_mfma_f32_16x16x32_bf16 v[22:25], v[58:61], a[20:23], v[22:25]
  ds_read_b64_tr_b16 v[86:87], v33 offset:10304
  buffer_load_dwordx4 a[104:107], v98, s[36:39], s77 offen offset:1024 sc1
  v_mfma_f32_16x16x32_bf16 v[46:49], v[58:61], a[100:103], v[46:49]
  s_waitcnt lgkmcnt(9)
  ds_read_b64_tr_b16 v[88:89], v33 offset:12864
  v_mfma_f32_16x16x32_bf16 v[26:29], v[66:69], a[20:23], v[26:29]
  ds_read_b64_tr_b16 v[58:59], v65 offset:10240
  v_mfma_f32_16x16x32_bf16 v[50:53], v[66:69], a[100:103], v[50:53]
  s_waitcnt lgkmcnt(9)
  ds_read_b64_tr_b16 v[60:61], v65 offset:12800
  v_mfma_f32_16x16x32_bf16 v[34:37], v[70:73], a[20:23], v[34:37]
  ds_read_b64_tr_b16 v[66:67], v30 offset:15360
  v_mfma_f32_16x16x32_bf16 v[54:57], v[70:73], a[100:103], v[54:57]
  s_waitcnt lgkmcnt(9)
  ds_read_b64_tr_b16 v[68:69], v30 offset:17920
  s_waitcnt vmcnt(7)
  v_mfma_f32_16x16x32_bf16 v[14:17], v[74:77], a[40:43], v[14:17]
  ds_read_b64_tr_b16 v[70:71], v33 offset:15360
  buffer_load_dwordx4 a[44:47], v94, s[36:39], s77 offen offset:2048 sc1
  s_waitcnt vmcnt(7)
  v_mfma_f32_16x16x32_bf16 v[38:41], v[74:77], a[120:123], v[38:41]
  s_waitcnt lgkmcnt(9)
  ds_read_b64_tr_b16 v[72:73], v33 offset:17920
  v_mfma_f32_16x16x32_bf16 v[18:21], v[78:81], a[40:43], v[18:21]
  ds_read_b64_tr_b16 v[74:75], v30 offset:15424
  v_mfma_f32_16x16x32_bf16 v[42:45], v[78:81], a[120:123], v[42:45]
  s_waitcnt lgkmcnt(9)
  ds_read_b64_tr_b16 v[76:77], v30 offset:17984
  v_mfma_f32_16x16x32_bf16 v[22:25], v[82:85], a[40:43], v[22:25]
  ds_read_b64_tr_b16 v[78:79], v33 offset:15424
  buffer_load_dwordx4 a[124:127], v99, s[36:39], s77 offen offset:2048 sc1
  v_mfma_f32_16x16x32_bf16 v[46:49], v[82:85], a[120:123], v[46:49]
  s_waitcnt lgkmcnt(9)
  ds_read_b64_tr_b16 v[80:81], v33 offset:17984
  v_mfma_f32_16x16x32_bf16 v[26:29], v[86:89], a[40:43], v[26:29]
  ds_read_b64_tr_b16 v[82:83], v65 offset:15360
  v_mfma_f32_16x16x32_bf16 v[50:53], v[86:89], a[120:123], v[50:53]
  s_waitcnt lgkmcnt(9)
  ds_read_b64_tr_b16 v[84:85], v65 offset:17920
  v_mfma_f32_16x16x32_bf16 v[34:37], v[58:61], a[40:43], v[34:37]
  ds_read_b64_tr_b16 v[86:87], v30 offset:20480
  v_mfma_f32_16x16x32_bf16 v[54:57], v[58:61], a[120:123], v[54:57]
  s_waitcnt lgkmcnt(9)
  ds_read_b64_tr_b16 v[88:89], v30 offset:23040
  s_waitcnt vmcnt(7)
  v_mfma_f32_16x16x32_bf16 v[14:17], v[66:69], a[60:63], v[14:17]
  ds_read_b64_tr_b16 v[58:59], v33 offset:20480
  buffer_load_dwordx4 a[64:67], v95, s[36:39], s77 offen offset:3072 sc1
  s_waitcnt vmcnt(7)
  v_mfma_f32_16x16x32_bf16 v[38:41], v[66:69], a[140:143], v[38:41]
  s_waitcnt lgkmcnt(9)
  ds_read_b64_tr_b16 v[60:61], v33 offset:23040
  v_mfma_f32_16x16x32_bf16 v[18:21], v[70:73], a[60:63], v[18:21]
  ds_read_b64_tr_b16 v[66:67], v30 offset:20544
  v_mfma_f32_16x16x32_bf16 v[42:45], v[70:73], a[140:143], v[42:45]
  s_waitcnt lgkmcnt(9)
  ds_read_b64_tr_b16 v[68:69], v30 offset:23104
  v_mfma_f32_16x16x32_bf16 v[22:25], v[74:77], a[60:63], v[22:25]
  ds_read_b64_tr_b16 v[70:71], v33 offset:20544
  buffer_load_dwordx4 a[144:147], v100, s[36:39], s77 offen offset:3072 sc1
  v_mfma_f32_16x16x32_bf16 v[46:49], v[74:77], a[140:143], v[46:49]
  s_waitcnt lgkmcnt(9)
  ds_read_b64_tr_b16 v[72:73], v33 offset:23104
  v_mfma_f32_16x16x32_bf16 v[26:29], v[78:81], a[60:63], v[26:29]
  ds_read_b64_tr_b16 v[74:75], v65 offset:20480
  v_mfma_f32_16x16x32_bf16 v[50:53], v[78:81], a[140:143], v[50:53]
  s_waitcnt lgkmcnt(9)
  ds_read_b64_tr_b16 v[76:77], v65 offset:23040
  v_mfma_f32_16x16x32_bf16 v[34:37], v[82:85], a[60:63], v[34:37]
  ds_read_b64_tr_b16 v[78:79], v30 offset:25600
  v_mfma_f32_16x16x32_bf16 v[54:57], v[82:85], a[140:143], v[54:57]
  s_waitcnt lgkmcnt(9)
  ds_read_b64_tr_b16 v[80:81], v30 offset:28160
  s_waitcnt vmcnt(7)
  v_mfma_f32_16x16x32_bf16 v[14:17], v[86:89], a[4:7], v[14:17]
  ds_read_b64_tr_b16 v[82:83], v33 offset:25600
  buffer_load_dwordx4 a[8:11], v6, s[36:39], s78 offen sc1
  s_waitcnt vmcnt(7)
  v_mfma_f32_16x16x32_bf16 v[38:41], v[86:89], a[84:87], v[38:41]
  s_waitcnt lgkmcnt(9)
  ds_read_b64_tr_b16 v[84:85], v33 offset:28160
  v_mfma_f32_16x16x32_bf16 v[18:21], v[58:61], a[4:7], v[18:21]
  ds_read_b64_tr_b16 v[86:87], v30 offset:25664
  v_mfma_f32_16x16x32_bf16 v[42:45], v[58:61], a[84:87], v[42:45]
  s_waitcnt lgkmcnt(9)
  ds_read_b64_tr_b16 v[88:89], v30 offset:28224
  v_mfma_f32_16x16x32_bf16 v[22:25], v[66:69], a[4:7], v[22:25]
  ds_read_b64_tr_b16 v[58:59], v33 offset:25664
  buffer_load_dwordx4 a[88:91], v97, s[36:39], s78 offen sc1
  v_mfma_f32_16x16x32_bf16 v[46:49], v[66:69], a[84:87], v[46:49]
  s_waitcnt lgkmcnt(9)
  ds_read_b64_tr_b16 v[60:61], v33 offset:28224
  v_mfma_f32_16x16x32_bf16 v[26:29], v[70:73], a[4:7], v[26:29]
  ds_read_b64_tr_b16 v[66:67], v65 offset:25600
  v_mfma_f32_16x16x32_bf16 v[50:53], v[70:73], a[84:87], v[50:53]
  s_waitcnt lgkmcnt(9)
  ds_read_b64_tr_b16 v[68:69], v65 offset:28160
  v_mfma_f32_16x16x32_bf16 v[34:37], v[74:77], a[4:7], v[34:37]
  ds_read_b64_tr_b16 v[70:71], v30 offset:30720
  v_mfma_f32_16x16x32_bf16 v[54:57], v[74:77], a[84:87], v[54:57]
  s_waitcnt lgkmcnt(9)
  ds_read_b64_tr_b16 v[72:73], v30 offset:33280
  s_waitcnt vmcnt(7)
  v_mfma_f32_16x16x32_bf16 v[14:17], v[78:81], a[24:27], v[14:17]
  ds_read_b64_tr_b16 v[74:75], v33 offset:30720
  buffer_load_dwordx4 a[28:31], v93, s[36:39], s78 offen offset:1024 sc1
  s_waitcnt vmcnt(7)
  v_mfma_f32_16x16x32_bf16 v[38:41], v[78:81], a[104:107], v[38:41]
  s_waitcnt lgkmcnt(9)
  ds_read_b64_tr_b16 v[76:77], v33 offset:33280
  v_mfma_f32_16x16x32_bf16 v[18:21], v[82:85], a[24:27], v[18:21]
  ds_read_b64_tr_b16 v[78:79], v30 offset:30784
  v_mfma_f32_16x16x32_bf16 v[42:45], v[82:85], a[104:107], v[42:45]
  s_waitcnt lgkmcnt(9)
  ds_read_b64_tr_b16 v[80:81], v30 offset:33344
  v_mfma_f32_16x16x32_bf16 v[22:25], v[86:89], a[24:27], v[22:25]
  ds_read_b64_tr_b16 v[82:83], v33 offset:30784
  buffer_load_dwordx4 a[108:111], v98, s[36:39], s78 offen offset:1024 sc1
  v_mfma_f32_16x16x32_bf16 v[46:49], v[86:89], a[104:107], v[46:49]
  s_waitcnt lgkmcnt(9)
  ds_read_b64_tr_b16 v[84:85], v33 offset:33344
  v_mfma_f32_16x16x32_bf16 v[26:29], v[58:61], a[24:27], v[26:29]
  ds_read_b64_tr_b16 v[86:87], v65 offset:30720
  v_mfma_f32_16x16x32_bf16 v[50:53], v[58:61], a[104:107], v[50:53]
  s_waitcnt lgkmcnt(9)
  ds_read_b64_tr_b16 v[88:89], v65 offset:33280
  v_mfma_f32_16x16x32_bf16 v[34:37], v[66:69], a[24:27], v[34:37]
  ds_read_b64_tr_b16 v[58:59], v30 offset:35840
  v_mfma_f32_16x16x32_bf16 v[54:57], v[66:69], a[104:107], v[54:57]
  s_waitcnt lgkmcnt(9)
  ds_read_b64_tr_b16 v[60:61], v30 offset:38400
  s_waitcnt vmcnt(7)
  v_mfma_f32_16x16x32_bf16 v[14:17], v[70:73], a[44:47], v[14:17]
  ds_read_b64_tr_b16 v[66:67], v33 offset:35840
  buffer_load_dwordx4 a[48:51], v94, s[36:39], s78 offen offset:2048 sc1
  s_waitcnt vmcnt(7)
  v_mfma_f32_16x16x32_bf16 v[38:41], v[70:73], a[124:127], v[38:41]
  s_waitcnt lgkmcnt(9)
  ds_read_b64_tr_b16 v[68:69], v33 offset:38400
  v_mfma_f32_16x16x32_bf16 v[18:21], v[74:77], a[44:47], v[18:21]
  ds_read_b64_tr_b16 v[70:71], v30 offset:35904
  v_mfma_f32_16x16x32_bf16 v[42:45], v[74:77], a[124:127], v[42:45]
  s_waitcnt lgkmcnt(9)
  ds_read_b64_tr_b16 v[72:73], v30 offset:38464
  v_mfma_f32_16x16x32_bf16 v[22:25], v[78:81], a[44:47], v[22:25]
  ds_read_b64_tr_b16 v[74:75], v33 offset:35904
  buffer_load_dwordx4 a[128:131], v99, s[36:39], s78 offen offset:2048 sc1
  v_mfma_f32_16x16x32_bf16 v[46:49], v[78:81], a[124:127], v[46:49]
  s_waitcnt lgkmcnt(9)
  ds_read_b64_tr_b16 v[76:77], v33 offset:38464
  v_mfma_f32_16x16x32_bf16 v[26:29], v[82:85], a[44:47], v[26:29]
  ds_read_b64_tr_b16 v[78:79], v65 offset:35840
  v_mfma_f32_16x16x32_bf16 v[50:53], v[82:85], a[124:127], v[50:53]
  s_waitcnt lgkmcnt(9)
  ds_read_b64_tr_b16 v[80:81], v65 offset:38400
  v_mfma_f32_16x16x32_bf16 v[34:37], v[86:89], a[44:47], v[34:37]
  ds_read_b64_tr_b16 v[82:83], v30 offset:40960
  v_mfma_f32_16x16x32_bf16 v[54:57], v[86:89], a[124:127], v[54:57]
  s_waitcnt lgkmcnt(9)
  ds_read_b64_tr_b16 v[84:85], v30 offset:43520
  s_waitcnt vmcnt(7)
  v_mfma_f32_16x16x32_bf16 v[14:17], v[58:61], a[64:67], v[14:17]
  ds_read_b64_tr_b16 v[86:87], v33 offset:40960
  buffer_load_dwordx4 a[68:71], v95, s[36:39], s78 offen offset:3072 sc1
  s_waitcnt vmcnt(7)
  v_mfma_f32_16x16x32_bf16 v[38:41], v[58:61], a[144:147], v[38:41]
  s_waitcnt lgkmcnt(9)
  ds_read_b64_tr_b16 v[88:89], v33 offset:43520
  v_mfma_f32_16x16x32_bf16 v[18:21], v[66:69], a[64:67], v[18:21]
  ds_read_b64_tr_b16 v[58:59], v30 offset:41024
  v_mfma_f32_16x16x32_bf16 v[42:45], v[66:69], a[144:147], v[42:45]
  s_waitcnt lgkmcnt(9)
  ds_read_b64_tr_b16 v[60:61], v30 offset:43584
  v_mfma_f32_16x16x32_bf16 v[22:25], v[70:73], a[64:67], v[22:25]
  ds_read_b64_tr_b16 v[66:67], v33 offset:41024
  buffer_load_dwordx4 a[148:151], v100, s[36:39], s78 offen offset:3072 sc1
  v_mfma_f32_16x16x32_bf16 v[46:49], v[70:73], a[144:147], v[46:49]
  s_waitcnt lgkmcnt(9)
  ds_read_b64_tr_b16 v[68:69], v33 offset:43584
  v_mfma_f32_16x16x32_bf16 v[26:29], v[74:77], a[64:67], v[26:29]
  ds_read_b64_tr_b16 v[70:71], v65 offset:40960
  v_mfma_f32_16x16x32_bf16 v[50:53], v[74:77], a[144:147], v[50:53]
  s_waitcnt lgkmcnt(9)
  ds_read_b64_tr_b16 v[72:73], v65 offset:43520
  v_mfma_f32_16x16x32_bf16 v[34:37], v[78:81], a[64:67], v[34:37]
  ds_read_b64_tr_b16 v[74:75], v30 offset:46080
  v_mfma_f32_16x16x32_bf16 v[54:57], v[78:81], a[144:147], v[54:57]
  s_waitcnt lgkmcnt(9)
  ds_read_b64_tr_b16 v[76:77], v30 offset:48640
  s_waitcnt vmcnt(7)
  v_mfma_f32_16x16x32_bf16 v[14:17], v[82:85], a[8:11], v[14:17]
  ds_read_b64_tr_b16 v[78:79], v33 offset:46080
  buffer_load_dwordx4 a[12:15], v6, s[36:39], s79 offen sc1
  s_waitcnt vmcnt(7)
  v_mfma_f32_16x16x32_bf16 v[38:41], v[82:85], a[88:91], v[38:41]
  s_waitcnt lgkmcnt(9)
  ds_read_b64_tr_b16 v[80:81], v33 offset:48640
  v_mfma_f32_16x16x32_bf16 v[18:21], v[86:89], a[8:11], v[18:21]
  ds_read_b64_tr_b16 v[82:83], v30 offset:46144
  v_mfma_f32_16x16x32_bf16 v[42:45], v[86:89], a[88:91], v[42:45]
  s_waitcnt lgkmcnt(9)
  ds_read_b64_tr_b16 v[84:85], v30 offset:48704
  v_mfma_f32_16x16x32_bf16 v[22:25], v[58:61], a[8:11], v[22:25]
  ds_read_b64_tr_b16 v[86:87], v33 offset:46144
  buffer_load_dwordx4 a[92:95], v97, s[36:39], s79 offen sc1
  v_mfma_f32_16x16x32_bf16 v[46:49], v[58:61], a[88:91], v[46:49]
  s_waitcnt lgkmcnt(9)
  ds_read_b64_tr_b16 v[88:89], v33 offset:48704
  v_mfma_f32_16x16x32_bf16 v[26:29], v[66:69], a[8:11], v[26:29]
  ds_read_b64_tr_b16 v[58:59], v65 offset:46080
  v_mfma_f32_16x16x32_bf16 v[50:53], v[66:69], a[88:91], v[50:53]
  s_waitcnt lgkmcnt(9)
  ds_read_b64_tr_b16 v[60:61], v65 offset:48640
  v_mfma_f32_16x16x32_bf16 v[34:37], v[70:73], a[8:11], v[34:37]
  ds_read_b64_tr_b16 v[66:67], v30 offset:51200
  v_mfma_f32_16x16x32_bf16 v[54:57], v[70:73], a[88:91], v[54:57]
  s_waitcnt lgkmcnt(9)
  ds_read_b64_tr_b16 v[68:69], v30 offset:53760
  s_waitcnt vmcnt(7)
  v_mfma_f32_16x16x32_bf16 v[14:17], v[74:77], a[28:31], v[14:17]
  ds_read_b64_tr_b16 v[70:71], v33 offset:51200
  buffer_load_dwordx4 a[32:35], v93, s[36:39], s79 offen offset:1024 sc1
  s_waitcnt vmcnt(7)
  v_mfma_f32_16x16x32_bf16 v[38:41], v[74:77], a[108:111], v[38:41]
  s_waitcnt lgkmcnt(9)
  ds_read_b64_tr_b16 v[72:73], v33 offset:53760
  v_mfma_f32_16x16x32_bf16 v[18:21], v[78:81], a[28:31], v[18:21]
  ds_read_b64_tr_b16 v[74:75], v30 offset:51264
  v_mfma_f32_16x16x32_bf16 v[42:45], v[78:81], a[108:111], v[42:45]
  s_waitcnt lgkmcnt(9)
  ds_read_b64_tr_b16 v[76:77], v30 offset:53824
  v_mfma_f32_16x16x32_bf16 v[22:25], v[82:85], a[28:31], v[22:25]
  ds_read_b64_tr_b16 v[78:79], v33 offset:51264
  buffer_load_dwordx4 a[112:115], v98, s[36:39], s79 offen offset:1024 sc1
  v_mfma_f32_16x16x32_bf16 v[46:49], v[82:85], a[108:111], v[46:49]
  s_waitcnt lgkmcnt(9)
  ds_read_b64_tr_b16 v[80:81], v33 offset:53824
  v_mfma_f32_16x16x32_bf16 v[26:29], v[86:89], a[28:31], v[26:29]
  ds_read_b64_tr_b16 v[82:83], v65 offset:51200
  v_mfma_f32_16x16x32_bf16 v[50:53], v[86:89], a[108:111], v[50:53]
  s_waitcnt lgkmcnt(9)
  ds_read_b64_tr_b16 v[84:85], v65 offset:53760
  v_mfma_f32_16x16x32_bf16 v[34:37], v[58:61], a[28:31], v[34:37]
  ds_read_b64_tr_b16 v[86:87], v30 offset:56320
  v_mfma_f32_16x16x32_bf16 v[54:57], v[58:61], a[108:111], v[54:57]
  s_waitcnt lgkmcnt(9)
  ds_read_b64_tr_b16 v[88:89], v30 offset:58880
  s_waitcnt vmcnt(7)
  v_mfma_f32_16x16x32_bf16 v[14:17], v[66:69], a[48:51], v[14:17]
  ds_read_b64_tr_b16 v[58:59], v33 offset:56320
  buffer_load_dwordx4 a[52:55], v94, s[36:39], s79 offen offset:2048 sc1
  s_waitcnt vmcnt(7)
  v_mfma_f32_16x16x32_bf16 v[38:41], v[66:69], a[128:131], v[38:41]
  s_waitcnt lgkmcnt(9)
  ds_read_b64_tr_b16 v[60:61], v33 offset:58880
  v_mfma_f32_16x16x32_bf16 v[18:21], v[70:73], a[48:51], v[18:21]
  ds_read_b64_tr_b16 v[66:67], v30 offset:56384
  v_mfma_f32_16x16x32_bf16 v[42:45], v[70:73], a[128:131], v[42:45]
  s_waitcnt lgkmcnt(9)
  ds_read_b64_tr_b16 v[68:69], v30 offset:58944
  v_mfma_f32_16x16x32_bf16 v[22:25], v[74:77], a[48:51], v[22:25]
  ds_read_b64_tr_b16 v[70:71], v33 offset:56384
  buffer_load_dwordx4 a[132:135], v99, s[36:39], s79 offen offset:2048 sc1
  v_mfma_f32_16x16x32_bf16 v[46:49], v[74:77], a[128:131], v[46:49]
  s_waitcnt lgkmcnt(9)
  ds_read_b64_tr_b16 v[72:73], v33 offset:58944
  v_mfma_f32_16x16x32_bf16 v[26:29], v[78:81], a[48:51], v[26:29]
  ds_read_b64_tr_b16 v[74:75], v65 offset:56320
  v_mfma_f32_16x16x32_bf16 v[50:53], v[78:81], a[128:131], v[50:53]
  s_waitcnt lgkmcnt(9)
  ds_read_b64_tr_b16 v[76:77], v65 offset:58880
  v_mfma_f32_16x16x32_bf16 v[34:37], v[82:85], a[48:51], v[34:37]
  s_barrier
  ds_read_b64_tr_b16 v[78:79], v13
  v_mfma_f32_16x16x32_bf16 v[54:57], v[82:85], a[128:131], v[54:57]
  s_waitcnt lgkmcnt(9)
  ds_read_b64_tr_b16 v[80:81], v13 offset:2560
  s_waitcnt vmcnt(7)
  v_mfma_f32_16x16x32_bf16 v[14:17], v[86:89], a[68:71], v[14:17]
  ds_read_b64_tr_b16 v[82:83], v31
  buffer_load_dwordx4 a[72:75], v95, s[36:39], s79 offen offset:3072 sc1
  s_waitcnt vmcnt(7)
  v_mfma_f32_16x16x32_bf16 v[38:41], v[86:89], a[148:151], v[38:41]
  s_waitcnt lgkmcnt(9)
  ds_read_b64_tr_b16 v[84:85], v31 offset:2560
  v_mfma_f32_16x16x32_bf16 v[18:21], v[58:61], a[68:71], v[18:21]
  ds_read_b64_tr_b16 v[86:87], v13 offset:64
  v_mfma_f32_16x16x32_bf16 v[42:45], v[58:61], a[148:151], v[42:45]
  s_waitcnt lgkmcnt(9)
  ds_read_b64_tr_b16 v[88:89], v13 offset:2624
  v_mfma_f32_16x16x32_bf16 v[22:25], v[66:69], a[68:71], v[22:25]
  ds_read_b64_tr_b16 v[58:59], v31 offset:64
  buffer_load_dwordx4 a[152:155], v100, s[36:39], s79 offen offset:3072 sc1
  v_mfma_f32_16x16x32_bf16 v[46:49], v[66:69], a[148:151], v[46:49]
  s_waitcnt lgkmcnt(9)
  ds_read_b64_tr_b16 v[60:61], v31 offset:2624
  v_mfma_f32_16x16x32_bf16 v[26:29], v[70:73], a[68:71], v[26:29]
  ds_read_b64_tr_b16 v[66:67], v62
  v_mfma_f32_16x16x32_bf16 v[50:53], v[70:73], a[148:151], v[50:53]
  s_waitcnt lgkmcnt(9)
  ds_read_b64_tr_b16 v[68:69], v62 offset:2560
  v_mfma_f32_16x16x32_bf16 v[34:37], v[74:77], a[68:71], v[34:37]
  ds_read_b64_tr_b16 v[70:71], v13 offset:5120
  v_mfma_f32_16x16x32_bf16 v[54:57], v[74:77], a[148:151], v[54:57]
  s_waitcnt lgkmcnt(9)
  ds_read_b64_tr_b16 v[72:73], v13 offset:7680
  s_waitcnt vmcnt(7)
  v_mfma_f32_16x16x32_bf16 v[14:17], v[78:81], a[12:15], v[14:17]
  ds_read_b64_tr_b16 v[74:75], v31 offset:5120
  buffer_load_dwordx4 a[16:19], v6, s[36:39], s80 offen sc1
  s_waitcnt vmcnt(7)
  v_mfma_f32_16x16x32_bf16 v[38:41], v[78:81], a[92:95], v[38:41]
  s_waitcnt lgkmcnt(9)
  ds_read_b64_tr_b16 v[76:77], v31 offset:7680
  v_mfma_f32_16x16x32_bf16 v[18:21], v[82:85], a[12:15], v[18:21]
  ds_read_b64_tr_b16 v[78:79], v13 offset:5184
  v_mfma_f32_16x16x32_bf16 v[42:45], v[82:85], a[92:95], v[42:45]
  s_waitcnt lgkmcnt(9)
  ds_read_b64_tr_b16 v[80:81], v13 offset:7744
  v_mfma_f32_16x16x32_bf16 v[22:25], v[86:89], a[12:15], v[22:25]
  ds_read_b64_tr_b16 v[82:83], v31 offset:5184
  buffer_load_dwordx4 a[96:99], v97, s[36:39], s80 offen sc1
  v_mfma_f32_16x16x32_bf16 v[46:49], v[86:89], a[92:95], v[46:49]
  s_waitcnt lgkmcnt(9)
  ds_read_b64_tr_b16 v[84:85], v31 offset:7744
  v_mfma_f32_16x16x32_bf16 v[26:29], v[58:61], a[12:15], v[26:29]
  ds_read_b64_tr_b16 v[86:87], v62 offset:5120
  v_mfma_f32_16x16x32_bf16 v[50:53], v[58:61], a[92:95], v[50:53]
  s_waitcnt lgkmcnt(9)
  ds_read_b64_tr_b16 v[88:89], v62 offset:7680
  v_mfma_f32_16x16x32_bf16 v[34:37], v[66:69], a[12:15], v[34:37]
  ds_read_b64_tr_b16 v[58:59], v13 offset:10240
  v_mfma_f32_16x16x32_bf16 v[54:57], v[66:69], a[92:95], v[54:57]
  s_waitcnt lgkmcnt(9)
  ds_read_b64_tr_b16 v[60:61], v13 offset:12800
  s_waitcnt vmcnt(7)
  v_mfma_f32_16x16x32_bf16 v[14:17], v[70:73], a[32:35], v[14:17]
  ds_read_b64_tr_b16 v[66:67], v31 offset:10240
  buffer_load_dwordx4 a[36:39], v93, s[36:39], s80 offen offset:1024 sc1
  s_waitcnt vmcnt(7)
  v_mfma_f32_16x16x32_bf16 v[38:41], v[70:73], a[112:115], v[38:41]
  s_waitcnt lgkmcnt(9)
  ds_read_b64_tr_b16 v[68:69], v31 offset:12800
  v_mfma_f32_16x16x32_bf16 v[18:21], v[74:77], a[32:35], v[18:21]
  ds_read_b64_tr_b16 v[70:71], v13 offset:10304
  v_mfma_f32_16x16x32_bf16 v[42:45], v[74:77], a[112:115], v[42:45]
  s_waitcnt lgkmcnt(9)
  ds_read_b64_tr_b16 v[72:73], v13 offset:12864
  v_mfma_f32_16x16x32_bf16 v[22:25], v[78:81], a[32:35], v[22:25]
  ds_read_b64_tr_b16 v[74:75], v31 offset:10304
  buffer_load_dwordx4 a[116:119], v98, s[36:39], s80 offen offset:1024 sc1
  v_mfma_f32_16x16x32_bf16 v[46:49], v[78:81], a[112:115], v[46:49]
  s_waitcnt lgkmcnt(9)
  ds_read_b64_tr_b16 v[76:77], v31 offset:12864
  v_mfma_f32_16x16x32_bf16 v[26:29], v[82:85], a[32:35], v[26:29]
  ds_read_b64_tr_b16 v[78:79], v62 offset:10240
  v_mfma_f32_16x16x32_bf16 v[50:53], v[82:85], a[112:115], v[50:53]
  s_waitcnt lgkmcnt(9)
  ds_read_b64_tr_b16 v[80:81], v62 offset:12800
  v_mfma_f32_16x16x32_bf16 v[34:37], v[86:89], a[32:35], v[34:37]
  ds_read_b64_tr_b16 v[82:83], v13 offset:15360
  v_mfma_f32_16x16x32_bf16 v[54:57], v[86:89], a[112:115], v[54:57]
  s_waitcnt lgkmcnt(9)
  ds_read_b64_tr_b16 v[84:85], v13 offset:17920
  s_waitcnt vmcnt(7)
  v_mfma_f32_16x16x32_bf16 v[14:17], v[58:61], a[52:55], v[14:17]
  ds_read_b64_tr_b16 v[86:87], v31 offset:15360
  buffer_load_dwordx4 a[56:59], v94, s[36:39], s80 offen offset:2048 sc1
  s_waitcnt vmcnt(7)
  v_mfma_f32_16x16x32_bf16 v[38:41], v[58:61], a[132:135], v[38:41]
  s_waitcnt lgkmcnt(9)
  ds_read_b64_tr_b16 v[88:89], v31 offset:17920
  v_mfma_f32_16x16x32_bf16 v[18:21], v[66:69], a[52:55], v[18:21]
  ds_read_b64_tr_b16 v[58:59], v13 offset:15424
  v_mfma_f32_16x16x32_bf16 v[42:45], v[66:69], a[132:135], v[42:45]
  s_waitcnt lgkmcnt(9)
  ds_read_b64_tr_b16 v[60:61], v13 offset:17984
  v_mfma_f32_16x16x32_bf16 v[22:25], v[70:73], a[52:55], v[22:25]
  ds_read_b64_tr_b16 v[66:67], v31 offset:15424
  buffer_load_dwordx4 a[136:139], v99, s[36:39], s80 offen offset:2048 sc1
  v_mfma_f32_16x16x32_bf16 v[46:49], v[70:73], a[132:135], v[46:49]
  s_waitcnt lgkmcnt(9)
  ds_read_b64_tr_b16 v[68:69], v31 offset:17984
  v_mfma_f32_16x16x32_bf16 v[26:29], v[74:77], a[52:55], v[26:29]
  ds_read_b64_tr_b16 v[70:71], v62 offset:15360
  v_mfma_f32_16x16x32_bf16 v[50:53], v[74:77], a[132:135], v[50:53]
  s_waitcnt lgkmcnt(9)
  ds_read_b64_tr_b16 v[72:73], v62 offset:17920
  v_mfma_f32_16x16x32_bf16 v[34:37], v[78:81], a[52:55], v[34:37]
  ds_read_b64_tr_b16 v[74:75], v90 offset:20480
  v_mfma_f32_16x16x32_bf16 v[54:57], v[78:81], a[132:135], v[54:57]
  s_waitcnt lgkmcnt(9)
  ds_read_b64_tr_b16 v[76:77], v90 offset:21120
  s_waitcnt vmcnt(7)
  v_mfma_f32_16x16x32_bf16 v[14:17], v[82:85], a[72:75], v[14:17]
  ds_read_b64_tr_b16 v[78:79], v91 offset:20480
  buffer_load_dwordx4 a[76:79], v95, s[36:39], s80 offen offset:3072 sc1
  s_waitcnt vmcnt(7)
  v_mfma_f32_16x16x32_bf16 v[38:41], v[82:85], a[152:155], v[38:41]
  s_waitcnt lgkmcnt(9)
  ds_read_b64_tr_b16 v[80:81], v91 offset:21120
  v_mfma_f32_16x16x32_bf16 v[18:21], v[86:89], a[72:75], v[18:21]
  ds_read_b64_tr_b16 v[82:83], v90 offset:20544
  v_mfma_f32_16x16x32_bf16 v[42:45], v[86:89], a[152:155], v[42:45]
  s_waitcnt lgkmcnt(9)
  ds_read_b64_tr_b16 v[84:85], v90 offset:21184
  v_mfma_f32_16x16x32_bf16 v[22:25], v[58:61], a[72:75], v[22:25]
  ds_read_b64_tr_b16 v[86:87], v91 offset:20544
  buffer_load_dwordx4 a[156:159], v100, s[36:39], s80 offen offset:3072 sc1
  v_mfma_f32_16x16x32_bf16 v[46:49], v[58:61], a[152:155], v[46:49]
  s_waitcnt lgkmcnt(9)
  ds_read_b64_tr_b16 v[88:89], v91 offset:21184
  v_mfma_f32_16x16x32_bf16 v[26:29], v[66:69], a[72:75], v[26:29]
  ds_read_b64_tr_b16 v[58:59], v92 offset:20480
  v_mfma_f32_16x16x32_bf16 v[50:53], v[66:69], a[152:155], v[50:53]
  s_waitcnt lgkmcnt(9)
  ds_read_b64_tr_b16 v[60:61], v92 offset:21120
  v_mfma_f32_16x16x32_bf16 v[34:37], v[70:73], a[72:75], v[34:37]
  ds_read_b64_tr_b16 v[66:67], v90 offset:25600
  v_mfma_f32_16x16x32_bf16 v[54:57], v[70:73], a[152:155], v[54:57]
  s_waitcnt lgkmcnt(9)
  ds_read_b64_tr_b16 v[68:69], v90 offset:26240
  s_waitcnt vmcnt(7)
  v_mfma_f32_16x16x32_bf16 v[14:17], v[74:77], a[16:19], v[14:17]
  ds_read_b64_tr_b16 v[70:71], v91 offset:25600
  s_waitcnt vmcnt(6)
  v_mfma_f32_16x16x32_bf16 v[38:41], v[74:77], a[96:99], v[38:41]
  s_waitcnt lgkmcnt(9)
  ds_read_b64_tr_b16 v[72:73], v91 offset:26240
  v_mfma_f32_16x16x32_bf16 v[18:21], v[78:81], a[16:19], v[18:21]
  ds_read_b64_tr_b16 v[74:75], v90 offset:25664
  v_mfma_f32_16x16x32_bf16 v[42:45], v[78:81], a[96:99], v[42:45]
  s_waitcnt lgkmcnt(9)
  ds_read_b64_tr_b16 v[76:77], v90 offset:26304
  v_mfma_f32_16x16x32_bf16 v[22:25], v[82:85], a[16:19], v[22:25]
  ds_read_b64_tr_b16 v[78:79], v91 offset:25664
  v_mfma_f32_16x16x32_bf16 v[46:49], v[82:85], a[96:99], v[46:49]
  s_waitcnt lgkmcnt(9)
  ds_read_b64_tr_b16 v[80:81], v91 offset:26304
  v_mfma_f32_16x16x32_bf16 v[26:29], v[86:89], a[16:19], v[26:29]
  ds_read_b64_tr_b16 v[82:83], v92 offset:25600
  v_mfma_f32_16x16x32_bf16 v[50:53], v[86:89], a[96:99], v[50:53]
  s_waitcnt lgkmcnt(9)
  ds_read_b64_tr_b16 v[84:85], v92 offset:26240
  v_mfma_f32_16x16x32_bf16 v[34:37], v[58:61], a[16:19], v[34:37]
  ds_read_b64_tr_b16 v[86:87], v90 offset:30720
  v_mfma_f32_16x16x32_bf16 v[54:57], v[58:61], a[96:99], v[54:57]
  s_waitcnt lgkmcnt(9)
  ds_read_b64_tr_b16 v[88:89], v90 offset:31360
  s_waitcnt vmcnt(5)
  v_mfma_f32_16x16x32_bf16 v[14:17], v[66:69], a[36:39], v[14:17]
  ds_read_b64_tr_b16 v[58:59], v91 offset:30720
  s_waitcnt vmcnt(4)
  v_mfma_f32_16x16x32_bf16 v[38:41], v[66:69], a[116:119], v[38:41]
  s_waitcnt lgkmcnt(9)
  ds_read_b64_tr_b16 v[60:61], v91 offset:31360
  v_mfma_f32_16x16x32_bf16 v[18:21], v[70:73], a[36:39], v[18:21]
  ds_read_b64_tr_b16 v[66:67], v90 offset:30784
  v_mfma_f32_16x16x32_bf16 v[42:45], v[70:73], a[116:119], v[42:45]
  s_waitcnt lgkmcnt(9)
  ds_read_b64_tr_b16 v[68:69], v90 offset:31424
  v_mfma_f32_16x16x32_bf16 v[22:25], v[74:77], a[36:39], v[22:25]
  ds_read_b64_tr_b16 v[70:71], v91 offset:30784
  v_mfma_f32_16x16x32_bf16 v[46:49], v[74:77], a[116:119], v[46:49]
  s_waitcnt lgkmcnt(9)
  ds_read_b64_tr_b16 v[72:73], v91 offset:31424
  v_mfma_f32_16x16x32_bf16 v[26:29], v[78:81], a[36:39], v[26:29]
  ds_read_b64_tr_b16 v[74:75], v92 offset:30720
  v_mfma_f32_16x16x32_bf16 v[50:53], v[78:81], a[116:119], v[50:53]
  s_waitcnt lgkmcnt(9)
  ds_read_b64_tr_b16 v[76:77], v92 offset:31360
  v_mfma_f32_16x16x32_bf16 v[34:37], v[82:85], a[36:39], v[34:37]
  ds_read_b64_tr_b16 v[78:79], v90 offset:35840
  v_mfma_f32_16x16x32_bf16 v[54:57], v[82:85], a[116:119], v[54:57]
  s_waitcnt lgkmcnt(9)
  ds_read_b64_tr_b16 v[80:81], v90 offset:36480
  s_waitcnt vmcnt(3)
  v_mfma_f32_16x16x32_bf16 v[14:17], v[86:89], a[56:59], v[14:17]
  ds_read_b64_tr_b16 v[82:83], v91 offset:35840
  s_waitcnt vmcnt(2)
  v_mfma_f32_16x16x32_bf16 v[38:41], v[86:89], a[136:139], v[38:41]
  s_waitcnt lgkmcnt(9)
  ds_read_b64_tr_b16 v[84:85], v91 offset:36480
  v_mfma_f32_16x16x32_bf16 v[18:21], v[58:61], a[56:59], v[18:21]
  ds_read_b64_tr_b16 v[86:87], v90 offset:35904
  v_mfma_f32_16x16x32_bf16 v[42:45], v[58:61], a[136:139], v[42:45]
  s_waitcnt lgkmcnt(9)
  ds_read_b64_tr_b16 v[88:89], v90 offset:36544
  v_mfma_f32_16x16x32_bf16 v[22:25], v[66:69], a[56:59], v[22:25]
  ds_read_b64_tr_b16 v[58:59], v91 offset:35904
  v_mfma_f32_16x16x32_bf16 v[46:49], v[66:69], a[136:139], v[46:49]
  s_waitcnt lgkmcnt(9)
  ds_read_b64_tr_b16 v[60:61], v91 offset:36544
  v_mfma_f32_16x16x32_bf16 v[26:29], v[70:73], a[56:59], v[26:29]
  ds_read_b64_tr_b16 v[66:67], v92 offset:35840
  v_mfma_f32_16x16x32_bf16 v[50:53], v[70:73], a[136:139], v[50:53]
  s_waitcnt lgkmcnt(9)
  ds_read_b64_tr_b16 v[68:69], v92 offset:36480
  v_mfma_f32_16x16x32_bf16 v[34:37], v[74:77], a[56:59], v[34:37]
  v_mfma_f32_16x16x32_bf16 v[54:57], v[74:77], a[136:139], v[54:57]
  s_waitcnt lgkmcnt(8)
  s_waitcnt vmcnt(1)
  v_mfma_f32_16x16x32_bf16 v[14:17], v[78:81], a[76:79], v[14:17]
  s_waitcnt vmcnt(0)
  v_mfma_f32_16x16x32_bf16 v[38:41], v[78:81], a[156:159], v[38:41]
  s_waitcnt lgkmcnt(6)
  v_mfma_f32_16x16x32_bf16 v[18:21], v[82:85], a[76:79], v[18:21]
  v_mfma_f32_16x16x32_bf16 v[42:45], v[82:85], a[156:159], v[42:45]
  s_waitcnt lgkmcnt(4)
  v_mfma_f32_16x16x32_bf16 v[22:25], v[86:89], a[76:79], v[22:25]
  v_mfma_f32_16x16x32_bf16 v[46:49], v[86:89], a[156:159], v[46:49]
  s_waitcnt lgkmcnt(2)
  v_mfma_f32_16x16x32_bf16 v[26:29], v[58:61], a[76:79], v[26:29]
  v_mfma_f32_16x16x32_bf16 v[50:53], v[58:61], a[156:159], v[50:53]
  s_waitcnt lgkmcnt(0)
  v_mfma_f32_16x16x32_bf16 v[34:37], v[66:69], a[76:79], v[34:37]
  v_mfma_f32_16x16x32_bf16 v[54:57], v[66:69], a[156:159], v[54:57]
  v_cvt_pk_bf16_f32 v104, v14, v15
  v_cvt_pk_bf16_f32 v105, v16, v17
  v_cvt_pk_bf16_f32 v106, v18, v19
  v_cvt_pk_bf16_f32 v107, v20, v21
  v_cvt_pk_bf16_f32 v108, v22, v23
  v_cvt_pk_bf16_f32 v109, v24, v25
  v_cvt_pk_bf16_f32 v110, v26, v27
  v_cvt_pk_bf16_f32 v111, v28, v29
  v_cmp_u_f32 vcc, v14, v38
  s_nop 4
  s_cbranch_vccnz L_redoA
L_stA:
  v_cndmask_b32_e64 v124, v104, v106, s[62:63]
  v_cndmask_b32_e64 v125, v105, v107, s[62:63]
  v_cndmask_b32_e64 v126, v106, v104, s[62:63]
  v_cndmask_b32_e64 v127, v107, v105, s[62:63]
  buffer_store_dwordx4 v[124:127], v102, s[48:51], 0 offen
  v_cndmask_b32_e64 v128, v108, v110, s[62:63]
  v_cndmask_b32_e64 v129, v109, v111, s[62:63]
  v_cndmask_b32_e64 v130, v110, v108, s[62:63]
  v_cndmask_b32_e64 v131, v111, v109, s[62:63]
  buffer_store_dwordx4 v[128:131], v102, s[48:51], 0 offen offset:64
  v_cvt_pk_bf16_f32 v112, v34, v35
  v_cvt_pk_bf16_f32 v113, v36, v37
  buffer_store_dwordx2 v[112:113], v103, s[48:51], 0 offen
  v_cvt_pk_bf16_f32 v114, v38, v39
  v_cvt_pk_bf16_f32 v115, v40, v41
  v_cvt_pk_bf16_f32 v116, v42, v43
  v_cvt_pk_bf16_f32 v117, v44, v45
  v_cvt_pk_bf16_f32 v118, v46, v47
  v_cvt_pk_bf16_f32 v119, v48, v49
  v_cvt_pk_bf16_f32 v120, v50, v51
  v_cvt_pk_bf16_f32 v121, v52, v53
  v_cndmask_b32_e64 v132, v114, v116, s[62:63]
  v_cndmask_b32_e64 v133, v115, v117, s[62:63]
  v_cndmask_b32_e64 v134, v116, v114, s[62:63]
  v_cndmask_b32_e64 v135, v117, v115, s[62:63]
  buffer_store_dwordx4 v[132:135], v102, s[48:51], s27 offen
  v_cndmask_b32_e64 v136, v118, v120, s[62:63]
  v_cndmask_b32_e64 v137, v119, v121, s[62:63]
  v_cndmask_b32_e64 v138, v120, v118, s[62:63]
  v_cndmask_b32_e64 v139, v121, v119, s[62:63]
  buffer_store_dwordx4 v[136:139], v102, s[48:51], s27 offen offset:64
  v_cvt_pk_bf16_f32 v122, v54, v55
  v_cvt_pk_bf16_f32 v123, v56, v57
  buffer_store_dwordx2 v[122:123], v103, s[48:51], s27 offen
  s_endpgm
L_redoA:
  s_add_u32 s92, s92, 1
  s_cmp_gt_u32 s92, 0xc8
  s_cbranch_scc1 L_stA
  s_sleep 8
  buffer_load_dwordx4 a[0:3], v6, s[36:39], s76 offen sc1
  buffer_load_dwordx4 a[80:83], v97, s[36:39], s76 offen sc1
  buffer_load_dwordx4 a[20:23], v93, s[36:39], s76 offen offset:1024 sc1
  buffer_load_dwordx4 a[100:103], v98, s[36:39], s76 offen offset:1024 sc1
  buffer_load_dwordx4 a[40:43], v94, s[36:39], s76 offen offset:2048 sc1
  buffer_load_dwordx4 a[120:123], v99, s[36:39], s76 offen offset:2048 sc1
  buffer_load_dwordx4 a[60:63], v95, s[36:39], s76 offen offset:3072 sc1
  buffer_load_dwordx4 a[140:143], v100, s[36:39], s76 offen offset:3072 sc1
  buffer_load_dwordx4 a[4:7], v6, s[36:39], s77 offen sc1
  buffer_load_dwordx4 a[84:87], v97, s[36:39], s77 offen sc1
  buffer_load_dwordx4 a[24:27], v93, s[36:39], s77 offen offset:1024 sc1
  buffer_load_dwordx4 a[104:107], v98, s[36:39], s77 offen offset:1024 sc1
  buffer_load_dwordx4 a[44:47], v94, s[36:39], s77 offen offset:2048 sc1
  buffer_load_dwordx4 a[124:127], v99, s[36:39], s77 offen offset:2048 sc1
  buffer_load_dwordx4 a[64:67], v95, s[36:39], s77 offen offset:3072 sc1
  buffer_load_dwordx4 a[144:147], v100, s[36:39], s77 offen offset:3072 sc1
  buffer_load_dwordx4 a[8:11], v6, s[36:39], s78 offen sc1
  buffer_load_dwordx4 a[88:91], v97, s[36:39], s78 offen sc1
  buffer_load_dwordx4 a[28:31], v93, s[36:39], s78 offen offset:1024 sc1
  buffer_load_dwordx4 a[108:111], v98, s[36:39], s78 offen offset:1024 sc1
  buffer_load_dwordx4 a[48:51], v94, s[36:39], s78 offen offset:2048 sc1
  buffer_load_dwordx4 a[128:131], v99, s[36:39], s78 offen offset:2048 sc1
  buffer_load_dwordx4 a[68:71], v95, s[36:39], s78 offen offset:3072 sc1
  buffer_load_dwordx4 a[148:151], v100, s[36:39], s78 offen offset:3072 sc1
  buffer_load_dwordx4 a[12:15], v6, s[36:39], s79 offen sc1
  buffer_load_dwordx4 a[92:95], v97, s[36:39], s79 offen sc1
  buffer_load_dwordx4 a[32:35], v93, s[36:39], s79 offen offset:1024 sc1
  buffer_load_dwordx4 a[112:115], v98, s[36:39], s79 offen offset:1024 sc1
  buffer_load_dwordx4 a[52:55], v94, s[36:39], s79 offen offset:2048 sc1
  buffer_load_dwordx4 a[132:135], v99, s[36:39], s79 offen offset:2048 sc1
  buffer_load_dwordx4 a[72:75], v95, s[36:39], s79 offen offset:3072 sc1
  buffer_load_dwordx4 a[152:155], v100, s[36:39], s79 offen offset:3072 sc1
  buffer_load_dwordx4 a[16:19], v6, s[36:39], s80 offen sc1
  buffer_load_dwordx4 a[96:99], v97, s[36:39], s80 offen sc1
  buffer_load_dwordx4 a[36:39], v93, s[36:39], s80 offen offset:1024 sc1
  buffer_load_dwordx4 a[116:119], v98, s[36:39], s80 offen offset:1024 sc1
  buffer_load_dwordx4 a[56:59], v94, s[36:39], s80 offen offset:2048 sc1
  buffer_load_dwordx4 a[136:139], v99, s[36:39], s80 offen offset:2048 sc1
  buffer_load_dwordx4 a[76:79], v95, s[36:39], s80 offen offset:3072 sc1
  buffer_load_dwordx4 a[156:159], v100, s[36:39], s80 offen offset:3072 sc1
  s_waitcnt vmcnt(0)
  ds_read_b64_tr_b16 v[58:59], v30
  ds_read_b64_tr_b16 v[60:61], v30 offset:2560
  ds_read_b64_tr_b16 v[66:67], v33
  ds_read_b64_tr_b16 v[68:69], v33 offset:2560
  ds_read_b64_tr_b16 v[70:71], v30 offset:64
  ds_read_b64_tr_b16 v[72:73], v30 offset:2624
  s_waitcnt lgkmcnt(4)
  v_mfma_f32_16x16x32_bf16 v[14:17], v[58:61], a[0:3], 0
  v_mfma_f32_16x16x32_bf16 v[38:41], v[58:61], a[80:83], 0
  ds_read_b64_tr_b16 v[74:75], v33 offset:64
  ds_read_b64_tr_b16 v[76:77], v33 offset:2624
  s_waitcnt lgkmcnt(4)
  v_mfma_f32_16x16x32_bf16 v[18:21], v[66:69], a[0:3], 0
  v_mfma_f32_16x16x32_bf16 v[42:45], v[66:69], a[80:83], 0
  ds_read_b64_tr_b16 v[78:79], v65
  ds_read_b64_tr_b16 v[80:81], v65 offset:2560
  s_waitcnt lgkmcnt(4)
  v_mfma_f32_16x16x32_bf16 v[22:25], v[70:73], a[0:3], 0
  v_mfma_f32_16x16x32_bf16 v[46:49], v[70:73], a[80:83], 0
  ds_read_b64_tr_b16 v[82:83], v30 offset:5120
  ds_read_b64_tr_b16 v[84:85], v30 offset:7680
  s_waitcnt lgkmcnt(4)
  v_mfma_f32_16x16x32_bf16 v[26:29], v[74:77], a[0:3], 0
  v_mfma_f32_16x16x32_bf16 v[50:53], v[74:77], a[80:83], 0
  ds_read_b64_tr_b16 v[86:87], v33 offset:5120
  ds_read_b64_tr_b16 v[88:89], v33 offset:7680
  s_waitcnt lgkmcnt(4)
  v_mfma_f32_16x16x32_bf16 v[34:37], v[78:81], a[0:3], 0
  v_mfma_f32_16x16x32_bf16 v[54:57], v[78:81], a[80:83], 0
  ds_read_b64_tr_b16 v[58:59], v30 offset:5184
  ds_read_b64_tr_b16 v[60:61], v30 offset:7744
  s_waitcnt lgkmcnt(4)
  v_mfma_f32_16x16x32_bf16 v[14:17], v[82:85], a[20:23], v[14:17]
  v_mfma_f32_16x16x32_bf16 v[38:41], v[82:85], a[100:103], v[38:41]
  ds_read_b64_tr_b16 v[66:67], v33 offset:5184
  ds_read_b64_tr_b16 v[68:69], v33 offset:7744
  s_waitcnt lgkmcnt(4)
  v_mfma_f32_16x16x32_bf16 v[18:21], v[86:89], a[20:23], v[18:21]
  v_mfma_f32_16x16x32_bf16 v[42:45], v[86:89], a[100:103], v[42:45]
  ds_read_b64_tr_b16 v[70:71], v65 offset:5120
  ds_read_b64_tr_b16 v[72:73], v65 offset:7680
  s_waitcnt lgkmcnt(4)
  v_mfma_f32_16x16x32_bf16 v[22:25], v[58:61], a[20:23], v[22:25]
  v_mfma_f32_16x16x32_bf16 v[46:49], v[58:61], a[100:103], v[46:49]
  ds_read_b64_tr_b16 v[74:75], v30 offset:10240
  ds_read_b64_tr_b16 v[76:77], v30 offset:12800
  s_waitcnt lgkmcnt(4)
  v_mfma_f32_16x16x32_bf16 v[26:29], v[66:69], a[20:23], v[26:29]
  v_mfma_f32_16x16x32_bf16 v[50:53], v[66:69], a[100:103], v[50:53]
  ds_read_b64_tr_b16 v[78:79], v33 offset:10240
  ds_read_b64_tr_b16 v[80:81], v33 offset:12800
  s_waitcnt lgkmcnt(4)
  v_mfma_f32_16x16x32_bf16 v[34:37], v[70:73], a[20:23], v[34:37]
  v_mfma_f32_16x16x32_bf16 v[54:57], v[70:73], a[100:103], v[54:57]
  ds_read_b64_tr_b16 v[82:83], v30 offset:10304
  ds_read_b64_tr_b16 v[84:85], v30 offset:12864
  s_waitcnt lgkmcnt(4)
  v_mfma_f32_16x16x32_bf16 v[14:17], v[74:77], a[40:43], v[14:17]
  v_mfma_f32_16x16x32_bf16 v[38:41], v[74:77], a[120:123], v[38:41]
  ds_read_b64_tr_b16 v[86:87], v33 offset:10304
  ds_read_b64_tr_b16 v[88:89], v33 offset:12864
  s_waitcnt lgkmcnt(4)
  v_mfma_f32_16x16x32_bf16 v[18:21], v[78:81], a[40:43], v[18:21]
  v_mfma_f32_16x16x32_bf16 v[42:45], v[78:81], a[120:123], v[42:45]
  ds_read_b64_tr_b16 v[58:59], v65 offset:10240
  ds_read_b64_tr_b16 v[60:61], v65 offset:12800
  s_waitcnt lgkmcnt(4)
  v_mfma_f32_16x16x32_bf16 v[22:25], v[82:85], a[40:43], v[22:25]
  v_mfma_f32_16x16x32_bf16 v[46:49], v[82:85], a[120:123], v[46:49]
  ds_read_b64_tr_b16 v[66:67], v30 offset:15360
  ds_read_b64_tr_b16 v[68:69], v30 offset:17920
  s_waitcnt lgkmcnt(4)
  v_mfma_f32_16x16x32_bf16 v[26:29], v[86:89], a[40:43], v[26:29]
  v_mfma_f32_16x16x32_bf16 v[50:53], v[86:89], a[120:123], v[50:53]
  ds_read_b64_tr_b16 v[70:71], v33 offset:15360
  ds_read_b64_tr_b16 v[72:73], v33 offset:17920
  s_waitcnt lgkmcnt(4)
  v_mfma_f32_16x16x32_bf16 v[34:37], v[58:61], a[40:43], v[34:37]
  v_mfma_f32_16x16x32_bf16 v[54:57], v[58:61], a[120:123], v[54:57]
  ds_read_b64_tr_b16 v[74:75], v30 offset:15424
  ds_read_b64_tr_b16 v[76:77], v30 offset:17984
  s_waitcnt lgkmcnt(4)
  v_mfma_f32_16x16x32_bf16 v[14:17], v[66:69], a[60:63], v[14:17]
  v_mfma_f32_16x16x32_bf16 v[38:41], v[66:69], a[140:143], v[38:41]
  ds_read_b64_tr_b16 v[78:79], v33 offset:15424
  ds_read_b64_tr_b16 v[80:81], v33 offset:17984
  s_waitcnt lgkmcnt(4)
  v_mfma_f32_16x16x32_bf16 v[18:21], v[70:73], a[60:63], v[18:21]
  v_mfma_f32_16x16x32_bf16 v[42:45], v[70:73], a[140:143], v[42:45]
  ds_read_b64_tr_b16 v[82:83], v65 offset:15360
  ds_read_b64_tr_b16 v[84:85], v65 offset:17920
  s_waitcnt lgkmcnt(4)
  v_mfma_f32_16x16x32_bf16 v[22:25], v[74:77], a[60:63], v[22:25]
  v_mfma_f32_16x16x32_bf16 v[46:49], v[74:77], a[140:143], v[46:49]
  ds_read_b64_tr_b16 v[86:87], v30 offset:20480
  ds_read_b64_tr_b16 v[88:89], v30 offset:23040
  s_waitcnt lgkmcnt(4)
  v_mfma_f32_16x16x32_bf16 v[26:29], v[78:81], a[60:63], v[26:29]
  v_mfma_f32_16x16x32_bf16 v[50:53], v[78:81], a[140:143], v[50:53]
  ds_read_b64_tr_b16 v[58:59], v33 offset:20480
  ds_read_b64_tr_b16 v[60:61], v33 offset:23040
  s_waitcnt lgkmcnt(4)
  v_mfma_f32_16x16x32_bf16 v[34:37], v[82:85], a[60:63], v[34:37]
  v_mfma_f32_16x16x32_bf16 v[54:57], v[82:85], a[140:143], v[54:57]
  ds_read_b64_tr_b16 v[66:67], v30 offset:20544
  ds_read_b64_tr_b16 v[68:69], v30 offset:23104
  s_waitcnt lgkmcnt(4)
  v_mfma_f32_16x16x32_bf16 v[14:17], v[86:89], a[4:7], v[14:17]
  v_mfma_f32_16x16x32_bf16 v[38:41], v[86:89], a[84:87], v[38:41]
  ds_read_b64_tr_b16 v[70:71], v33 offset:20544
  ds_read_b64_tr_b16 v[72:73], v33 offset:23104
  s_waitcnt lgkmcnt(4)
  v_mfma_f32_16x16x32_bf16 v[18:21], v[58:61], a[4:7], v[18:21]
  v_mfma_f32_16x16x32_bf16 v[42:45], v[58:61], a[84:87], v[42:45]
  ds_read_b64_tr_b16 v[74:75], v65 offset:20480
  ds_read_b64_tr_b16 v[76:77], v65 offset:23040
  s_waitcnt lgkmcnt(4)
  v_mfma_f32_16x16x32_bf16 v[22:25], v[66:69], a[4:7], v[22:25]
  v_mfma_f32_16x16x32_bf16 v[46:49], v[66:69], a[84:87], v[46:49]
  ds_read_b64_tr_b16 v[78:79], v30 offset:25600
  ds_read_b64_tr_b16 v[80:81], v30 offset:28160
  s_waitcnt lgkmcnt(4)
  v_mfma_f32_16x16x32_bf16 v[26:29], v[70:73], a[4:7], v[26:29]
  v_mfma_f32_16x16x32_bf16 v[50:53], v[70:73], a[84:87], v[50:53]
  ds_read_b64_tr_b16 v[82:83], v33 offset:25600
  ds_read_b64_tr_b16 v[84:85], v33 offset:28160
  s_waitcnt lgkmcnt(4)
  v_mfma_f32_16x16x32_bf16 v[34:37], v[74:77], a[4:7], v[34:37]
  v_mfma_f32_16x16x32_bf16 v[54:57], v[74:77], a[84:87], v[54:57]
  ds_read_b64_tr_b16 v[86:87], v30 offset:25664
  ds_read_b64_tr_b16 v[88:89], v30 offset:28224
  s_waitcnt lgkmcnt(4)
  v_mfma_f32_16x16x32_bf16 v[14:17], v[78:81], a[24:27], v[14:17]
  v_mfma_f32_16x16x32_bf16 v[38:41], v[78:81], a[104:107], v[38:41]
  ds_read_b64_tr_b16 v[58:59], v33 offset:25664
  ds_read_b64_tr_b16 v[60:61], v33 offset:28224
  s_waitcnt lgkmcnt(4)
  v_mfma_f32_16x16x32_bf16 v[18:21], v[82:85], a[24:27], v[18:21]
  v_mfma_f32_16x16x32_bf16 v[42:45], v[82:85], a[104:107], v[42:45]
  ds_read_b64_tr_b16 v[66:67], v65 offset:25600
  ds_read_b64_tr_b16 v[68:69], v65 offset:28160
  s_waitcnt lgkmcnt(4)
  v_mfma_f32_16x16x32_bf16 v[22:25], v[86:89], a[24:27], v[22:25]
  v_mfma_f32_16x16x32_bf16 v[46:49], v[86:89], a[104:107], v[46:49]
  ds_read_b64_tr_b16 v[70:71], v30 offset:30720
  ds_read_b64_tr_b16 v[72:73], v30 offset:33280
  s_waitcnt lgkmcnt(4)
  v_mfma_f32_16x16x32_bf16 v[26:29], v[58:61], a[24:27], v[26:29]
  v_mfma_f32_16x16x32_bf16 v[50:53], v[58:61], a[104:107], v[50:53]
  ds_read_b64_tr_b16 v[74:75], v33 offset:30720
  ds_read_b64_tr_b16 v[76:77], v33 offset:33280
  s_waitcnt lgkmcnt(4)
  v_mfma_f32_16x16x32_bf16 v[34:37], v[66:69], a[24:27], v[34:37]
  v_mfma_f32_16x16x32_bf16 v[54:57], v[66:69], a[104:107], v[54:57]
  ds_read_b64_tr_b16 v[78:79], v30 offset:30784
  ds_read_b64_tr_b16 v[80:81], v30 offset:33344
  s_waitcnt lgkmcnt(4)
  v_mfma_f32_16x16x32_bf16 v[14:17], v[70:73], a[44:47], v[14:17]
  v_mfma_f32_16x16x32_bf16 v[38:41], v[70:73], a[124:127], v[38:41]
  ds_read_b64_tr_b16 v[82:83], v33 offset:30784
  ds_read_b64_tr_b16 v[84:85], v33 offset:33344
  s_waitcnt lgkmcnt(4)
  v_mfma_f32_16x16x32_bf16 v[18:21], v[74:77], a[44:47], v[18:21]
  v_mfma_f32_16x16x32_bf16 v[42:45], v[74:77], a[124:127], v[42:45]
  ds_read_b64_tr_b16 v[86:87], v65 offset:30720
  ds_read_b64_tr_b16 v[88:89], v65 offset:33280
  s_waitcnt lgkmcnt(4)
  v_mfma_f32_16x16x32_bf16 v[22:25], v[78:81], a[44:47], v[22:25]
  v_mfma_f32_16x16x32_bf16 v[46:49], v[78:81], a[124:127], v[46:49]
  ds_read_b64_tr_b16 v[58:59], v30 offset:35840
  ds_read_b64_tr_b16 v[60:61], v30 offset:38400
  s_waitcnt lgkmcnt(4)
  v_mfma_f32_16x16x32_bf16 v[26:29], v[82:85], a[44:47], v[26:29]
  v_mfma_f32_16x16x32_bf16 v[50:53], v[82:85], a[124:127], v[50:53]
  ds_read_b64_tr_b16 v[66:67], v33 offset:35840
  ds_read_b64_tr_b16 v[68:69], v33 offset:38400
  s_waitcnt lgkmcnt(4)
  v_mfma_f32_16x16x32_bf16 v[34:37], v[86:89], a[44:47], v[34:37]
  v_mfma_f32_16x16x32_bf16 v[54:57], v[86:89], a[124:127], v[54:57]
  ds_read_b64_tr_b16 v[70:71], v30 offset:35904
  ds_read_b64_tr_b16 v[72:73], v30 offset:38464
  s_waitcnt lgkmcnt(4)
  v_mfma_f32_16x16x32_bf16 v[14:17], v[58:61], a[64:67], v[14:17]
  v_mfma_f32_16x16x32_bf16 v[38:41], v[58:61], a[144:147], v[38:41]
  ds_read_b64_tr_b16 v[74:75], v33 offset:35904
  ds_read_b64_tr_b16 v[76:77], v33 offset:38464
  s_waitcnt lgkmcnt(4)
  v_mfma_f32_16x16x32_bf16 v[18:21], v[66:69], a[64:67], v[18:21]
  v_mfma_f32_16x16x32_bf16 v[42:45], v[66:69], a[144:147], v[42:45]
  ds_read_b64_tr_b16 v[78:79], v65 offset:35840
  ds_read_b64_tr_b16 v[80:81], v65 offset:38400
  s_waitcnt lgkmcnt(4)
  v_mfma_f32_16x16x32_bf16 v[22:25], v[70:73], a[64:67], v[22:25]
  v_mfma_f32_16x16x32_bf16 v[46:49], v[70:73], a[144:147], v[46:49]
  ds_read_b64_tr_b16 v[82:83], v30 offset:40960
  ds_read_b64_tr_b16 v[84:85], v30 offset:43520
  s_waitcnt lgkmcnt(4)
  v_mfma_f32_16x16x32_bf16 v[26:29], v[74:77], a[64:67], v[26:29]
  v_mfma_f32_16x16x32_bf16 v[50:53], v[74:77], a[144:147], v[50:53]
  ds_read_b64_tr_b16 v[86:87], v33 offset:40960
  ds_read_b64_tr_b16 v[88:89], v33 offset:43520
  s_waitcnt lgkmcnt(4)
  v_mfma_f32_16x16x32_bf16 v[34:37], v[78:81], a[64:67], v[34:37]
  v_mfma_f32_16x16x32_bf16 v[54:57], v[78:81], a[144:147], v[54:57]
  ds_read_b64_tr_b16 v[58:59], v30 offset:41024
  ds_read_b64_tr_b16 v[60:61], v30 offset:43584
  s_waitcnt lgkmcnt(4)
  v_mfma_f32_16x16x32_bf16 v[14:17], v[82:85], a[8:11], v[14:17]
  v_mfma_f32_16x16x32_bf16 v[38:41], v[82:85], a[88:91], v[38:41]
  ds_read_b64_tr_b16 v[66:67], v33 offset:41024
  ds_read_b64_tr_b16 v[68:69], v33 offset:43584
  s_waitcnt lgkmcnt(4)
  v_mfma_f32_16x16x32_bf16 v[18:21], v[86:89], a[8:11], v[18:21]
  v_mfma_f32_16x16x32_bf16 v[42:45], v[86:89], a[88:91], v[42:45]
  ds_read_b64_tr_b16 v[70:71], v65 offset:40960
  ds_read_b64_tr_b16 v[72:73], v65 offset:43520
  s_waitcnt lgkmcnt(4)
  v_mfma_f32_16x16x32_bf16 v[22:25], v[58:61], a[8:11], v[22:25]
  v_mfma_f32_16x16x32_bf16 v[46:49], v[58:61], a[88:91], v[46:49]
  ds_read_b64_tr_b16 v[74:75], v30 offset:46080
  ds_read_b64_tr_b16 v[76:77], v30 offset:48640
  s_waitcnt lgkmcnt(4)
  v_mfma_f32_16x16x32_bf16 v[26:29], v[66:69], a[8:11], v[26:29]
  v_mfma_f32_16x16x32_bf16 v[50:53], v[66:69], a[88:91], v[50:53]
  ds_read_b64_tr_b16 v[78:79], v33 offset:46080
  ds_read_b64_tr_b16 v[80:81], v33 offset:48640
  s_waitcnt lgkmcnt(4)
  v_mfma_f32_16x16x32_bf16 v[34:37], v[70:73], a[8:11], v[34:37]
  v_mfma_f32_16x16x32_bf16 v[54:57], v[70:73], a[88:91], v[54:57]
  ds_read_b64_tr_b16 v[82:83], v30 offset:46144
  ds_read_b64_tr_b16 v[84:85], v30 offset:48704
  s_waitcnt lgkmcnt(4)
  v_mfma_f32_16x16x32_bf16 v[14:17], v[74:77], a[28:31], v[14:17]
  v_mfma_f32_16x16x32_bf16 v[38:41], v[74:77], a[108:111], v[38:41]
  ds_read_b64_tr_b16 v[86:87], v33 offset:46144
  ds_read_b64_tr_b16 v[88:89], v33 offset:48704
  s_waitcnt lgkmcnt(4)
  v_mfma_f32_16x16x32_bf16 v[18:21], v[78:81], a[28:31], v[18:21]
  v_mfma_f32_16x16x32_bf16 v[42:45], v[78:81], a[108:111], v[42:45]
  ds_read_b64_tr_b16 v[58:59], v65 offset:46080
  ds_read_b64_tr_b16 v[60:61], v65 offset:48640
  s_waitcnt lgkmcnt(4)
  v_mfma_f32_16x16x32_bf16 v[22:25], v[82:85], a[28:31], v[22:25]
  v_mfma_f32_16x16x32_bf16 v[46:49], v[82:85], a[108:111], v[46:49]
  ds_read_b64_tr_b16 v[66:67], v30 offset:51200
  ds_read_b64_tr_b16 v[68:69], v30 offset:53760
  s_waitcnt lgkmcnt(4)
  v_mfma_f32_16x16x32_bf16 v[26:29], v[86:89], a[28:31], v[26:29]
  v_mfma_f32_16x16x32_bf16 v[50:53], v[86:89], a[108:111], v[50:53]
  ds_read_b64_tr_b16 v[70:71], v33 offset:51200
  ds_read_b64_tr_b16 v[72:73], v33 offset:53760
  s_waitcnt lgkmcnt(4)
  v_mfma_f32_16x16x32_bf16 v[34:37], v[58:61], a[28:31], v[34:37]
  v_mfma_f32_16x16x32_bf16 v[54:57], v[58:61], a[108:111], v[54:57]
  ds_read_b64_tr_b16 v[74:75], v30 offset:51264
  ds_read_b64_tr_b16 v[76:77], v30 offset:53824
  s_waitcnt lgkmcnt(4)
  v_mfma_f32_16x16x32_bf16 v[14:17], v[66:69], a[48:51], v[14:17]
  v_mfma_f32_16x16x32_bf16 v[38:41], v[66:69], a[128:131], v[38:41]
  ds_read_b64_tr_b16 v[78:79], v33 offset:51264
  ds_read_b64_tr_b16 v[80:81], v33 offset:53824
  s_waitcnt lgkmcnt(4)
  v_mfma_f32_16x16x32_bf16 v[18:21], v[70:73], a[48:51], v[18:21]
  v_mfma_f32_16x16x32_bf16 v[42:45], v[70:73], a[128:131], v[42:45]
  ds_read_b64_tr_b16 v[82:83], v65 offset:51200
  ds_read_b64_tr_b16 v[84:85], v65 offset:53760
  s_waitcnt lgkmcnt(4)
  v_mfma_f32_16x16x32_bf16 v[22:25], v[74:77], a[48:51], v[22:25]
  v_mfma_f32_16x16x32_bf16 v[46:49], v[74:77], a[128:131], v[46:49]
  ds_read_b64_tr_b16 v[86:87], v30 offset:56320
  ds_read_b64_tr_b16 v[88:89], v30 offset:58880
  s_waitcnt lgkmcnt(4)
  v_mfma_f32_16x16x32_bf16 v[26:29], v[78:81], a[48:51], v[26:29]
  v_mfma_f32_16x16x32_bf16 v[50:53], v[78:81], a[128:131], v[50:53]
  ds_read_b64_tr_b16 v[58:59], v33 offset:56320
  ds_read_b64_tr_b16 v[60:61], v33 offset:58880
  s_waitcnt lgkmcnt(4)
  v_mfma_f32_16x16x32_bf16 v[34:37], v[82:85], a[48:51], v[34:37]
  v_mfma_f32_16x16x32_bf16 v[54:57], v[82:85], a[128:131], v[54:57]
  ds_read_b64_tr_b16 v[66:67], v30 offset:56384
  ds_read_b64_tr_b16 v[68:69], v30 offset:58944
  s_waitcnt lgkmcnt(4)
  v_mfma_f32_16x16x32_bf16 v[14:17], v[86:89], a[68:71], v[14:17]
  v_mfma_f32_16x16x32_bf16 v[38:41], v[86:89], a[148:151], v[38:41]
  ds_read_b64_tr_b16 v[70:71], v33 offset:56384
  ds_read_b64_tr_b16 v[72:73], v33 offset:58944
  s_waitcnt lgkmcnt(4)
  v_mfma_f32_16x16x32_bf16 v[18:21], v[58:61], a[68:71], v[18:21]
  v_mfma_f32_16x16x32_bf16 v[42:45], v[58:61], a[148:151], v[42:45]
  ds_read_b64_tr_b16 v[74:75], v65 offset:56320
  ds_read_b64_tr_b16 v[76:77], v65 offset:58880
  s_waitcnt lgkmcnt(4)
  v_mfma_f32_16x16x32_bf16 v[22:25], v[66:69], a[68:71], v[22:25]
  v_mfma_f32_16x16x32_bf16 v[46:49], v[66:69], a[148:151], v[46:49]
  ds_read_b64_tr_b16 v[78:79], v13
  ds_read_b64_tr_b16 v[80:81], v13 offset:2560
  s_waitcnt lgkmcnt(4)
  v_mfma_f32_16x16x32_bf16 v[26:29], v[70:73], a[68:71], v[26:29]
  v_mfma_f32_16x16x32_bf16 v[50:53], v[70:73], a[148:151], v[50:53]
  ds_read_b64_tr_b16 v[82:83], v31
  ds_read_b64_tr_b16 v[84:85], v31 offset:2560
  s_waitcnt lgkmcnt(4)
  v_mfma_f32_16x16x32_bf16 v[34:37], v[74:77], a[68:71], v[34:37]
  v_mfma_f32_16x16x32_bf16 v[54:57], v[74:77], a[148:151], v[54:57]
  ds_read_b64_tr_b16 v[86:87], v13 offset:64
  ds_read_b64_tr_b16 v[88:89], v13 offset:2624
  s_waitcnt lgkmcnt(4)
  v_mfma_f32_16x16x32_bf16 v[14:17], v[78:81], a[12:15], v[14:17]
  v_mfma_f32_16x16x32_bf16 v[38:41], v[78:81], a[92:95], v[38:41]
  ds_read_b64_tr_b16 v[58:59], v31 offset:64
  ds_read_b64_tr_b16 v[60:61], v31 offset:2624
  s_waitcnt lgkmcnt(4)
  v_mfma_f32_16x16x32_bf16 v[18:21], v[82:85], a[12:15], v[18:21]
  v_mfma_f32_16x16x32_bf16 v[42:45], v[82:85], a[92:95], v[42:45]
  ds_read_b64_tr_b16 v[66:67], v62
  ds_read_b64_tr_b16 v[68:69], v62 offset:2560
  s_waitcnt lgkmcnt(4)
  v_mfma_f32_16x16x32_bf16 v[22:25], v[86:89], a[12:15], v[22:25]
  v_mfma_f32_16x16x32_bf16 v[46:49], v[86:89], a[92:95], v[46:49]
  ds_read_b64_tr_b16 v[70:71], v13 offset:5120
  ds_read_b64_tr_b16 v[72:73], v13 offset:7680
  s_waitcnt lgkmcnt(4)
  v_mfma_f32_16x16x32_bf16 v[26:29], v[58:61], a[12:15], v[26:29]
  v_mfma_f32_16x16x32_bf16 v[50:53], v[58:61], a[92:95], v[50:53]
  ds_read_b64_tr_b16 v[74:75], v31 offset:5120
  ds_read_b64_tr_b16 v[76:77], v31 offset:7680
  s_waitcnt lgkmcnt(4)
  v_mfma_f32_16x16x32_bf16 v[34:37], v[66:69], a[12:15], v[34:37]
  v_mfma_f32_16x16x32_bf16 v[54:57], v[66:69], a[92:95], v[54:57]
  ds_read_b64_tr_b16 v[78:79], v13 offset:5184
  ds_read_b64_tr_b16 v[80:81], v13 offset:7744
  s_waitcnt lgkmcnt(4)
  v_mfma_f32_16x16x32_bf16 v[14:17], v[70:73], a[32:35], v[14:17]
  v_mfma_f32_16x16x32_bf16 v[38:41], v[70:73], a[112:115], v[38:41]
  ds_read_b64_tr_b16 v[82:83], v31 offset:5184
  ds_read_b64_tr_b16 v[84:85], v31 offset:7744
  s_waitcnt lgkmcnt(4)
  v_mfma_f32_16x16x32_bf16 v[18:21], v[74:77], a[32:35], v[18:21]
  v_mfma_f32_16x16x32_bf16 v[42:45], v[74:77], a[112:115], v[42:45]
  ds_read_b64_tr_b16 v[86:87], v62 offset:5120
  ds_read_b64_tr_b16 v[88:89], v62 offset:7680
  s_waitcnt lgkmcnt(4)
  v_mfma_f32_16x16x32_bf16 v[22:25], v[78:81], a[32:35], v[22:25]
  v_mfma_f32_16x16x32_bf16 v[46:49], v[78:81], a[112:115], v[46:49]
  ds_read_b64_tr_b16 v[58:59], v13 offset:10240
  ds_read_b64_tr_b16 v[60:61], v13 offset:12800
  s_waitcnt lgkmcnt(4)
  v_mfma_f32_16x16x32_bf16 v[26:29], v[82:85], a[32:35], v[26:29]
  v_mfma_f32_16x16x32_bf16 v[50:53], v[82:85], a[112:115], v[50:53]
  ds_read_b64_tr_b16 v[66:67], v31 offset:10240
  ds_read_b64_tr_b16 v[68:69], v31 offset:12800
  s_waitcnt lgkmcnt(4)
  v_mfma_f32_16x16x32_bf16 v[34:37], v[86:89], a[32:35], v[34:37]
  v_mfma_f32_16x16x32_bf16 v[54:57], v[86:89], a[112:115], v[54:57]
  ds_read_b64_tr_b16 v[70:71], v13 offset:10304
  ds_read_b64_tr_b16 v[72:73], v13 offset:12864
  s_waitcnt lgkmcnt(4)
  v_mfma_f32_16x16x32_bf16 v[14:17], v[58:61], a[52:55], v[14:17]
  v_mfma_f32_16x16x32_bf16 v[38:41], v[58:61], a[132:135], v[38:41]
  ds_read_b64_tr_b16 v[74:75], v31 offset:10304
  ds_read_b64_tr_b16 v[76:77], v31 offset:12864
  s_waitcnt lgkmcnt(4)
  v_mfma_f32_16x16x32_bf16 v[18:21], v[66:69], a[52:55], v[18:21]
  v_mfma_f32_16x16x32_bf16 v[42:45], v[66:69], a[132:135], v[42:45]
  ds_read_b64_tr_b16 v[78:79], v62 offset:10240
  ds_read_b64_tr_b16 v[80:81], v62 offset:12800
  s_waitcnt lgkmcnt(4)
  v_mfma_f32_16x16x32_bf16 v[22:25], v[70:73], a[52:55], v[22:25]
  v_mfma_f32_16x16x32_bf16 v[46:49], v[70:73], a[132:135], v[46:49]
  ds_read_b64_tr_b16 v[82:83], v13 offset:15360
  ds_read_b64_tr_b16 v[84:85], v13 offset:17920
  s_waitcnt lgkmcnt(4)
  v_mfma_f32_16x16x32_bf16 v[26:29], v[74:77], a[52:55], v[26:29]
  v_mfma_f32_16x16x32_bf16 v[50:53], v[74:77], a[132:135], v[50:53]
  ds_read_b64_tr_b16 v[86:87], v31 offset:15360
  ds_read_b64_tr_b16 v[88:89], v31 offset:17920
  s_waitcnt lgkmcnt(4)
  v_mfma_f32_16x16x32_bf16 v[34:37], v[78:81], a[52:55], v[34:37]
  v_mfma_f32_16x16x32_bf16 v[54:57], v[78:81], a[132:135], v[54:57]
  ds_read_b64_tr_b16 v[58:59], v13 offset:15424
  ds_read_b64_tr_b16 v[60:61], v13 offset:17984
  s_waitcnt lgkmcnt(4)
  v_mfma_f32_16x16x32_bf16 v[14:17], v[82:85], a[72:75], v[14:17]
  v_mfma_f32_16x16x32_bf16 v[38:41], v[82:85], a[152:155], v[38:41]
  ds_read_b64_tr_b16 v[66:67], v31 offset:15424
  ds_read_b64_tr_b16 v[68:69], v31 offset:17984
  s_waitcnt lgkmcnt(4)
  v_mfma_f32_16x16x32_bf16 v[18:21], v[86:89], a[72:75], v[18:21]
  v_mfma_f32_16x16x32_bf16 v[42:45], v[86:89], a[152:155], v[42:45]
  ds_read_b64_tr_b16 v[70:71], v62 offset:15360
  ds_read_b64_tr_b16 v[72:73], v62 offset:17920
  s_waitcnt lgkmcnt(4)
  v_mfma_f32_16x16x32_bf16 v[22:25], v[58:61], a[72:75], v[22:25]
  v_mfma_f32_16x16x32_bf16 v[46:49], v[58:61], a[152:155], v[46:49]
  ds_read_b64_tr_b16 v[74:75], v90 offset:20480
  ds_read_b64_tr_b16 v[76:77], v90 offset:21120
  s_waitcnt lgkmcnt(4)
  v_mfma_f32_16x16x32_bf16 v[26:29], v[66:69], a[72:75], v[26:29]
  v_mfma_f32_16x16x32_bf16 v[50:53], v[66:69], a[152:155], v[50:53]
  ds_read_b64_tr_b16 v[78:79], v91 offset:20480
  ds_read_b64_tr_b16 v[80:81], v91 offset:21120
  s_waitcnt lgkmcnt(4)
  v_mfma_f32_16x16x32_bf16 v[34:37], v[70:73], a[72:75], v[34:37]
  v_mfma_f32_16x16x32_bf16 v[54:57], v[70:73], a[152:155], v[54:57]
  ds_read_b64_tr_b16 v[82:83], v90 offset:20544
  ds_read_b64_tr_b16 v[84:85], v90 offset:21184
  s_waitcnt lgkmcnt(4)
  v_mfma_f32_16x16x32_bf16 v[14:17], v[74:77], a[16:19], v[14:17]
  v_mfma_f32_16x16x32_bf16 v[38:41], v[74:77], a[96:99], v[38:41]
  ds_read_b64_tr_b16 v[86:87], v91 offset:20544
  ds_read_b64_tr_b16 v[88:89], v91 offset:21184
  s_waitcnt lgkmcnt(4)
  v_mfma_f32_16x16x32_bf16 v[18:21], v[78:81], a[16:19], v[18:21]
  v_mfma_f32_16x16x32_bf16 v[42:45], v[78:81], a[96:99], v[42:45]
  ds_read_b64_tr_b16 v[58:59], v92 offset:20480
  ds_read_b64_tr_b16 v[60:61], v92 offset:21120
  s_waitcnt lgkmcnt(4)
  v_mfma_f32_16x16x32_bf16 v[22:25], v[82:85], a[16:19], v[22:25]
  v_mfma_f32_16x16x32_bf16 v[46:49], v[82:85], a[96:99], v[46:49]
  ds_read_b64_tr_b16 v[66:67], v90 offset:25600
  ds_read_b64_tr_b16 v[68:69], v90 offset:26240
  s_waitcnt lgkmcnt(4)
  v_mfma_f32_16x16x32_bf16 v[26:29], v[86:89], a[16:19], v[26:29]
  v_mfma_f32_16x16x32_bf16 v[50:53], v[86:89], a[96:99], v[50:53]
  ds_read_b64_tr_b16 v[70:71], v91 offset:25600
  ds_read_b64_tr_b16 v[72:73], v91 offset:26240
  s_waitcnt lgkmcnt(4)
  v_mfma_f32_16x16x32_bf16 v[34:37], v[58:61], a[16:19], v[34:37]
  v_mfma_f32_16x16x32_bf16 v[54:57], v[58:61], a[96:99], v[54:57]
  ds_read_b64_tr_b16 v[74:75], v90 offset:25664
  ds_read_b64_tr_b16 v[76:77], v90 offset:26304
  s_waitcnt lgkmcnt(4)
  v_mfma_f32_16x16x32_bf16 v[14:17], v[66:69], a[36:39], v[14:17]
  v_mfma_f32_16x16x32_bf16 v[38:41], v[66:69], a[116:119], v[38:41]
  ds_read_b64_tr_b16 v[78:79], v91 offset:25664
  ds_read_b64_tr_b16 v[80:81], v91 offset:26304
  s_waitcnt lgkmcnt(4)
  v_mfma_f32_16x16x32_bf16 v[18:21], v[70:73], a[36:39], v[18:21]
  v_mfma_f32_16x16x32_bf16 v[42:45], v[70:73], a[116:119], v[42:45]
  ds_read_b64_tr_b16 v[82:83], v92 offset:25600
  ds_read_b64_tr_b16 v[84:85], v92 offset:26240
  s_waitcnt lgkmcnt(4)
  v_mfma_f32_16x16x32_bf16 v[22:25], v[74:77], a[36:39], v[22:25]
  v_mfma_f32_16x16x32_bf16 v[46:49], v[74:77], a[116:119], v[46:49]
  ds_read_b64_tr_b16 v[86:87], v90 offset:30720
  ds_read_b64_tr_b16 v[88:89], v90 offset:31360
  s_waitcnt lgkmcnt(4)
  v_mfma_f32_16x16x32_bf16 v[26:29], v[78:81], a[36:39], v[26:29]
  v_mfma_f32_16x16x32_bf16 v[50:53], v[78:81], a[116:119], v[50:53]
  ds_read_b64_tr_b16 v[58:59], v91 offset:30720
  ds_read_b64_tr_b16 v[60:61], v91 offset:31360
  s_waitcnt lgkmcnt(4)
  v_mfma_f32_16x16x32_bf16 v[34:37], v[82:85], a[36:39], v[34:37]
  v_mfma_f32_16x16x32_bf16 v[54:57], v[82:85], a[116:119], v[54:57]
  ds_read_b64_tr_b16 v[66:67], v90 offset:30784
  ds_read_b64_tr_b16 v[68:69], v90 offset:31424
  s_waitcnt lgkmcnt(4)
  v_mfma_f32_16x16x32_bf16 v[14:17], v[86:89], a[56:59], v[14:17]
  v_mfma_f32_16x16x32_bf16 v[38:41], v[86:89], a[136:139], v[38:41]
  ds_read_b64_tr_b16 v[70:71], v91 offset:30784
  ds_read_b64_tr_b16 v[72:73], v91 offset:31424
  s_waitcnt lgkmcnt(4)
  v_mfma_f32_16x16x32_bf16 v[18:21], v[58:61], a[56:59], v[18:21]
  v_mfma_f32_16x16x32_bf16 v[42:45], v[58:61], a[136:139], v[42:45]
  ds_read_b64_tr_b16 v[74:75], v92 offset:30720
  ds_read_b64_tr_b16 v[76:77], v92 offset:31360
  s_waitcnt lgkmcnt(4)
  v_mfma_f32_16x16x32_bf16 v[22:25], v[66:69], a[56:59], v[22:25]
  v_mfma_f32_16x16x32_bf16 v[46:49], v[66:69], a[136:139], v[46:49]
  ds_read_b64_tr_b16 v[78:79], v90 offset:35840
  ds_read_b64_tr_b16 v[80:81], v90 offset:36480
  s_waitcnt lgkmcnt(4)
  v_mfma_f32_16x16x32_bf16 v[26:29], v[70:73], a[56:59], v[26:29]
  v_mfma_f32_16x16x32_bf16 v[50:53], v[70:73], a[136:139], v[50:53]
  ds_read_b64_tr_b16 v[82:83], v91 offset:35840
  ds_read_b64_tr_b16 v[84:85], v91 offset:36480
  s_waitcnt lgkmcnt(4)
  v_mfma_f32_16x16x32_bf16 v[34:37], v[74:77], a[56:59], v[34:37]
  v_mfma_f32_16x16x32_bf16 v[54:57], v[74:77], a[136:139], v[54:57]
  ds_read_b64_tr_b16 v[86:87], v90 offset:35904
  ds_read_b64_tr_b16 v[88:89], v90 offset:36544
  s_waitcnt lgkmcnt(4)
  v_mfma_f32_16x16x32_bf16 v[14:17], v[78:81], a[76:79], v[14:17]
  v_mfma_f32_16x16x32_bf16 v[38:41], v[78:81], a[156:159], v[38:41]
  ds_read_b64_tr_b16 v[58:59], v91 offset:35904
  ds_read_b64_tr_b16 v[60:61], v91 offset:36544
  s_waitcnt lgkmcnt(4)
  v_mfma_f32_16x16x32_bf16 v[18:21], v[82:85], a[76:79], v[18:21]
  v_mfma_f32_16x16x32_bf16 v[42:45], v[82:85], a[156:159], v[42:45]
  ds_read_b64_tr_b16 v[66:67], v92 offset:35840
  ds_read_b64_tr_b16 v[68:69], v92 offset:36480
  s_waitcnt lgkmcnt(4)
  v_mfma_f32_16x16x32_bf16 v[22:25], v[86:89], a[76:79], v[22:25]
  v_mfma_f32_16x16x32_bf16 v[46:49], v[86:89], a[156:159], v[46:49]
  s_waitcnt lgkmcnt(2)
  v_mfma_f32_16x16x32_bf16 v[26:29], v[58:61], a[76:79], v[26:29]
  v_mfma_f32_16x16x32_bf16 v[50:53], v[58:61], a[156:159], v[50:53]
  s_waitcnt lgkmcnt(0)
  v_mfma_f32_16x16x32_bf16 v[34:37], v[66:69], a[76:79], v[34:37]
  v_mfma_f32_16x16x32_bf16 v[54:57], v[66:69], a[156:159], v[54:57]
  v_cvt_pk_bf16_f32 v104, v14, v15
  v_cvt_pk_bf16_f32 v105, v16, v17
  v_cvt_pk_bf16_f32 v106, v18, v19
  v_cvt_pk_bf16_f32 v107, v20, v21
  v_cvt_pk_bf16_f32 v108, v22, v23
  v_cvt_pk_bf16_f32 v109, v24, v25
  v_cvt_pk_bf16_f32 v110, v26, v27
  v_cvt_pk_bf16_f32 v111, v28, v29
  v_cmp_u_f32 vcc, v14, v38
  s_nop 4
  s_cbranch_vccnz L_redoA
  s_branch L_stA
L_B:
  s_getpc_b64 s[100:101]
L_pcB:
  s_mov_b32 s27, L_end-L_pcB-192
  s_lshl_b32 s26, s3, 2
  s_add_u32 s26, s26, s22
  s_lshl_b32 s26, s26, 8
  s_min_u32 s26, s26, s27
  s_add_u32 s100, s100, s26
  s_addc_u32 s101, s101, 0
  s_load_dword s0, s[100:101], 0
  s_load_dword s0, s[100:101], 64
  s_load_dword s0, s[100:101], 128
  s_load_dword s0, s[100:101], 192
  s_mov_b32 s40, s14
  s_and_b32 s41, s15, 0xffff
  s_mov_b32 s42, 0xc8000
  s_mov_b32 s43, 0x20000
  s_mov_b32 s36, s20
  s_and_b32 s37, s21, 0xffff
  s_mov_b32 s38, 0x800000
  s_mov_b32 s39, 0x20000
  s_mov_b32 s44, s18
  s_and_b32 s45, s19, 0xffff
  s_mov_b32 s46, 0x100
  s_mov_b32 s47, 0x20000
  s_mov_b32 s48, s16
  s_and_b32 s49, s17, 0xffff
  s_mov_b32 s50, 0x500000
  s_mov_b32 s51, 0x20000
  s_mul_i32 s75, s76, 0x780
  s_add_u32 s75, s75, s81
  s_add_u32 s75, s75, 0xa00
  s_add_u32 m0, s74, 0x5000
  s_nop 0
  buffer_load_dwordx4 v10, s[32:35], s75 offen lds
  buffer_load_dwordx4 v11, s[32:35], s75 offen offset:1024 lds
  buffer_load_dwordx4 v12, s[32:35], s75 offen offset:2048 lds
  buffer_load_dwordx4 v13, s[32:35], s75 offen offset:3072 lds
  s_add_u32 m0, s74, 0x6000
  s_nop 0
  buffer_load_dwordx4 v14, s[32:35], s75 offen lds
  v_lshrrev_b32 v4, 1, v3
  v_lshlrev_b32 v4, 4, v4
  v_and_b32 v5, 1, v3
  v_lshl_add_u32 v4, v5, 2, v4
  v_bfe_u32 v5, v1, 2, 2
  v_add_u32 v4, v5, v4
  v_mul_u32_u24 v4, 0xa0, v4
  v_and_b32 v5, 3, v1
  v_lshl_add_u32 v4, v5, 3, v4
  s_xor_b32 s27, s22, 0
  s_mul_i32 s27, s27, 0x1400
  v_add_u32 v9, s27, v4
  v_add_u32 v23, 0xf000, v9
  s_xor_b32 s27, s22, 1
  s_mul_i32 s27, s27, 0x1400
  v_add_u32 v24, s27, v4
  v_add_u32 v25, 0xf000, v24
  s_xor_b32 s27, s22, 2
  s_mul_i32 s27, s27, 0x1400
  v_add_u32 v26, s27, v4
  v_add_u32 v27, 0xf000, v26
  s_xor_b32 s27, s22, 3
  s_mul_i32 s27, s27, 0x1400
  v_add_u32 v28, s27, v4
  v_add_u32 v29, 0xf000, v28
  v_bfe_u32 v4, v1, 2, 1
  v_lshlrev_b32 v4, 1, v4
  v_xor_b32 v4, v4, v3
  v_lshlrev_b32 v4, 4, v4
  v_lshl_add_u32 v4, v2, 6, v4
  v_add_u32 v30, s82, v4
  v_bfe_u32 v4, v1, 2, 1
  v_lshlrev_b32 v4, 1, v4
  v_xor_b32 v4, v4, v3
  v_bfe_u32 v5, v1, 1, 1
  v_xor_b32 v5, s22, v5
  v_and_b32 v5, 1, v5
  v_lshl_add_u32 v4, v5, 2, v4
  v_lshlrev_b32 v4, 4, v4
  v_lshl_add_u32 v4, v2, 7, v4
  v_add_u32 v31, s82, v4
  v_xor_b32 v32, 64, v31
  v_lshlrev_b32 v7, 3, v1
  v_mov_b32 v34, 0x358637bd
  v_mov_b32 v35, 0x358637bd
  v_mov_b32 v36, 0x358637bd
  v_mov_b32 v37, 0x358637bd
  s_mov_b32 s52, 0xffff0000
  s_mov_b32 s53, 0xffffffff
  s_mov_b32 s54, 0
  s_mov_b32 s55, 0xffffffff
  s_mov_b32 s56, 0
  s_mov_b32 s57, 0xffff0000
  s_lshl_b32 s26, s23, 2
  s_add_u32 s26, s26, s22
  s_mul_i32 s26, s26, 0xa000
  s_add_u32 s26, s26, 0x280000
  s_lshr_b32 s27, s24, 1
  s_mul_i32 s27, s27, 0x1400
  s_add_u32 s26, s26, s27
  s_and_b32 s27, s24, 1
  s_lshl_b32 s100, s27, 11
  s_add_u32 s94, s26, s100
  s_add_u32 s95, s94, 0x5000
  s_lshl_b32 s100, s27, 9
  s_add_u32 s96, s26, s100
  s_add_u32 s96, s96, 0x1000
  s_add_u32 s97, s96, 0x5000
  s_lshl_b32 s26, s72, 2
  s_add_u32 s26, s26, s22
  s_mul_i32 s91, s26, 0xa000
  s_add_u32 s91, s91, 0x280000
  v_mov_b32 v33, 0x40000000
  s_cmp_eq_u32 s22, 0
  s_cselect_b32 s27, 0, 0x40000000
  s_lshl_b32 s26, s23, 2
  s_add_u32 s26, s26, s27
  s_add_u32 s26, s26, 64
  v_writelane_b32 v33, s26, 0
  s_lshl_b32 s26, s24, 2
  s_add_u32 s26, s26, s27
  s_add_u32 s26, s26, 0x80
  v_writelane_b32 v33, s26, 1
  s_lshl_b32 s26, s72, 2
  s_add_u32 s26, s26, 64
  v_mov_b32 v66, s26
  s_lshl_b32 s26, s24, 2
  s_add_u32 s26, s26, s22
  s_lshl_b32 s85, s26, 15
  s_add_u32 s85, s85, 0x500000
  s_lshl_b32 s86, s26, 11
  s_add_u32 s86, s86, 0x600000
  s_lshl_b32 s26, s23, 7
  s_add_u32 s98, s85, s26
  s_cmp_lt_u32 s23, 14
  s_cselect_b32 s26, s26, 0x40000000
  s_lshl_b32 s27, s23, 11
  s_cmp_lt_u32 s23, 14
  s_cselect_b32 s27, s27, 0x40000000
  v_add_u32 v68, s27, v6
  v_and_b32 v5, 7, v1
  v_lshl_add_u32 v5, v5, 4, s26
  v_lshl_add_u32 v69, v3, 2, v5
  s_mul_i32 s26, s73, 0xa0
  s_mov_b32 s84, 0x460
  v_add_u32 v75, s26, v6
  v_mov_b32 v4, v8
  v_lshrrev_b32 v4, 16, v4
  v_mad_u32_u24 v70, v4, s84, v75
  v_add_u32 v4, 0x66680, v8
  v_lshrrev_b32 v4, 16, v4
  v_mad_u32_u24 v71, v4, s84, v75
  v_add_u32 v4, 0xccd00, v8
  v_lshrrev_b32 v4, 16, v4
  v_mad_u32_u24 v72, v4, s84, v75
  v_add_u32 v4, 0x133380, v8
  v_lshrrev_b32 v4, 16, v4
  v_mad_u32_u24 v73, v4, s84, v75
  v_add_u32 v4, 0x199a00, v8
  v_lshrrev_b32 v4, 16, v4
  v_mad_u32_u24 v74, v4, s84, v75
  v_add_u32 v74, 0x1000, v74
  v_add_u32 v4, 0x14000, v72
  v_cndmask_b32_e64 v75, v72, v4, s[54:55]
  s_mov_b32 s88, 0x3fb8aa3b
  s_mov_b32 s89, 0x3fb8aa3b
  v_mov_b32 v76, 0xb5c1a2a0
  v_mov_b32 v77, 0xb5c1a2a0
  v_add_u32 v8, s82, v6
  s_mul_i32 s99, s22, 20
  v_add_u32 v4, s99, v2
  v_lshrrev_b32 v5, 4, v4
  v_lshlrev_b32 v5, 6, v5
  v_and_b32 v82, 15, v4
  v_add_u32 v82, v82, v5
  v_lshl_add_u32 v82, v3, 4, v82
  v_lshlrev_b32 v82, 4, v82
  v_add_u32 v82, 0x1e000, v82
  v_and_b32 v4, 3, v2
  v_add3_u32 v4, v4, s99, 16
  v_lshrrev_b32 v5, 4, v4
  v_lshlrev_b32 v5, 6, v5
  v_and_b32 v85, 15, v4
  v_add_u32 v85, v85, v5
  v_lshl_add_u32 v85, v3, 4, v85
  v_lshlrev_b32 v85, 4, v85
  v_add_u32 v85, 0x1e000, v85
  s_mov_b32 s58, 0xf000f
  s_mov_b32 s59, 0xf000f
  s_mov_b32 s60, 0xf000f0
  s_mov_b32 s61, 0xf000f0
  v_mov_b32 v4, 0x1f400
  v_cndmask_b32_e64 v83, v4, v85, s[58:59]
  v_cndmask_b32_e64 v84, v4, v85, s[60:61]
  v_mov_b32 v4, 0x1cc00
  v_cndmask_b32_e64 v85, v4, v85, s[58:59]
  v_lshrrev_b32 v5, 3, v1
  v_lshlrev_b32 v5, 11, v5
  v_and_b32 v86, 7, v1
  v_lshl_add_u32 v86, v86, 4, v5
  v_min_u32 v4, 4, v2
  v_mad_u32_u24 v4, v3, 5, v4
  v_add_u32 v4, 64, v4
  v_lshlrev_b32 v87, 4, v4
  v_lshrrev_b32 v5, 3, v4
  v_lshlrev_b32 v5, 11, v5
  v_and_b32 v89, 7, v4
  v_lshl_add_u32 v89, v89, 4, v5
  s_mov_b32 s62, 0x1f0000
  s_mov_b32 s63, 0
  v_add_u32 v4, 0x64, v2
  v_add_u32 v90, 0x54, v2
  v_cndmask_b32_e64 v88, v90, v4, s[62:63]
  v_lshlrev_b32 v88, 4, v88
  v_add_u32 v4, 0x54, v1
  v_lshrrev_b32 v5, 3, v4
  v_lshlrev_b32 v5, 11, v5
  v_and_b32 v90, 7, v4
  v_lshl_add_u32 v90, v90, 4, v5
  v_mov_b32 v5, 0x40000000
  s_mov_b32 s100, 0x1f001f
  s_mov_b32 s101, 0x1f001f
  v_cndmask_b32_e64 v89, v5, v89, s[100:101]
  s_mov_b32 s100, 0xfffffff
  s_mov_b32 s101, 0
  v_cndmask_b32_e64 v90, v5, v90, s[100:101]
  s_mul_i32 s26, s22, 5
  v_add_u32 v4, s26, v3
  v_lshrrev_b32 v5, 3, v4
  v_lshlrev_b32 v94, 6, v5
  v_and_b32 v5, 3, v4
  v_lshl_add_u32 v94, v5, 4, v94
  v_bfe_u32 v5, v4, 2, 1
  v_lshl_add_u32 v94, v5, 3, v94
  v_add_u32 v94, 0x1e000, v94
  s_mov_b32 s83, 0xd0
  v_add_u32 v4, s99, v2
  v_mad_u32_u24 v91, v4, s83, v94
  v_add3_u32 v4, v2, s99, 16
  s_add_u32 s27, s22, 0x50
  v_mov_b32 v5, s27
  v_cndmask_b32_e64 v95, v5, v4, s[58:59]
  v_mad_u32_u24 v92, v95, s83, v94
  s_mul_i32 s26, s22, 5
  s_add_u32 s26, s26, 4
  v_mov_b32 v4, s26
  v_lshrrev_b32 v5, 3, v4
  v_lshlrev_b32 v94, 6, v5
  v_and_b32 v5, 3, v4
  v_lshl_add_u32 v94, v5, 4, v94
  v_bfe_u32 v5, v4, 2, 1
  v_lshl_add_u32 v94, v5, 3, v94
  v_add_u32 v94, 0x1e000, v94
  v_add_u32 v4, s99, v2
  v_cndmask_b32_e64 v4, v4, v95, s[62:63]
  v_mad_u32_u24 v93, v4, s83, v94
  v_lshlrev_b32 v5, 4, v3
  v_add_u32 v5, 0x1e000, v5
  v_mad_u32_u24 v94, v2, s83, v5
  v_and_b32 v4, 3, v2
  v_add_u32 v4, 0x50, v4
  v_mad_u32_u24 v95, v4, s83, v5
  v_lshlrev_b32 v96, 4, v0
  v_add_u32 v96, 0x1e000, v96
  s_lshl_b32 s26, s24, 2
  s_add_u32 s26, s26, 0x80
  v_mov_b32 v98, s26
  s_mul_i32 s75, s77, 0x780
  s_add_u32 s75, s75, s81
  s_add_u32 s75, s75, 0x500
  s_add_u32 m0, s74, 0xa000
  s_nop 0
  buffer_load_dwordx4 v10, s[32:35], s75 offen lds
  buffer_load_dwordx4 v11, s[32:35], s75 offen offset:1024 lds
  buffer_load_dwordx4 v12, s[32:35], s75 offen offset:2048 lds
  buffer_load_dwordx4 v13, s[32:35], s75 offen offset:3072 lds
  s_add_u32 m0, s74, 0xb000
  s_nop 0
  buffer_load_dwordx4 v14, s[32:35], s75 offen lds
  s_waitcnt vmcnt(18)
  s_barrier
  v_mov_b32 v100, -1
  v_mov_b32 v101, -1
  v_mov_b32 v102, -1
  v_mov_b32 v103, -1
  buffer_store_dwordx4 v[100:103], v6, s[36:39], s94 offen sc1
  buffer_store_dwordx4 v[100:103], v6, s[36:39], s94 offen offset:1024 sc1
  buffer_store_dwordx2 v[100:101], v7, s[36:39], s96 offen sc1
  buffer_store_dwordx4 v[100:103], v6, s[36:39], s95 offen sc1
  buffer_store_dwordx4 v[100:103], v6, s[36:39], s95 offen offset:1024 sc1
  buffer_store_dwordx2 v[100:101], v7, s[36:39], s97 offen sc1
  v_mov_b32 v104, 0
  v_mov_b32 v105, 0
  v_mov_b32 v106, 0
  v_mov_b32 v107, 0
  buffer_store_dwordx4 v[100:103], v68, s[36:39], s85 offen sc1
  buffer_store_dwordx4 v[100:103], v68, s[36:39], s85 offen offset:1024 sc1
  buffer_store_dword v100, v69, s[36:39], s86 offen sc1
  s_waitcnt vmcnt(25)
  ds_read_b128 a[0:3], v31
  ds_read_b128 a[4:7], v32
  s_waitcnt vmcnt(23)
  ds_read_b128 a[80:83], v31 offset:2048
  ds_read_b128 a[84:87], v32 offset:2048
  ds_read_b64_tr_b16 v[38:39], v9
  ds_read_b64_tr_b16 v[40:41], v9 offset:1280
  ds_read_b64_tr_b16 v[42:43], v9 offset:32
  ds_read_b64_tr_b16 v[44:45], v9 offset:1312
  ds_read_b64_tr_b16 v[46:47], v9 offset:64
  ds_read_b64_tr_b16 v[48:49], v9 offset:1344
  ds_read_b64_tr_b16 v[50:51], v9 offset:96
  ds_read_b64_tr_b16 v[52:53], v9 offset:1376
  ds_read_b64_tr_b16 v[54:55], v9 offset:128
  ds_read_b64_tr_b16 v[56:57], v9 offset:1408
  ds_read_b64_tr_b16 v[58:59], v24
  ds_read_b64_tr_b16 v[60:61], v24 offset:1280
  s_waitcnt lgkmcnt(10)
  v_mfma_f32_16x16x32_bf16 v[108:111], a[0:3], v[38:41], v[34:37]
  ds_read_b64_tr_b16 v[62:63], v24 offset:32
  s_add_u32 m0, s82, 0x2000
  v_mfma_f32_16x16x32_bf16 v[120:123], a[80:83], v[38:41], v[34:37]
  s_waitcnt lgkmcnt(9)
  ds_read_b64_tr_b16 v[64:65], v24 offset:1312
  v_mfma_f32_16x16x32_bf16 v[124:127], a[0:3], v[42:45], v[34:37]
  ds_read_b64_tr_b16 v[38:39], v24 offset:64
  v_mfma_f32_16x16x32_bf16 v[128:131], a[80:83], v[42:45], v[34:37]
  s_waitcnt lgkmcnt(9)
  ds_read_b64_tr_b16 v[40:41], v24 offset:1344
  v_mfma_f32_16x16x32_bf16 v[132:135], a[0:3], v[46:49], v[34:37]
  ds_read_b64_tr_b16 v[42:43], v24 offset:96
  v_mfma_f32_16x16x32_bf16 v[136:139], a[80:83], v[46:49], v[34:37]
  s_waitcnt lgkmcnt(9)
  ds_read_b64_tr_b16 v[44:45], v24 offset:1376
  buffer_load_dwordx4 v15, s[28:31], s77 offen lds
  v_mfma_f32_16x16x32_bf16 v[140:143], a[0:3], v[50:53], v[34:37]
  ds_read_b64_tr_b16 v[46:47], v24 offset:128
  v_mfma_f32_16x16x32_bf16 v[144:147], a[80:83], v[50:53], v[34:37]
  s_waitcnt lgkmcnt(9)
  ds_read_b64_tr_b16 v[48:49], v24 offset:1408
  v_mfma_f32_16x16x32_bf16 v[148:151], a[0:3], v[54:57], v[34:37]
  s_waitcnt vmcnt(22)
  ds_read_b128 a[8:11], v31 offset:4096
  ds_read_b128 a[12:15], v32 offset:4096
  s_waitcnt vmcnt(20)
  ds_read_b128 a[88:91], v31 offset:6144
  ds_read_b128 a[92:95], v32 offset:6144
  ds_read_b64_tr_b16 v[50:51], v26
  buffer_load_dwordx4 v16, s[28:31], s77 offen offset:1024 lds
  v_mfma_f32_16x16x32_bf16 v[152:155], a[80:83], v[54:57], v[34:37]
  s_waitcnt lgkmcnt(13)
  ds_read_b64_tr_b16 v[52:53], v26 offset:1280
  s_add_u32 m0, s82, 0
  v_mfma_f32_16x16x32_bf16 v[108:111], a[4:7], v[58:61], v[108:111]
  ds_read_b64_tr_b16 v[54:55], v26 offset:32
  v_mfma_f32_16x16x32_bf16 v[120:123], a[84:87], v[58:61], v[120:123]
  s_waitcnt lgkmcnt(13)
  ds_read_b64_tr_b16 v[56:57], v26 offset:1312
  buffer_load_dwordx4 v17, s[28:31], s77 offen lds
  v_mfma_f32_16x16x32_bf16 v[124:127], a[4:7], v[62:65], v[124:127]
  ds_read_b64_tr_b16 v[58:59], v26 offset:64
  v_mfma_f32_16x16x32_bf16 v[128:131], a[84:87], v[62:65], v[128:131]
  s_waitcnt lgkmcnt(13)
  ds_read_b64_tr_b16 v[60:61], v26 offset:1344
  v_mfma_f32_16x16x32_bf16 v[132:135], a[4:7], v[38:41], v[132:135]
  ds_read_b64_tr_b16 v[62:63], v26 offset:96
  buffer_load_dwordx4 v18, s[28:31], s77 offen offset:1024 lds
  v_mfma_f32_16x16x32_bf16 v[136:139], a[84:87], v[38:41], v[136:139]
  s_waitcnt lgkmcnt(13)
  ds_read_b64_tr_b16 v[64:65], v26 offset:1376
  s_add_u32 m0, s82, 0x800
  v_mfma_f32_16x16x32_bf16 v[140:143], a[4:7], v[42:45], v[140:143]
  ds_read_b64_tr_b16 v[38:39], v26 offset:128
  v_mfma_f32_16x16x32_bf16 v[144:147], a[84:87], v[42:45], v[144:147]
  s_waitcnt lgkmcnt(13)
  ds_read_b64_tr_b16 v[40:41], v26 offset:1408
  buffer_load_dwordx4 v19, s[28:31], s77 offen lds
  v_mfma_f32_16x16x32_bf16 v[148:151], a[4:7], v[46:49], v[148:151]
  ds_read_b64_tr_b16 v[42:43], v28
  v_mfma_f32_16x16x32_bf16 v[152:155], a[84:87], v[46:49], v[152:155]
  s_waitcnt lgkmcnt(9)
  ds_read_b64_tr_b16 v[44:45], v28 offset:1280
  v_mfma_f32_16x16x32_bf16 v[108:111], a[8:11], v[50:53], v[108:111]
  ds_read_b64_tr_b16 v[46:47], v28 offset:32
  buffer_load_dwordx4 v20, s[28:31], s77 offen offset:1024 lds
  v_mfma_f32_16x16x32_bf16 v[120:123], a[88:91], v[50:53], v[120:123]
  s_waitcnt lgkmcnt(9)
  ds_read_b64_tr_b16 v[48:49], v28 offset:1312
  s_add_u32 m0, s82, 0x1000
  v_mfma_f32_16x16x32_bf16 v[124:127], a[8:11], v[54:57], v[124:127]
  ds_read_b64_tr_b16 v[50:51], v28 offset:64
  v_mfma_f32_16x16x32_bf16 v[128:131], a[88:91], v[54:57], v[128:131]
  s_waitcnt lgkmcnt(9)
  ds_read_b64_tr_b16 v[52:53], v28 offset:1344
  buffer_load_dwordx4 v21, s[28:31], s77 offen lds
  v_mfma_f32_16x16x32_bf16 v[132:135], a[8:11], v[58:61], v[132:135]
  ds_read_b64_tr_b16 v[54:55], v28 offset:96
  v_mfma_f32_16x16x32_bf16 v[136:139], a[88:91], v[58:61], v[136:139]
  s_waitcnt lgkmcnt(9)
  ds_read_b64_tr_b16 v[56:57], v28 offset:1376
  v_mfma_f32_16x16x32_bf16 v[140:143], a[8:11], v[62:65], v[140:143]
  ds_read_b64_tr_b16 v[58:59], v28 offset:128
  buffer_load_dwordx4 v22, s[28:31], s77 offen offset:1024 lds
  v_mfma_f32_16x16x32_bf16 v[144:147], a[88:91], v[62:65], v[144:147]
  s_waitcnt lgkmcnt(9)
  ds_read_b64_tr_b16 v[60:61], v28 offset:1408
  s_mul_i32 s75, s77, 0x780
  s_add_u32 s75, s75, s81
  v_mfma_f32_16x16x32_bf16 v[148:151], a[8:11], v[38:41], v[148:151]
  s_waitcnt vmcnt(22)
  s_barrier
  ds_read_b64_tr_b16 v[62:63], v9 offset:20480
  s_add_u32 s75, s75, 0xa00
  s_add_u32 m0, s74, 0xf000
  v_mfma_f32_16x16x32_bf16 v[152:155], a[88:91], v[38:41], v[152:155]
  s_waitcnt lgkmcnt(9)
  ds_read_b64_tr_b16 v[64:65], v9 offset:21760
  buffer_load_dwordx4 v10, s[32:35], s75 offen lds
  v_mfma_f32_16x16x32_bf16 v[108:111], a[12:15], v[42:45], v[108:111]
  ds_read_b64_tr_b16 v[38:39], v9 offset:20512
  v_mfma_f32_16x16x32_bf16 v[120:123], a[92:95], v[42:45], v[120:123]
  s_waitcnt lgkmcnt(9)
  ds_read_b64_tr_b16 v[40:41], v9 offset:21792
  v_mfma_f32_16x16x32_bf16 v[124:127], a[12:15], v[46:49], v[124:127]
  ds_read_b64_tr_b16 v[42:43], v9 offset:20544
  v_mfma_f32_16x16x32_bf16 v[128:131], a[92:95], v[46:49], v[128:131]
  s_waitcnt lgkmcnt(9)
  ds_read_b64_tr_b16 v[44:45], v9 offset:21824
  v_mfma_f32_16x16x32_bf16 v[132:135], a[12:15], v[50:53], v[132:135]
  ds_read_b64_tr_b16 v[46:47], v9 offset:20576
  v_mfma_f32_16x16x32_bf16 v[136:139], a[92:95], v[50:53], v[136:139]
  s_waitcnt lgkmcnt(9)
  ds_read_b64_tr_b16 v[48:49], v9 offset:21856
  buffer_load_dwordx4 v11, s[32:35], s75 offen offset:1024 lds
  v_mfma_f32_16x16x32_bf16 v[140:143], a[12:15], v[54:57], v[140:143]
  ds_read_b64_tr_b16 v[50:51], v9 offset:20608
  v_mfma_f32_16x16x32_bf16 v[144:147], a[92:95], v[54:57], v[144:147]
  s_waitcnt lgkmcnt(9)
  ds_read_b64_tr_b16 v[52:53], v9 offset:21888
  v_mfma_f32_16x16x32_bf16 v[148:151], a[12:15], v[58:61], v[148:151]
  ds_read_b64_tr_b16 v[54:55], v24 offset:20480
  v_mfma_f32_16x16x32_bf16 v[152:155], a[92:95], v[58:61], v[152:155]
  s_waitcnt lgkmcnt(9)
  ds_read_b64_tr_b16 v[56:57], v24 offset:21760
  v_mfma_f32_16x16x32_bf16 v[156:159], a[0:3], v[62:65], 0
  ds_read_b64_tr_b16 v[58:59], v24 offset:20512
  v_mfma_f32_16x16x32_bf16 v[160:163], a[80:83], v[62:65], 0
  s_waitcnt lgkmcnt(9)
  ds_read_b64_tr_b16 v[60:61], v24 offset:21792
  buffer_load_dwordx4 v12, s[32:35], s75 offen offset:2048 lds
  v_mfma_f32_16x16x32_bf16 v[164:167], a[0:3], v[38:41], 0
  ds_read_b64_tr_b16 v[62:63], v24 offset:20544
  v_mfma_f32_16x16x32_bf16 v[168:171], a[80:83], v[38:41], 0
  s_waitcnt lgkmcnt(9)
  ds_read_b64_tr_b16 v[64:65], v24 offset:21824
  v_mfma_f32_16x16x32_bf16 v[172:175], a[0:3], v[42:45], 0
  ds_read_b64_tr_b16 v[38:39], v24 offset:20576
  v_mfma_f32_16x16x32_bf16 v[176:179], a[80:83], v[42:45], 0
  s_waitcnt lgkmcnt(9)
  ds_read_b64_tr_b16 v[40:41], v24 offset:21856
  v_mfma_f32_16x16x32_bf16 v[180:183], a[0:3], v[46:49], 0
  ds_read_b64_tr_b16 v[42:43], v24 offset:20608
  v_mfma_f32_16x16x32_bf16 v[184:187], a[80:83], v[46:49], 0
  s_waitcnt lgkmcnt(9)
  ds_read_b64_tr_b16 v[44:45], v24 offset:21888
  buffer_load_dwordx4 v13, s[32:35], s75 offen offset:3072 lds
  v_mfma_f32_16x16x32_bf16 v[188:191], a[0:3], v[50:53], 0
  ds_read_b64_tr_b16 v[46:47], v26 offset:20480
  s_add_u32 m0, s74, 0x10000
  v_mfma_f32_16x16x32_bf16 v[192:195], a[80:83], v[50:53], 0
  s_waitcnt lgkmcnt(9)
  ds_read_b64_tr_b16 v[48:49], v26 offset:21760
  v_mfma_f32_16x16x32_bf16 v[156:159], a[4:7], v[54:57], v[156:159]
  ds_read_b64_tr_b16 v[50:51], v26 offset:20512
  v_mfma_f32_16x16x32_bf16 v[160:163], a[84:87], v[54:57], v[160:163]
  s_waitcnt lgkmcnt(9)
  ds_read_b64_tr_b16 v[52:53], v26 offset:21792
  v_mfma_f32_16x16x32_bf16 v[164:167], a[4:7], v[58:61], v[164:167]
  ds_read_b64_tr_b16 v[54:55], v26 offset:20544
  v_mfma_f32_16x16x32_bf16 v[168:171], a[84:87], v[58:61], v[168:171]
  s_waitcnt lgkmcnt(9)
  ds_read_b64_tr_b16 v[56:57], v26 offset:21824
  buffer_load_dwordx4 v14, s[32:35], s75 offen lds
  v_mfma_f32_16x16x32_bf16 v[172:175], a[4:7], v[62:65], v[172:175]
  ds_read_b64_tr_b16 v[58:59], v26 offset:20576
  s_mul_i32 s75, s78, 0x780
  s_add_u32 s75, s75, s81
  v_mfma_f32_16x16x32_bf16 v[176:179], a[84:87], v[62:65], v[176:179]
  s_waitcnt lgkmcnt(9)
  ds_read_b64_tr_b16 v[60:61], v26 offset:21856
  s_add_u32 s75, s75, 0x500
  s_add_u32 m0, s74, 0x14000
  v_mfma_f32_16x16x32_bf16 v[180:183], a[4:7], v[38:41], v[180:183]
  ds_read_b64_tr_b16 v[62:63], v26 offset:20608
  v_mfma_f32_16x16x32_bf16 v[184:187], a[84:87], v[38:41], v[184:187]
  s_waitcnt lgkmcnt(9)
  ds_read_b64_tr_b16 v[64:65], v26 offset:21888
  v_mfma_f32_16x16x32_bf16 v[188:191], a[4:7], v[42:45], v[188:191]
  ds_read_b64_tr_b16 v[38:39], v28 offset:20480
  v_mfma_f32_16x16x32_bf16 v[192:195], a[84:87], v[42:45], v[192:195]
  s_waitcnt lgkmcnt(9)
  ds_read_b64_tr_b16 v[40:41], v28 offset:21760
  buffer_load_dwordx4 v10, s[32:35], s75 offen lds
  v_mfma_f32_16x16x32_bf16 v[156:159], a[8:11], v[46:49], v[156:159]
  ds_read_b64_tr_b16 v[42:43], v28 offset:20512
  v_mfma_f32_16x16x32_bf16 v[160:163], a[88:91], v[46:49], v[160:163]
  s_waitcnt lgkmcnt(9)
  ds_read_b64_tr_b16 v[44:45], v28 offset:21792
  v_mfma_f32_16x16x32_bf16 v[164:167], a[8:11], v[50:53], v[164:167]
  ds_read_b64_tr_b16 v[46:47], v28 offset:20544
  v_mfma_f32_16x16x32_bf16 v[168:171], a[88:91], v[50:53], v[168:171]
  s_waitcnt lgkmcnt(9)
  ds_read_b64_tr_b16 v[48:49], v28 offset:21824
  v_mfma_f32_16x16x32_bf16 v[172:175], a[8:11], v[54:57], v[172:175]
  ds_read_b64_tr_b16 v[50:51], v28 offset:20576
  v_mfma_f32_16x16x32_bf16 v[176:179], a[88:91], v[54:57], v[176:179]
  s_waitcnt lgkmcnt(9)
  ds_read_b64_tr_b16 v[52:53], v28 offset:21856
  buffer_load_dwordx4 v11, s[32:35], s75 offen offset:1024 lds
  v_mfma_f32_16x16x32_bf16 v[180:183], a[8:11], v[58:61], v[180:183]
  ds_read_b64_tr_b16 v[54:55], v28 offset:20608
  v_mfma_f32_16x16x32_bf16 v[184:187], a[88:91], v[58:61], v[184:187]
  s_waitcnt lgkmcnt(9)
  ds_read_b64_tr_b16 v[56:57], v28 offset:21888
  v_mfma_f32_16x16x32_bf16 v[188:191], a[8:11], v[62:65], v[188:191]
  s_waitcnt vmcnt(24)
  s_barrier
  s_waitcnt vmcnt(13)
  ds_read_b128 a[16:19], v31 offset:8192
  ds_read_b128 a[20:23], v32 offset:8192
  s_waitcnt vmcnt(11)
  ds_read_b128 a[96:99], v31
  ds_read_b128 a[100:103], v32
  ds_read_b64_tr_b16 v[58:59], v9 offset:40960
  v_mfma_f32_16x16x32_bf16 v[192:195], a[88:91], v[62:65], v[192:195]
  s_waitcnt lgkmcnt(13)
  ds_read_b64_tr_b16 v[60:61], v9 offset:42240
  v_mfma_f32_16x16x32_bf16 v[156:159], a[12:15], v[38:41], v[156:159]
  ds_read_b64_tr_b16 v[62:63], v9 offset:40992
  v_mfma_f32_16x16x32_bf16 v[160:163], a[92:95], v[38:41], v[160:163]
  s_waitcnt lgkmcnt(13)
  ds_read_b64_tr_b16 v[64:65], v9 offset:42272
  buffer_load_dwordx4 v12, s[32:35], s75 offen offset:2048 lds
  v_mfma_f32_16x16x32_bf16 v[164:167], a[12:15], v[42:45], v[164:167]
  ds_read_b64_tr_b16 v[38:39], v9 offset:41024
  v_mfma_f32_16x16x32_bf16 v[168:171], a[92:95], v[42:45], v[168:171]
  s_waitcnt lgkmcnt(13)
  ds_read_b64_tr_b16 v[40:41], v9 offset:42304
  v_mfma_f32_16x16x32_bf16 v[172:175], a[12:15], v[46:49], v[172:175]
  ds_read_b64_tr_b16 v[42:43], v9 offset:41056
  v_mfma_f32_16x16x32_bf16 v[176:179], a[92:95], v[46:49], v[176:179]
  s_waitcnt lgkmcnt(13)
  ds_read_b64_tr_b16 v[44:45], v9 offset:42336
  v_mfma_f32_16x16x32_bf16 v[180:183], a[12:15], v[50:53], v[180:183]
  ds_read_b64_tr_b16 v[46:47], v9 offset:41088
  v_mfma_f32_16x16x32_bf16 v[184:187], a[92:95], v[50:53], v[184:187]
  s_waitcnt lgkmcnt(13)
  ds_read_b64_tr_b16 v[48:49], v9 offset:42368
  buffer_load_dwordx4 v13, s[32:35], s75 offen offset:3072 lds
  v_mfma_f32_16x16x32_bf16 v[188:191], a[12:15], v[54:57], v[188:191]
  ds_read_b64_tr_b16 v[50:51], v24 offset:40960
  s_add_u32 m0, s74, 0x15000
  v_mfma_f32_16x16x32_bf16 v[192:195], a[92:95], v[54:57], v[192:195]
  s_waitcnt lgkmcnt(9)
  ds_read_b64_tr_b16 v[52:53], v24 offset:42240
  v_mfma_f32_16x16x32_bf16 v[108:111], a[16:19], v[58:61], v[108:111]
  ds_read_b64_tr_b16 v[54:55], v24 offset:40992
  v_mfma_f32_16x16x32_bf16 v[120:123], a[96:99], v[58:61], v[120:123]
  s_waitcnt lgkmcnt(9)
  ds_read_b64_tr_b16 v[56:57], v24 offset:42272
  v_mfma_f32_16x16x32_bf16 v[124:127], a[16:19], v[62:65], v[124:127]
  ds_read_b64_tr_b16 v[58:59], v24 offset:41024
  v_mfma_f32_16x16x32_bf16 v[128:131], a[96:99], v[62:65], v[128:131]
  s_waitcnt lgkmcnt(9)
  ds_read_b64_tr_b16 v[60:61], v24 offset:42304
  buffer_load_dwordx4 v14, s[32:35], s75 offen lds
  v_mfma_f32_16x16x32_bf16 v[132:135], a[16:19], v[38:41], v[132:135]
  ds_read_b64_tr_b16 v[62:63], v24 offset:41056
  s_add_u32 m0, s82, 0x1800
  v_mfma_f32_16x16x32_bf16 v[136:139], a[96:99], v[38:41], v[136:139]
  s_waitcnt lgkmcnt(9)
  ds_read_b64_tr_b16 v[64:65], v24 offset:42336
  v_mfma_f32_16x16x32_bf16 v[140:143], a[16:19], v[42:45], v[140:143]
  ds_read_b64_tr_b16 v[38:39], v24 offset:41088
  v_mfma_f32_16x16x32_bf16 v[144:147], a[96:99], v[42:45], v[144:147]
  s_waitcnt lgkmcnt(9)
  ds_read_b64_tr_b16 v[40:41], v24 offset:42368
  v_mfma_f32_16x16x32_bf16 v[148:151], a[16:19], v[46:49], v[148:151]
  s_waitcnt vmcnt(12)
  ds_read_b128 a[24:27], v31 offset:2048
  ds_read_b128 a[28:31], v32 offset:2048
  s_waitcnt vmcnt(10)
  ds_read_b128 a[104:107], v31 offset:4096
  ds_read_b128 a[108:111], v32 offset:4096
  ds_read_b64_tr_b16 v[42:43], v26 offset:40960
  v_mfma_f32_16x16x32_bf16 v[152:155], a[96:99], v[46:49], v[152:155]
  s_waitcnt lgkmcnt(13)
  ds_read_b64_tr_b16 v[44:45], v26 offset:42240
  buffer_load_dwordx4 v15, s[28:31], s78 offen lds
  v_mfma_f32_16x16x32_bf16 v[108:111], a[20:23], v[50:53], v[108:111]
  ds_read_b64_tr_b16 v[46:47], v26 offset:40992
  v_mfma_f32_16x16x32_bf16 v[120:123], a[100:103], v[50:53], v[120:123]
  s_waitcnt lgkmcnt(13)
  ds_read_b64_tr_b16 v[48:49], v26 offset:42272
  v_mfma_f32_16x16x32_bf16 v[124:127], a[20:23], v[54:57], v[124:127]
  ds_read_b64_tr_b16 v[50:51], v26 offset:41024
  buffer_load_dwordx4 v16, s[28:31], s78 offen offset:1024 lds
  v_mfma_f32_16x16x32_bf16 v[128:131], a[100:103], v[54:57], v[128:131]
  s_waitcnt lgkmcnt(13)
  ds_read_b64_tr_b16 v[52:53], v26 offset:42304
  s_add_u32 m0, s82, 0x2000
  v_mfma_f32_16x16x32_bf16 v[132:135], a[20:23], v[58:61], v[132:135]
  ds_read_b64_tr_b16 v[54:55], v26 offset:41056
  v_mfma_f32_16x16x32_bf16 v[136:139], a[100:103], v[58:61], v[136:139]
  s_waitcnt lgkmcnt(13)
  ds_read_b64_tr_b16 v[56:57], v26 offset:42336
  buffer_load_dwordx4 v17, s[28:31], s78 offen lds
  v_mfma_f32_16x16x32_bf16 v[140:143], a[20:23], v[62:65], v[140:143]
  ds_read_b64_tr_b16 v[58:59], v26 offset:41088
  v_mfma_f32_16x16x32_bf16 v[144:147], a[100:103], v[62:65], v[144:147]
  s_waitcnt lgkmcnt(13)
  ds_read_b64_tr_b16 v[60:61], v26 offset:42368
  v_mfma_f32_16x16x32_bf16 v[148:151], a[20:23], v[38:41], v[148:151]
  ds_read_b64_tr_b16 v[62:63], v28 offset:40960
  buffer_load_dwordx4 v18, s[28:31], s78 offen offset:1024 lds
  v_mfma_f32_16x16x32_bf16 v[152:155], a[100:103], v[38:41], v[152:155]
  s_waitcnt lgkmcnt(9)
  ds_read_b64_tr_b16 v[64:65], v28 offset:42240
  s_add_u32 m0, s82, 0
  v_mfma_f32_16x16x32_bf16 v[108:111], a[24:27], v[42:45], v[108:111]
  ds_read_b64_tr_b16 v[38:39], v28 offset:40992
  v_mfma_f32_16x16x32_bf16 v[120:123], a[104:107], v[42:45], v[120:123]
  s_waitcnt lgkmcnt(9)
  ds_read_b64_tr_b16 v[40:41], v28 offset:42272
  buffer_load_dwordx4 v19, s[28:31], s78 offen lds
  v_mfma_f32_16x16x32_bf16 v[124:127], a[24:27], v[46:49], v[124:127]
  ds_read_b64_tr_b16 v[42:43], v28 offset:41024
  v_mfma_f32_16x16x32_bf16 v[128:131], a[104:107], v[46:49], v[128:131]
  s_waitcnt lgkmcnt(9)
  ds_read_b64_tr_b16 v[44:45], v28 offset:42304
  v_mfma_f32_16x16x32_bf16 v[132:135], a[24:27], v[50:53], v[132:135]
  ds_read_b64_tr_b16 v[46:47], v28 offset:41056
  buffer_load_dwordx4 v20, s[28:31], s78 offen offset:1024 lds
  v_mfma_f32_16x16x32_bf16 v[136:139], a[104:107], v[50:53], v[136:139]
  s_waitcnt lgkmcnt(9)
  ds_read_b64_tr_b16 v[48:49], v28 offset:42336
  s_add_u32 m0, s82, 0x800
  v_mfma_f32_16x16x32_bf16 v[140:143], a[24:27], v[54:57], v[140:143]
  ds_read_b64_tr_b16 v[50:51], v28 offset:41088
  v_mfma_f32_16x16x32_bf16 v[144:147], a[104:107], v[54:57], v[144:147]
  s_waitcnt lgkmcnt(9)
  ds_read_b64_tr_b16 v[52:53], v28 offset:42368
  buffer_load_dwordx4 v21, s[28:31], s78 offen lds
  v_mfma_f32_16x16x32_bf16 v[148:151], a[24:27], v[58:61], v[148:151]
  s_waitcnt vmcnt(12)
  s_barrier
  ds_read_b64_tr_b16 v[54:55], v23
  v_mfma_f32_16x16x32_bf16 v[152:155], a[104:107], v[58:61], v[152:155]
  s_waitcnt lgkmcnt(9)
  ds_read_b64_tr_b16 v[56:57], v23 offset:1280
  v_mfma_f32_16x16x32_bf16 v[108:111], a[28:31], v[62:65], v[108:111]
  ds_read_b64_tr_b16 v[58:59], v23 offset:32
  buffer_load_dwordx4 v22, s[28:31], s78 offen offset:1024 lds
  v_mfma_f32_16x16x32_bf16 v[120:123], a[108:111], v[62:65], v[120:123]
  s_waitcnt lgkmcnt(9)
  ds_read_b64_tr_b16 v[60:61], v23 offset:1312
  s_mul_i32 s75, s79, 0x780
  s_add_u32 s75, s75, s81
  v_mfma_f32_16x16x32_bf16 v[124:127], a[28:31], v[38:41], v[124:127]
  ds_read_b64_tr_b16 v[62:63], v23 offset:64
  s_add_u32 s75, s75, 0x500
  s_add_u32 m0, s74, 0x19000
  v_mfma_f32_16x16x32_bf16 v[128:131], a[108:111], v[38:41], v[128:131]
  s_waitcnt lgkmcnt(9)
  ds_read_b64_tr_b16 v[64:65], v23 offset:1344
  buffer_load_dwordx4 v10, s[32:35], s75 offen lds
  v_mfma_f32_16x16x32_bf16 v[132:135], a[28:31], v[42:45], v[132:135]
  ds_read_b64_tr_b16 v[38:39], v23 offset:96
  v_mfma_f32_16x16x32_bf16 v[136:139], a[108:111], v[42:45], v[136:139]
  s_waitcnt lgkmcnt(9)
  ds_read_b64_tr_b16 v[40:41], v23 offset:1376
  v_mfma_f32_16x16x32_bf16 v[140:143], a[28:31], v[46:49], v[140:143]
  ds_read_b64_tr_b16 v[42:43], v23 offset:128
  v_mfma_f32_16x16x32_bf16 v[144:147], a[108:111], v[46:49], v[144:147]
  s_waitcnt lgkmcnt(9)
  ds_read_b64_tr_b16 v[44:45], v23 offset:1408
  v_mfma_f32_16x16x32_bf16 v[148:151], a[28:31], v[50:53], v[148:151]
  ds_read_b64_tr_b16 v[46:47], v25
  v_mfma_f32_16x16x32_bf16 v[152:155], a[108:111], v[50:53], v[152:155]
  s_waitcnt lgkmcnt(9)
  ds_read_b64_tr_b16 v[48:49], v25 offset:1280
  buffer_load_dwordx4 v11, s[32:35], s75 offen offset:1024 lds
  v_mfma_f32_16x16x32_bf16 v[156:159], a[16:19], v[54:57], v[156:159]
  ds_read_b64_tr_b16 v[50:51], v25 offset:32
  v_mfma_f32_16x16x32_bf16 v[160:163], a[96:99], v[54:57], v[160:163]
  s_waitcnt lgkmcnt(9)
  ds_read_b64_tr_b16 v[52:53], v25 offset:1312
  v_mfma_f32_16x16x32_bf16 v[164:167], a[16:19], v[58:61], v[164:167]
  ds_read_b64_tr_b16 v[54:55], v25 offset:64
  v_mfma_f32_16x16x32_bf16 v[168:171], a[96:99], v[58:61], v[168:171]
  s_waitcnt lgkmcnt(9)
  ds_read_b64_tr_b16 v[56:57], v25 offset:1344
  v_mfma_f32_16x16x32_bf16 v[172:175], a[16:19], v[62:65], v[172:175]
  ds_read_b64_tr_b16 v[58:59], v25 offset:96
  v_mfma_f32_16x16x32_bf16 v[176:179], a[96:99], v[62:65], v[176:179]
  s_waitcnt lgkmcnt(9)
  ds_read_b64_tr_b16 v[60:61], v25 offset:1376
  buffer_load_dwordx4 v12, s[32:35], s75 offen offset:2048 lds
  v_mfma_f32_16x16x32_bf16 v[180:183], a[16:19], v[38:41], v[180:183]
  ds_read_b64_tr_b16 v[62:63], v25 offset:128
  v_mfma_f32_16x16x32_bf16 v[184:187], a[96:99], v[38:41], v[184:187]
  s_waitcnt lgkmcnt(9)
  ds_read_b64_tr_b16 v[64:65], v25 offset:1408
  v_mfma_f32_16x16x32_bf16 v[188:191], a[16:19], v[42:45], v[188:191]
  ds_read_b64_tr_b16 v[38:39], v27
  v_mfma_f32_16x16x32_bf16 v[192:195], a[96:99], v[42:45], v[192:195]
  s_waitcnt lgkmcnt(9)
  ds_read_b64_tr_b16 v[40:41], v27 offset:1280
  v_mfma_f32_16x16x32_bf16 v[156:159], a[20:23], v[46:49], v[156:159]
  ds_read_b64_tr_b16 v[42:43], v27 offset:32
  v_mfma_f32_16x16x32_bf16 v[160:163], a[100:103], v[46:49], v[160:163]
  s_waitcnt lgkmcnt(9)
  ds_read_b64_tr_b16 v[44:45], v27 offset:1312
  buffer_load_dwordx4 v13, s[32:35], s75 offen offset:3072 lds
  v_mfma_f32_16x16x32_bf16 v[164:167], a[20:23], v[50:53], v[164:167]
  ds_read_b64_tr_b16 v[46:47], v27 offset:64
  s_add_u32 m0, s74, 0x1a000
  v_mfma_f32_16x16x32_bf16 v[168:171], a[100:103], v[50:53], v[168:171]
  s_waitcnt lgkmcnt(9)
  ds_read_b64_tr_b16 v[48:49], v27 offset:1344
  v_mfma_f32_16x16x32_bf16 v[172:175], a[20:23], v[54:57], v[172:175]
  ds_read_b64_tr_b16 v[50:51], v27 offset:96
  v_mfma_f32_16x16x32_bf16 v[176:179], a[100:103], v[54:57], v[176:179]
  s_waitcnt lgkmcnt(9)
  ds_read_b64_tr_b16 v[52:53], v27 offset:1376
  v_mfma_f32_16x16x32_bf16 v[180:183], a[20:23], v[58:61], v[180:183]
  ds_read_b64_tr_b16 v[54:55], v27 offset:128
  v_mfma_f32_16x16x32_bf16 v[184:187], a[100:103], v[58:61], v[184:187]
  s_waitcnt lgkmcnt(9)
  ds_read_b64_tr_b16 v[56:57], v27 offset:1408
  buffer_load_dwordx4 v14, s[32:35], s75 offen lds
  v_mfma_f32_16x16x32_bf16 v[188:191], a[20:23], v[62:65], v[188:191]
  ds_read_b64_tr_b16 v[58:59], v29
  s_add_u32 m0, s82, 0x1000
  v_mfma_f32_16x16x32_bf16 v[192:195], a[100:103], v[62:65], v[192:195]
  s_waitcnt lgkmcnt(9)
  ds_read_b64_tr_b16 v[60:61], v29 offset:1280
  v_mfma_f32_16x16x32_bf16 v[156:159], a[24:27], v[38:41], v[156:159]
  ds_read_b64_tr_b16 v[62:63], v29 offset:32
  v_mfma_f32_16x16x32_bf16 v[160:163], a[104:107], v[38:41], v[160:163]
  s_waitcnt lgkmcnt(9)
  ds_read_b64_tr_b16 v[64:65], v29 offset:1312
  v_mfma_f32_16x16x32_bf16 v[164:167], a[24:27], v[42:45], v[164:167]
  ds_read_b64_tr_b16 v[38:39], v29 offset:64
  v_mfma_f32_16x16x32_bf16 v[168:171], a[104:107], v[42:45], v[168:171]
  s_waitcnt lgkmcnt(9)
  ds_read_b64_tr_b16 v[40:41], v29 offset:1344
  buffer_load_dwordx4 v15, s[28:31], s79 offen lds
  v_mfma_f32_16x16x32_bf16 v[172:175], a[24:27], v[46:49], v[172:175]
  ds_read_b64_tr_b16 v[42:43], v29 offset:96
  v_mfma_f32_16x16x32_bf16 v[176:179], a[104:107], v[46:49], v[176:179]
  s_waitcnt lgkmcnt(9)
  ds_read_b64_tr_b16 v[44:45], v29 offset:1376
  v_mfma_f32_16x16x32_bf16 v[180:183], a[24:27], v[50:53], v[180:183]
  ds_read_b64_tr_b16 v[46:47], v29 offset:128
  buffer_load_dwordx4 v16, s[28:31], s79 offen offset:1024 lds
  v_mfma_f32_16x16x32_bf16 v[184:187], a[104:107], v[50:53], v[184:187]
  s_waitcnt lgkmcnt(9)
  ds_read_b64_tr_b16 v[48:49], v29 offset:1408
  s_mul_i32 s75, s78, 0x780
  s_add_u32 s75, s75, s81
  v_mfma_f32_16x16x32_bf16 v[188:191], a[24:27], v[54:57], v[188:191]
  s_waitcnt vmcnt(15)
  s_barrier
  v_mov_b32 v100, 1
  s_waitcnt vmcnt(13)
  ds_read_b128 a[32:35], v31 offset:6144
  ds_read_b128 a[36:39], v32 offset:6144
  s_waitcnt vmcnt(11)
  ds_read_b128 a[112:115], v31 offset:8192
  ds_read_b128 a[116:119], v32 offset:8192
  ds_read_b64_tr_b16 v[50:51], v23 offset:20480
  s_add_u32 s75, s75, 0xa00
  s_add_u32 m0, s74, 0
  v_mfma_f32_16x16x32_bf16 v[192:195], a[104:107], v[54:57], v[192:195]
  s_waitcnt lgkmcnt(13)
  ds_read_b64_tr_b16 v[52:53], v23 offset:21760
  buffer_load_dwordx4 v10, s[32:35], s75 offen lds
  v_mfma_f32_16x16x32_bf16 v[156:159], a[28:31], v[58:61], v[156:159]
  ds_read_b64_tr_b16 v[54:55], v23 offset:20512
  v_mfma_f32_16x16x32_bf16 v[160:163], a[108:111], v[58:61], v[160:163]
  s_waitcnt lgkmcnt(13)
  ds_read_b64_tr_b16 v[56:57], v23 offset:21792
  v_mfma_f32_16x16x32_bf16 v[164:167], a[28:31], v[62:65], v[164:167]
  ds_read_b64_tr_b16 v[58:59], v23 offset:20544
  v_mfma_f32_16x16x32_bf16 v[168:171], a[108:111], v[62:65], v[168:171]
  s_waitcnt lgkmcnt(13)
  ds_read_b64_tr_b16 v[60:61], v23 offset:21824
  v_mfma_f32_16x16x32_bf16 v[172:175], a[28:31], v[38:41], v[172:175]
  ds_read_b64_tr_b16 v[62:63], v23 offset:20576
  s_add_u32 m0, s82, 0x1800
  v_mfma_f32_16x16x32_bf16 v[176:179], a[108:111], v[38:41], v[176:179]
  s_waitcnt lgkmcnt(13)
  ds_read_b64_tr_b16 v[64:65], v23 offset:21856
  s_waitcnt lgkmcnt(10)
  buffer_load_dwordx4 v17, s[28:31], s79 offen lds
  v_mfma_f32_16x16x32_bf16 v[180:183], a[28:31], v[42:45], v[180:183]
  ds_read_b64_tr_b16 v[38:39], v23 offset:20608
  v_mfma_f32_16x16x32_bf16 v[184:187], a[108:111], v[42:45], v[184:187]
  ds_read_b64_tr_b16 v[40:41], v23 offset:21888
  v_mfma_f32_16x16x32_bf16 v[188:191], a[28:31], v[46:49], v[188:191]
  ds_read_b64_tr_b16 v[42:43], v25 offset:20480
  buffer_load_dwordx4 v18, s[28:31], s79 offen offset:1024 lds
  v_mfma_f32_16x16x32_bf16 v[192:195], a[108:111], v[46:49], v[192:195]
  s_waitcnt lgkmcnt(9)
  ds_read_b64_tr_b16 v[44:45], v25 offset:21760
  s_add_u32 m0, s82, 0x2000
  v_mfma_f32_16x16x32_bf16 v[108:111], a[32:35], v[50:53], v[108:111]
  ds_read_b64_tr_b16 v[46:47], v25 offset:20512
  v_mfma_f32_16x16x32_bf16 v[120:123], a[112:115], v[50:53], v[120:123]
  s_waitcnt lgkmcnt(9)
  ds_read_b64_tr_b16 v[48:49], v25 offset:21792
  buffer_load_dwordx4 v19, s[28:31], s79 offen lds
  v_mfma_f32_16x16x32_bf16 v[124:127], a[32:35], v[54:57], v[124:127]
  ds_read_b64_tr_b16 v[50:51], v25 offset:20544
  v_mfma_f32_16x16x32_bf16 v[128:131], a[112:115], v[54:57], v[128:131]
  s_waitcnt lgkmcnt(9)
  ds_read_b64_tr_b16 v[52:53], v25 offset:21824
  v_mfma_f32_16x16x32_bf16 v[132:135], a[32:35], v[58:61], v[132:135]
  ds_read_b64_tr_b16 v[54:55], v25 offset:20576
  buffer_load_dwordx4 v20, s[28:31], s79 offen offset:1024 lds
  v_mfma_f32_16x16x32_bf16 v[136:139], a[112:115], v[58:61], v[136:139]
  s_waitcnt lgkmcnt(9)
  ds_read_b64_tr_b16 v[56:57], v25 offset:21856
  s_add_u32 m0, s74, 0
  v_mfma_f32_16x16x32_bf16 v[140:143], a[32:35], v[62:65], v[140:143]
  ds_read_b64_tr_b16 v[58:59], v25 offset:20608
  v_mfma_f32_16x16x32_bf16 v[144:147], a[112:115], v[62:65], v[144:147]
  s_waitcnt lgkmcnt(9)
  ds_read_b64_tr_b16 v[60:61], v25 offset:21888
  buffer_load_dwordx4 v11, s[32:35], s75 offen offset:1024 lds
  v_mfma_f32_16x16x32_bf16 v[148:151], a[32:35], v[38:41], v[148:151]
  s_waitcnt vmcnt(15)
  ds_read_b128 a[40:43], v31
  ds_read_b128 a[44:47], v32
  s_waitcnt vmcnt(13)
  ds_read_b128 a[120:123], v31 offset:2048
  ds_read_b128 a[124:127], v32 offset:2048
  ds_read_b64_tr_b16 v[62:63], v27 offset:20480
  v_mfma_f32_16x16x32_bf16 v[152:155], a[112:115], v[38:41], v[152:155]
  s_waitcnt lgkmcnt(13)
  ds_read_b64_tr_b16 v[64:65], v27 offset:21760
  v_mfma_f32_16x16x32_bf16 v[108:111], a[36:39], v[42:45], v[108:111]
  ds_read_b64_tr_b16 v[38:39], v27 offset:20512
  v_mfma_f32_16x16x32_bf16 v[120:123], a[116:119], v[42:45], v[120:123]
  s_waitcnt lgkmcnt(13)
  ds_read_b64_tr_b16 v[40:41], v27 offset:21792
  v_mfma_f32_16x16x32_bf16 v[124:127], a[36:39], v[46:49], v[124:127]
  ds_read_b64_tr_b16 v[42:43], v27 offset:20544
  v_mfma_f32_16x16x32_bf16 v[128:131], a[116:119], v[46:49], v[128:131]
  s_waitcnt lgkmcnt(13)
  ds_read_b64_tr_b16 v[44:45], v27 offset:21824
  buffer_load_dwordx4 v12, s[32:35], s75 offen offset:2048 lds
  v_mfma_f32_16x16x32_bf16 v[132:135], a[36:39], v[50:53], v[132:135]
  ds_read_b64_tr_b16 v[46:47], v27 offset:20576
  s_add_u32 m0, s82, 0
  v_mfma_f32_16x16x32_bf16 v[136:139], a[116:119], v[50:53], v[136:139]
  s_waitcnt lgkmcnt(13)
  ds_read_b64_tr_b16 v[48:49], v27 offset:21856
  v_mfma_f32_16x16x32_bf16 v[140:143], a[36:39], v[54:57], v[140:143]
  ds_read_b64_tr_b16 v[50:51], v27 offset:20608
  v_mfma_f32_16x16x32_bf16 v[144:147], a[116:119], v[54:57], v[144:147]
  s_waitcnt lgkmcnt(13)
  ds_read_b64_tr_b16 v[52:53], v27 offset:21888
  v_mfma_f32_16x16x32_bf16 v[148:151], a[36:39], v[58:61], v[148:151]
  ds_read_b64_tr_b16 v[54:55], v29 offset:20480
  v_mfma_f32_16x16x32_bf16 v[152:155], a[116:119], v[58:61], v[152:155]
  s_waitcnt lgkmcnt(9)
  ds_read_b64_tr_b16 v[56:57], v29 offset:21760
  buffer_load_dwordx4 v21, s[28:31], s79 offen lds
  v_mfma_f32_16x16x32_bf16 v[108:111], a[40:43], v[62:65], v[108:111]
  ds_read_b64_tr_b16 v[58:59], v29 offset:20512
  v_mfma_f32_16x16x32_bf16 v[120:123], a[120:123], v[62:65], v[120:123]
  s_waitcnt lgkmcnt(9)
  ds_read_b64_tr_b16 v[60:61], v29 offset:21792
  v_mfma_f32_16x16x32_bf16 v[124:127], a[40:43], v[38:41], v[124:127]
  ds_read_b64_tr_b16 v[62:63], v29 offset:20544
  buffer_load_dwordx4 v22, s[28:31], s79 offen offset:1024 lds
  v_mfma_f32_16x16x32_bf16 v[128:131], a[120:123], v[38:41], v[128:131]
  s_waitcnt lgkmcnt(9)
  ds_read_b64_tr_b16 v[64:65], v29 offset:21824
  s_add_u32 m0, s74, 0
  v_mfma_f32_16x16x32_bf16 v[132:135], a[40:43], v[42:45], v[132:135]
  ds_read_b64_tr_b16 v[38:39], v29 offset:20576
  v_mfma_f32_16x16x32_bf16 v[136:139], a[120:123], v[42:45], v[136:139]
  s_waitcnt lgkmcnt(9)
  ds_read_b64_tr_b16 v[40:41], v29 offset:21856
  buffer_load_dwordx4 v13, s[32:35], s75 offen offset:3072 lds
  v_mfma_f32_16x16x32_bf16 v[140:143], a[40:43], v[46:49], v[140:143]
  ds_read_b64_tr_b16 v[42:43], v29 offset:20608
  s_add_u32 m0, s74, 0x1000
  v_mfma_f32_16x16x32_bf16 v[144:147], a[120:123], v[46:49], v[144:147]
  s_waitcnt lgkmcnt(9)
  ds_read_b64_tr_b16 v[44:45], v29 offset:21888
  v_mfma_f32_16x16x32_bf16 v[148:151], a[40:43], v[50:53], v[148:151]
  s_waitcnt vmcnt(12)
  s_barrier
  s_waitcnt vmcnt(10)
  ds_read_b128 a[48:51], v31 offset:4096
  ds_read_b128 a[52:55], v32 offset:4096
  s_waitcnt vmcnt(7)
  ds_read_b128 a[128:131], v31 offset:6144
  ds_read_b128 a[132:135], v32 offset:6144
  ds_read_b64_tr_b16 v[46:47], v23 offset:40960
  v_mfma_f32_16x16x32_bf16 v[152:155], a[120:123], v[50:53], v[152:155]
  s_waitcnt lgkmcnt(13)
  ds_read_b64_tr_b16 v[48:49], v23 offset:42240
  v_mfma_f32_16x16x32_bf16 v[108:111], a[44:47], v[54:57], v[108:111]
  ds_read_b64_tr_b16 v[50:51], v23 offset:40992
  v_mfma_f32_16x16x32_bf16 v[120:123], a[124:127], v[54:57], v[120:123]
  s_waitcnt lgkmcnt(13)
  ds_read_b64_tr_b16 v[52:53], v23 offset:42272
  buffer_load_dwordx4 v14, s[32:35], s75 offen lds
  v_mfma_f32_16x16x32_bf16 v[124:127], a[44:47], v[58:61], v[124:127]
  ds_read_b64_tr_b16 v[54:55], v23 offset:41024
  s_mul_i32 s75, s80, 0x780
  s_add_u32 s75, s75, s81
  v_mfma_f32_16x16x32_bf16 v[128:131], a[124:127], v[58:61], v[128:131]
  s_waitcnt lgkmcnt(13)
  ds_read_b64_tr_b16 v[56:57], v23 offset:42304
  s_add_u32 s75, s75, 0x500
  s_add_u32 m0, s74, 0x5000
  v_mfma_f32_16x16x32_bf16 v[132:135], a[44:47], v[62:65], v[132:135]
  ds_read_b64_tr_b16 v[58:59], v23 offset:41056
  v_mfma_f32_16x16x32_bf16 v[136:139], a[124:127], v[62:65], v[136:139]
  s_waitcnt lgkmcnt(13)
  ds_read_b64_tr_b16 v[60:61], v23 offset:42336
  v_mfma_f32_16x16x32_bf16 v[140:143], a[44:47], v[38:41], v[140:143]
  ds_read_b64_tr_b16 v[62:63], v23 offset:41088
  v_mfma_f32_16x16x32_bf16 v[144:147], a[124:127], v[38:41], v[144:147]
  s_waitcnt lgkmcnt(13)
  ds_read_b64_tr_b16 v[64:65], v23 offset:42368
  buffer_load_dwordx4 v10, s[32:35], s75 offen lds
  v_mfma_f32_16x16x32_bf16 v[148:151], a[44:47], v[42:45], v[148:151]
  ds_read_b64_tr_b16 v[38:39], v25 offset:40960
  v_mfma_f32_16x16x32_bf16 v[152:155], a[124:127], v[42:45], v[152:155]
  s_waitcnt lgkmcnt(9)
  ds_read_b64_tr_b16 v[40:41], v25 offset:42240
  v_mfma_f32_16x16x32_bf16 v[108:111], a[48:51], v[46:49], v[108:111]
  ds_read_b64_tr_b16 v[42:43], v25 offset:40992
  v_mfma_f32_16x16x32_bf16 v[120:123], a[128:131], v[46:49], v[120:123]
  s_waitcnt lgkmcnt(9)
  ds_read_b64_tr_b16 v[44:45], v25 offset:42272
  v_mfma_f32_16x16x32_bf16 v[124:127], a[48:51], v[50:53], v[124:127]
  ds_read_b64_tr_b16 v[46:47], v25 offset:41024
  v_mfma_f32_16x16x32_bf16 v[128:131], a[128:131], v[50:53], v[128:131]
  s_waitcnt lgkmcnt(9)
  ds_read_b64_tr_b16 v[48:49], v25 offset:42304
  buffer_load_dwordx4 v11, s[32:35], s75 offen offset:1024 lds
  v_mfma_f32_16x16x32_bf16 v[132:135], a[48:51], v[54:57], v[132:135]
  ds_read_b64_tr_b16 v[50:51], v25 offset:41056
  v_mfma_f32_16x16x32_bf16 v[136:139], a[128:131], v[54:57], v[136:139]
  s_waitcnt lgkmcnt(9)
  ds_read_b64_tr_b16 v[52:53], v25 offset:42336
  v_mfma_f32_16x16x32_bf16 v[140:143], a[48:51], v[58:61], v[140:143]
  ds_read_b64_tr_b16 v[54:55], v25 offset:41088
  v_mfma_f32_16x16x32_bf16 v[144:147], a[128:131], v[58:61], v[144:147]
  s_waitcnt lgkmcnt(9)
  ds_read_b64_tr_b16 v[56:57], v25 offset:42368
  v_mfma_f32_16x16x32_bf16 v[148:151], a[48:51], v[62:65], v[148:151]
  s_waitcnt vmcnt(8)
  ds_read_b128 a[56:59], v31 offset:8192
  ds_read_b128 a[60:63], v32 offset:8192
  s_waitcnt vmcnt(4)
  ds_read_b128 a[136:139], v31
  ds_read_b128 a[140:143], v32
  ds_read_b64_tr_b16 v[58:59], v27 offset:40960
  v_mfma_f32_16x16x32_bf16 v[152:155], a[128:131], v[62:65], v[152:155]
  s_waitcnt lgkmcnt(13)
  ds_read_b64_tr_b16 v[60:61], v27 offset:42240
  buffer_load_dwordx4 v12, s[32:35], s75 offen offset:2048 lds
  v_mfma_f32_16x16x32_bf16 v[108:111], a[52:55], v[38:41], v[108:111]
  ds_read_b64_tr_b16 v[62:63], v27 offset:40992
  v_mfma_f32_16x16x32_bf16 v[120:123], a[132:135], v[38:41], v[120:123]
  s_waitcnt lgkmcnt(13)
  ds_read_b64_tr_b16 v[64:65], v27 offset:42272
  v_mfma_f32_16x16x32_bf16 v[124:127], a[52:55], v[42:45], v[124:127]
  ds_read_b64_tr_b16 v[38:39], v27 offset:41024
  v_mfma_f32_16x16x32_bf16 v[128:131], a[132:135], v[42:45], v[128:131]
  s_waitcnt lgkmcnt(13)
  ds_read_b64_tr_b16 v[40:41], v27 offset:42304
  v_mfma_f32_16x16x32_bf16 v[132:135], a[52:55], v[46:49], v[132:135]
  ds_read_b64_tr_b16 v[42:43], v27 offset:41056
  v_mfma_f32_16x16x32_bf16 v[136:139], a[132:135], v[46:49], v[136:139]
  s_waitcnt lgkmcnt(13)
  ds_read_b64_tr_b16 v[44:45], v27 offset:42336
  buffer_load_dwordx4 v13, s[32:35], s75 offen offset:3072 lds
  v_mfma_f32_16x16x32_bf16 v[140:143], a[52:55], v[50:53], v[140:143]
  ds_read_b64_tr_b16 v[46:47], v27 offset:41088
  s_add_u32 m0, s74, 0x6000
  v_mfma_f32_16x16x32_bf16 v[144:147], a[132:135], v[50:53], v[144:147]
  s_waitcnt lgkmcnt(13)
  ds_read_b64_tr_b16 v[48:49], v27 offset:42368
  v_mfma_f32_16x16x32_bf16 v[148:151], a[52:55], v[54:57], v[148:151]
  ds_read_b64_tr_b16 v[50:51], v29 offset:40960
  v_mfma_f32_16x16x32_bf16 v[152:155], a[132:135], v[54:57], v[152:155]
  s_waitcnt lgkmcnt(9)
  ds_read_b64_tr_b16 v[52:53], v29 offset:42240
  v_mfma_f32_16x16x32_bf16 v[108:111], a[56:59], v[58:61], v[108:111]
  ds_read_b64_tr_b16 v[54:55], v29 offset:40992
  v_mfma_f32_16x16x32_bf16 v[120:123], a[136:139], v[58:61], v[120:123]
  s_waitcnt lgkmcnt(9)
  ds_read_b64_tr_b16 v[56:57], v29 offset:42272
  buffer_load_dwordx4 v14, s[32:35], s75 offen lds
  v_mfma_f32_16x16x32_bf16 v[124:127], a[56:59], v[62:65], v[124:127]
  ds_read_b64_tr_b16 v[58:59], v29 offset:41024
  s_add_u32 m0, s82, 0x800
  v_mfma_f32_16x16x32_bf16 v[128:131], a[136:139], v[62:65], v[128:131]
  s_waitcnt lgkmcnt(9)
  ds_read_b64_tr_b16 v[60:61], v29 offset:42304
  v_mfma_f32_16x16x32_bf16 v[132:135], a[56:59], v[38:41], v[132:135]
  ds_read_b64_tr_b16 v[62:63], v29 offset:41056
  v_mfma_f32_16x16x32_bf16 v[136:139], a[136:139], v[38:41], v[136:139]
  s_waitcnt lgkmcnt(9)
  ds_read_b64_tr_b16 v[64:65], v29 offset:42336
  v_mfma_f32_16x16x32_bf16 v[140:143], a[56:59], v[42:45], v[140:143]
  ds_read_b64_tr_b16 v[38:39], v29 offset:41088
  v_mfma_f32_16x16x32_bf16 v[144:147], a[136:139], v[42:45], v[144:147]
  s_waitcnt lgkmcnt(9)
  ds_read_b64_tr_b16 v[40:41], v29 offset:42368
  buffer_load_dwordx4 v15, s[28:31], s80 offen lds
  v_mfma_f32_16x16x32_bf16 v[148:151], a[56:59], v[46:49], v[148:151]
  s_waitcnt vmcnt(6)
  s_barrier
  ds_read_b64_tr_b16 v[42:43], v9
  v_mfma_f32_16x16x32_bf16 v[152:155], a[136:139], v[46:49], v[152:155]
  s_waitcnt lgkmcnt(9)
  ds_read_b64_tr_b16 v[44:45], v9 offset:1280
  v_mfma_f32_16x16x32_bf16 v[108:111], a[60:63], v[50:53], v[108:111]
  ds_read_b64_tr_b16 v[46:47], v9 offset:32
  buffer_load_dwordx4 v16, s[28:31], s80 offen offset:1024 lds
  v_mfma_f32_16x16x32_bf16 v[120:123], a[140:143], v[50:53], v[120:123]
  s_waitcnt lgkmcnt(9)
  ds_read_b64_tr_b16 v[48:49], v9 offset:1312
  s_add_u32 m0, s82, 0x1000
  v_mfma_f32_16x16x32_bf16 v[124:127], a[60:63], v[54:57], v[124:127]
  ds_read_b64_tr_b16 v[50:51], v9 offset:64
  v_mfma_f32_16x16x32_bf16 v[128:131], a[140:143], v[54:57], v[128:131]
  s_waitcnt lgkmcnt(9)
  ds_read_b64_tr_b16 v[52:53], v9 offset:1344
  buffer_load_dwordx4 v17, s[28:31], s80 offen lds
  v_mfma_f32_16x16x32_bf16 v[132:135], a[60:63], v[58:61], v[132:135]
  ds_read_b64_tr_b16 v[54:55], v9 offset:96
  v_mfma_f32_16x16x32_bf16 v[136:139], a[140:143], v[58:61], v[136:139]
  s_waitcnt lgkmcnt(9)
  ds_read_b64_tr_b16 v[56:57], v9 offset:1376
  v_mfma_f32_16x16x32_bf16 v[140:143], a[60:63], v[62:65], v[140:143]
  ds_read_b64_tr_b16 v[58:59], v9 offset:128
  buffer_load_dwordx4 v18, s[28:31], s80 offen offset:1024 lds
  v_mfma_f32_16x16x32_bf16 v[144:147], a[140:143], v[62:65], v[144:147]
  s_waitcnt lgkmcnt(9)
  ds_read_b64_tr_b16 v[60:61], v9 offset:1408
  s_add_u32 m0, s82, 0x1800
  v_mfma_f32_16x16x32_bf16 v[148:151], a[60:63], v[38:41], v[148:151]
  ds_read_b64_tr_b16 v[62:63], v24
  v_mfma_f32_16x16x32_bf16 v[152:155], a[140:143], v[38:41], v[152:155]
  s_waitcnt lgkmcnt(9)
  ds_read_b64_tr_b16 v[64:65], v24 offset:1280
  buffer_load_dwordx4 v19, s[28:31], s80 offen lds
  v_mfma_f32_16x16x32_bf16 v[156:159], a[32:35], v[42:45], v[156:159]
  ds_read_b64_tr_b16 v[38:39], v24 offset:32
  v_mfma_f32_16x16x32_bf16 v[160:163], a[112:115], v[42:45], v[160:163]
  s_waitcnt lgkmcnt(9)
  ds_read_b64_tr_b16 v[40:41], v24 offset:1312
  v_mfma_f32_16x16x32_bf16 v[164:167], a[32:35], v[46:49], v[164:167]
  ds_read_b64_tr_b16 v[42:43], v24 offset:64
  buffer_load_dwordx4 v20, s[28:31], s80 offen offset:1024 lds
  v_mfma_f32_16x16x32_bf16 v[168:171], a[112:115], v[46:49], v[168:171]
  s_waitcnt lgkmcnt(9)
  ds_read_b64_tr_b16 v[44:45], v24 offset:1344
  s_add_u32 m0, s82, 0x2000
  v_mfma_f32_16x16x32_bf16 v[172:175], a[32:35], v[50:53], v[172:175]
  ds_read_b64_tr_b16 v[46:47], v24 offset:96
  v_mfma_f32_16x16x32_bf16 v[176:179], a[112:115], v[50:53], v[176:179]
  s_waitcnt lgkmcnt(9)
  ds_read_b64_tr_b16 v[48:49], v24 offset:1376
  buffer_load_dwordx4 v21, s[28:31], s80 offen lds
  v_mfma_f32_16x16x32_bf16 v[180:183], a[32:35], v[54:57], v[180:183]
  ds_read_b64_tr_b16 v[50:51], v24 offset:128
  v_mfma_f32_16x16x32_bf16 v[184:187], a[112:115], v[54:57], v[184:187]
  s_waitcnt lgkmcnt(9)
  ds_read_b64_tr_b16 v[52:53], v24 offset:1408
  v_mfma_f32_16x16x32_bf16 v[188:191], a[32:35], v[58:61], v[188:191]
  ds_read_b64_tr_b16 v[54:55], v26
  buffer_load_dwordx4 v22, s[28:31], s80 offen offset:1024 lds
  v_mfma_f32_16x16x32_bf16 v[192:195], a[112:115], v[58:61], v[192:195]
  s_waitcnt lgkmcnt(9)
  ds_read_b64_tr_b16 v[56:57], v26 offset:1280
  buffer_atomic_add v100, v33, s[44:47], 0 offen sc1
  v_mfma_f32_16x16x32_bf16 v[156:159], a[36:39], v[62:65], v[156:159]
  ds_read_b64_tr_b16 v[58:59], v26 offset:32
  s_mul_i32 s75, s79, 0x780
  s_add_u32 s75, s75, s81
  v_mfma_f32_16x16x32_bf16 v[160:163], a[116:119], v[62:65], v[160:163]
  s_waitcnt lgkmcnt(9)
  ds_read_b64_tr_b16 v[60:61], v26 offset:1312
  s_add_u32 s75, s75, 0xa00
  s_add_u32 m0, s74, 0xa000
  v_mfma_f32_16x16x32_bf16 v[164:167], a[36:39], v[38:41], v[164:167]
  ds_read_b64_tr_b16 v[62:63], v26 offset:64
  buffer_load_dwordx4 v10, s[32:35], s75 offen lds
  v_mfma_f32_16x16x32_bf16 v[168:171], a[116:119], v[38:41], v[168:171]
  s_waitcnt lgkmcnt(9)
  ds_read_b64_tr_b16 v[64:65], v26 offset:1344
  v_mfma_f32_16x16x32_bf16 v[172:175], a[36:39], v[42:45], v[172:175]
  ds_read_b64_tr_b16 v[38:39], v26 offset:96
  v_mfma_f32_16x16x32_bf16 v[176:179], a[116:119], v[42:45], v[176:179]
  s_waitcnt lgkmcnt(9)
  ds_read_b64_tr_b16 v[40:41], v26 offset:1376
  v_mfma_f32_16x16x32_bf16 v[180:183], a[36:39], v[46:49], v[180:183]
  ds_read_b64_tr_b16 v[42:43], v26 offset:128
  v_mfma_f32_16x16x32_bf16 v[184:187], a[116:119], v[46:49], v[184:187]
  s_waitcnt lgkmcnt(9)
  ds_read_b64_tr_b16 v[44:45], v26 offset:1408
  v_mfma_f32_16x16x32_bf16 v[188:191], a[36:39], v[50:53], v[188:191]
  ds_read_b64_tr_b16 v[46:47], v28
  buffer_load_dwordx4 v11, s[32:35], s75 offen offset:1024 lds
  v_mfma_f32_16x16x32_bf16 v[192:195], a[116:119], v[50:53], v[192:195]
  s_waitcnt lgkmcnt(9)
  ds_read_b64_tr_b16 v[48:49], v28 offset:1280
  v_mfma_f32_16x16x32_bf16 v[156:159], a[40:43], v[54:57], v[156:159]
  ds_read_b64_tr_b16 v[50:51], v28 offset:32
  v_mfma_f32_16x16x32_bf16 v[160:163], a[120:123], v[54:57], v[160:163]
  s_waitcnt lgkmcnt(9)
  ds_read_b64_tr_b16 v[52:53], v28 offset:1312
  v_mfma_f32_16x16x32_bf16 v[164:167], a[40:43], v[58:61], v[164:167]
  ds_read_b64_tr_b16 v[54:55], v28 offset:64
  v_mfma_f32_16x16x32_bf16 v[168:171], a[120:123], v[58:61], v[168:171]
  s_waitcnt lgkmcnt(9)
  ds_read_b64_tr_b16 v[56:57], v28 offset:1344
  v_mfma_f32_16x16x32_bf16 v[172:175], a[40:43], v[62:65], v[172:175]
  ds_read_b64_tr_b16 v[58:59], v28 offset:96
  buffer_load_dwordx4 v12, s[32:35], s75 offen offset:2048 lds
  v_mfma_f32_16x16x32_bf16 v[176:179], a[120:123], v[62:65], v[176:179]
  s_waitcnt lgkmcnt(9)
  ds_read_b64_tr_b16 v[60:61], v28 offset:1376
  v_mfma_f32_16x16x32_bf16 v[180:183], a[40:43], v[38:41], v[180:183]
  ds_read_b64_tr_b16 v[62:63], v28 offset:128
  v_mfma_f32_16x16x32_bf16 v[184:187], a[120:123], v[38:41], v[184:187]
  s_waitcnt lgkmcnt(9)
  ds_read_b64_tr_b16 v[64:65], v28 offset:1408
  v_mfma_f32_16x16x32_bf16 v[188:191], a[40:43], v[42:45], v[188:191]
  s_waitcnt vmcnt(12)
  s_barrier
  s_waitcnt vmcnt(10)
  ds_read_b128 a[64:67], v31 offset:2048
  ds_read_b128 a[68:71], v32 offset:2048
  s_waitcnt vmcnt(8)
  ds_read_b128 a[144:147], v31 offset:4096
  ds_read_b128 a[148:151], v32 offset:4096
  ds_read_b64_tr_b16 v[38:39], v9 offset:20480
  v_mfma_f32_16x16x32_bf16 v[192:195], a[120:123], v[42:45], v[192:195]
  s_waitcnt lgkmcnt(13)
  ds_read_b64_tr_b16 v[40:41], v9 offset:21760
  v_mfma_f32_16x16x32_bf16 v[156:159], a[44:47], v[46:49], v[156:159]
  ds_read_b64_tr_b16 v[42:43], v9 offset:20512
  buffer_load_dwordx4 v13, s[32:35], s75 offen offset:3072 lds
  v_mfma_f32_16x16x32_bf16 v[160:163], a[124:127], v[46:49], v[160:163]
  s_waitcnt lgkmcnt(13)
  ds_read_b64_tr_b16 v[44:45], v9 offset:21792
  s_add_u32 m0, s74, 0xb000
  v_mfma_f32_16x16x32_bf16 v[164:167], a[44:47], v[50:53], v[164:167]
  ds_read_b64_tr_b16 v[46:47], v9 offset:20544
  v_mfma_f32_16x16x32_bf16 v[168:171], a[124:127], v[50:53], v[168:171]
  s_waitcnt lgkmcnt(13)
  ds_read_b64_tr_b16 v[48:49], v9 offset:21824
  v_mfma_f32_16x16x32_bf16 v[172:175], a[44:47], v[54:57], v[172:175]
  ds_read_b64_tr_b16 v[50:51], v9 offset:20576
  v_mfma_f32_16x16x32_bf16 v[176:179], a[124:127], v[54:57], v[176:179]
  s_waitcnt lgkmcnt(13)
  ds_read_b64_tr_b16 v[52:53], v9 offset:21856
  v_mfma_f32_16x16x32_bf16 v[180:183], a[44:47], v[58:61], v[180:183]
  ds_read_b64_tr_b16 v[54:55], v9 offset:20608
  buffer_load_dwordx4 v14, s[32:35], s75 offen lds
  v_mfma_f32_16x16x32_bf16 v[184:187], a[124:127], v[58:61], v[184:187]
  s_waitcnt lgkmcnt(13)
  ds_read_b64_tr_b16 v[56:57], v9 offset:21888
  s_mul_i32 s75, s80, 0x780
  s_add_u32 s75, s75, s81
  v_mfma_f32_16x16x32_bf16 v[188:191], a[44:47], v[62:65], v[188:191]
  ds_read_b64_tr_b16 v[58:59], v24 offset:20480
  s_add_u32 s75, s75, 0xa00
  s_add_u32 m0, s74, 0xf000
  v_mfma_f32_16x16x32_bf16 v[192:195], a[124:127], v[62:65], v[192:195]
  s_waitcnt lgkmcnt(9)
  ds_read_b64_tr_b16 v[60:61], v24 offset:21760
  v_mfma_f32_16x16x32_bf16 v[108:111], a[64:67], v[38:41], v[108:111]
  s_waitcnt vmcnt(8)
  ds_read_b128 a[72:75], v31 offset:6144
  ds_read_b128 a[76:79], v32 offset:6144
  s_waitcnt vmcnt(6)
  ds_read_b128 a[152:155], v31 offset:8192
  ds_read_b128 a[156:159], v32 offset:8192
  ds_read_b64_tr_b16 v[62:63], v26 offset:20480
  v_mfma_f32_16x16x32_bf16 v[120:123], a[144:147], v[38:41], v[120:123]
  s_waitcnt lgkmcnt(13)
  ds_read_b64_tr_b16 v[64:65], v26 offset:21760
  v_mfma_f32_16x16x32_bf16 v[124:127], a[64:67], v[42:45], v[124:127]
  ds_read_b64_tr_b16 v[38:39], v28 offset:20480
  buffer_load_dwordx4 v10, s[32:35], s75 offen lds
  v_mfma_f32_16x16x32_bf16 v[128:131], a[144:147], v[42:45], v[128:131]
  s_waitcnt lgkmcnt(13)
  ds_read_b64_tr_b16 v[40:41], v28 offset:21760
  v_mfma_f32_16x16x32_bf16 v[132:135], a[64:67], v[46:49], v[132:135]
  ds_read_b64_tr_b16 v[42:43], v24 offset:20512
  v_mfma_f32_16x16x32_bf16 v[136:139], a[144:147], v[46:49], v[136:139]
  s_waitcnt lgkmcnt(13)
  ds_read_b64_tr_b16 v[44:45], v24 offset:21792
  v_mfma_f32_16x16x32_bf16 v[140:143], a[64:67], v[50:53], v[140:143]
  ds_read_b64_tr_b16 v[46:47], v26 offset:20512
  v_mfma_f32_16x16x32_bf16 v[144:147], a[144:147], v[50:53], v[144:147]
  s_waitcnt lgkmcnt(13)
  ds_read_b64_tr_b16 v[48:49], v26 offset:21792
  v_mfma_f32_16x16x32_bf16 v[148:151], a[64:67], v[54:57], v[148:151]
  ds_read_b64_tr_b16 v[50:51], v28 offset:20512
  buffer_load_dwordx4 v11, s[32:35], s75 offen offset:1024 lds
  v_mfma_f32_16x16x32_bf16 v[152:155], a[144:147], v[54:57], v[152:155]
  s_waitcnt lgkmcnt(13)
  ds_read_b64_tr_b16 v[52:53], v28 offset:21792
  v_mfma_f32_16x16x32_bf16 v[108:111], a[68:71], v[58:61], v[108:111]
  ds_read_b64_tr_b16 v[54:55], v24 offset:20544
  v_mfma_f32_16x16x32_bf16 v[120:123], a[148:151], v[58:61], v[120:123]
  s_waitcnt lgkmcnt(9)
  ds_read_b64_tr_b16 v[56:57], v24 offset:21824
  v_mfma_f32_16x16x32_bf16 v[108:111], a[72:75], v[62:65], v[108:111]
  ds_read_b64_tr_b16 v[58:59], v26 offset:20544
  v_mfma_f32_16x16x32_bf16 v[120:123], a[152:155], v[62:65], v[120:123]
  s_waitcnt lgkmcnt(9)
  ds_read_b64_tr_b16 v[60:61], v26 offset:21824
  v_mfma_f32_16x16x32_bf16 v[108:111], a[76:79], v[38:41], v[108:111]
  ds_read_b64_tr_b16 v[62:63], v28 offset:20544
  buffer_load_dwordx4 v12, s[32:35], s75 offen offset:2048 lds
  v_mfma_f32_16x16x32_bf16 v[120:123], a[156:159], v[38:41], v[120:123]
  s_waitcnt lgkmcnt(9)
  ds_read_b64_tr_b16 v[64:65], v28 offset:21824
  v_mfma_f32_16x16x32_bf16 v[124:127], a[68:71], v[42:45], v[124:127]
  ds_read_b64_tr_b16 v[38:39], v24 offset:20576
  v_mfma_f32_16x16x32_bf16 v[128:131], a[148:151], v[42:45], v[128:131]
  s_waitcnt lgkmcnt(9)
  ds_read_b64_tr_b16 v[40:41], v24 offset:21856
  v_fma_f32 v78, v108, s88, v76
  v_fma_f32 v79, v109, s88, v76
  v_fma_f32 v80, v110, s88, v76
  v_mfma_f32_16x16x32_bf16 v[124:127], a[72:75], v[46:49], v[124:127]
  ds_read_b64_tr_b16 v[42:43], v26 offset:20576
  v_fma_f32 v81, v111, s88, v76
  v_exp_f32_e64 v78, v78 clamp
  v_mfma_f32_16x16x32_bf16 v[128:131], a[152:155], v[46:49], v[128:131]
  s_waitcnt lgkmcnt(9)
  ds_read_b64_tr_b16 v[44:45], v26 offset:21856
  v_max_f32 v108, 0x358637bd, v108
  v_exp_f32_e64 v79, v79 clamp
  v_mfma_f32_16x16x32_bf16 v[124:127], a[76:79], v[50:53], v[124:127]
  ds_read_b64_tr_b16 v[46:47], v28 offset:20576
  buffer_load_dwordx4 v13, s[32:35], s75 offen offset:3072 lds
  v_max_f32 v109, 0x358637bd, v109
  v_exp_f32_e64 v80, v80 clamp
  v_mfma_f32_16x16x32_bf16 v[128:131], a[156:159], v[50:53], v[128:131]
  s_waitcnt lgkmcnt(9)
  ds_read_b64_tr_b16 v[48:49], v28 offset:21856
  s_add_u32 m0, s74, 0x10000
  v_max_f32 v110, 0x358637bd, v110
  v_exp_f32_e64 v81, v81 clamp
  v_mfma_f32_16x16x32_bf16 v[132:135], a[68:71], v[54:57], v[132:135]
  ds_read_b64_tr_b16 v[50:51], v24 offset:20608
  v_max_f32 v111, 0x358637bd, v111
  v_add_f32 v108, v108, v78
  v_add_f32 v109, v109, v79
  v_mfma_f32_16x16x32_bf16 v[136:139], a[148:151], v[54:57], v[136:139]
  s_waitcnt lgkmcnt(9)
  ds_read_b64_tr_b16 v[52:53], v24 offset:21888
  v_add_f32 v110, v110, v80
  v_add_f32 v111, v111, v81
  v_cvt_pk_bf16_f32 v112, v108, v109
  v_cvt_pk_bf16_f32 v113, v110, v111
  v_mfma_f32_16x16x32_bf16 v[132:135], a[72:75], v[58:61], v[132:135]
  ds_read_b64_tr_b16 v[54:55], v26 offset:20608
  v_fma_f32 v78, v120, s88, v76
  v_fma_f32 v79, v121, s88, v76
  v_fma_f32 v80, v122, s88, v76
  v_mfma_f32_16x16x32_bf16 v[136:139], a[152:155], v[58:61], v[136:139]
  s_waitcnt lgkmcnt(9)
  ds_read_b64_tr_b16 v[56:57], v26 offset:21888
  v_fma_f32 v81, v123, s88, v76
  v_exp_f32_e64 v78, v78 clamp
  v_mfma_f32_16x16x32_bf16 v[132:135], a[76:79], v[62:65], v[132:135]
  ds_read_b64_tr_b16 v[58:59], v28 offset:20608
  buffer_load_dwordx4 v14, s[32:35], s75 offen lds
  v_max_f32 v120, 0x358637bd, v120
  v_exp_f32_e64 v79, v79 clamp
  v_mfma_f32_16x16x32_bf16 v[136:139], a[156:159], v[62:65], v[136:139]
  s_waitcnt lgkmcnt(9)
  ds_read_b64_tr_b16 v[60:61], v28 offset:21888
  s_mul_i32 s75, s76, 0x780
  s_add_u32 s75, s75, s81
  v_max_f32 v121, 0x358637bd, v121
  v_exp_f32_e64 v80, v80 clamp
  v_mfma_f32_16x16x32_bf16 v[140:143], a[68:71], v[38:41], v[140:143]
  s_waitcnt vmcnt(5)
  s_barrier
  ds_read_b64_tr_b16 v[62:63], v9 offset:40960
  s_add_u32 m0, s74, 0x14000
  v_max_f32 v122, 0x358637bd, v122
  v_exp_f32_e64 v81, v81 clamp
  v_mfma_f32_16x16x32_bf16 v[144:147], a[148:151], v[38:41], v[144:147]
  s_waitcnt lgkmcnt(9)
  ds_read_b64_tr_b16 v[64:65], v9 offset:42240
  v_max_f32 v123, 0x358637bd, v123
  v_add_f32 v120, v120, v78
  v_add_f32 v121, v121, v79
  v_mfma_f32_16x16x32_bf16 v[140:143], a[72:75], v[42:45], v[140:143]
  ds_read_b64_tr_b16 v[38:39], v9 offset:40992
  v_add_f32 v122, v122, v80
  v_add_f32 v123, v123, v81
  v_cvt_pk_bf16_f32 v114, v120, v121
  v_cvt_pk_bf16_f32 v115, v122, v123
  v_mfma_f32_16x16x32_bf16 v[144:147], a[152:155], v[42:45], v[144:147]
  s_waitcnt lgkmcnt(9)
  ds_read_b64_tr_b16 v[40:41], v9 offset:42272
  ds_write_b128 v8, v[112:115]
  v_fma_f32 v78, v124, s88, v76
  v_fma_f32 v79, v125, s88, v76
  v_mfma_f32_16x16x32_bf16 v[140:143], a[76:79], v[46:49], v[140:143]
  ds_read_b64_tr_b16 v[42:43], v9 offset:41024
  buffer_load_dwordx4 v10, s[32:35], s75 offen lds
  v_fma_f32 v80, v126, s88, v76
  v_fma_f32 v81, v127, s88, v76
  v_exp_f32_e64 v78, v78 clamp
  v_mfma_f32_16x16x32_bf16 v[144:147], a[156:159], v[46:49], v[144:147]
  s_waitcnt lgkmcnt(10)
  ds_read_b64_tr_b16 v[44:45], v9 offset:42304
  v_max_f32 v124, 0x358637bd, v124
  v_exp_f32_e64 v79, v79 clamp
  v_mfma_f32_16x16x32_bf16 v[148:151], a[68:71], v[50:53], v[148:151]
  ds_read_b64_tr_b16 v[46:47], v9 offset:41056
  v_max_f32 v125, 0x358637bd, v125
  v_exp_f32_e64 v80, v80 clamp
  v_mfma_f32_16x16x32_bf16 v[152:155], a[148:151], v[50:53], v[152:155]
  s_waitcnt lgkmcnt(10)
  ds_read_b64_tr_b16 v[48:49], v9 offset:42336
  v_max_f32 v126, 0x358637bd, v126
  v_exp_f32_e64 v81, v81 clamp
  v_mfma_f32_16x16x32_bf16 v[148:151], a[72:75], v[54:57], v[148:151]
  ds_read_b64_tr_b16 v[50:51], v9 offset:41088
  v_max_f32 v127, 0x358637bd, v127
  v_add_f32 v124, v124, v78
  v_add_f32 v125, v125, v79
  v_mfma_f32_16x16x32_bf16 v[152:155], a[152:155], v[54:57], v[152:155]
  s_waitcnt lgkmcnt(10)
  ds_read_b64_tr_b16 v[52:53], v9 offset:42368
  v_add_f32 v126, v126, v80
  v_add_f32 v127, v127, v81
  v_cvt_pk_bf16_f32 v116, v124, v125
  v_cvt_pk_bf16_f32 v117, v126, v127
  v_mfma_f32_16x16x32_bf16 v[148:151], a[76:79], v[58:61], v[148:151]
  ds_read_b64_tr_b16 v[54:55], v24 offset:40960
  buffer_load_dwordx4 v11, s[32:35], s75 offen offset:1024 lds
  v_fma_f32 v78, v128, s88, v76
  v_fma_f32 v79, v129, s88, v76
  v_fma_f32 v80, v130, s88, v76
  v_mfma_f32_16x16x32_bf16 v[152:155], a[156:159], v[58:61], v[152:155]
  s_waitcnt lgkmcnt(10)
  ds_read_b64_tr_b16 v[56:57], v24 offset:42240
  v_fma_f32 v81, v131, s88, v76
  v_exp_f32_e64 v78, v78 clamp
  v_mfma_f32_16x16x32_bf16 v[156:159], a[48:51], v[62:65], v[156:159]
  ds_read_b64_tr_b16 v[58:59], v24 offset:40992
  v_max_f32 v128, 0x358637bd, v128
  v_exp_f32_e64 v79, v79 clamp
  v_mfma_f32_16x16x32_bf16 v[160:163], a[128:131], v[62:65], v[160:163]
  s_waitcnt lgkmcnt(10)
  ds_read_b64_tr_b16 v[60:61], v24 offset:42272
  v_max_f32 v129, 0x358637bd, v129
  v_exp_f32_e64 v80, v80 clamp
  v_mfma_f32_16x16x32_bf16 v[164:167], a[48:51], v[38:41], v[164:167]
  ds_read_b64_tr_b16 v[62:63], v24 offset:41024
  v_max_f32 v130, 0x358637bd, v130
  v_exp_f32_e64 v81, v81 clamp
  v_mfma_f32_16x16x32_bf16 v[168:171], a[128:131], v[38:41], v[168:171]
  s_waitcnt lgkmcnt(9)
  ds_read_b64_tr_b16 v[64:65], v24 offset:42304
  v_max_f32 v131, 0x358637bd, v131
  v_add_f32 v128, v128, v78
  v_add_f32 v129, v129, v79
  v_mfma_f32_16x16x32_bf16 v[172:175], a[48:51], v[42:45], v[172:175]
  ds_read_b64_tr_b16 v[38:39], v24 offset:41056
  buffer_load_dwordx4 v12, s[32:35], s75 offen offset:2048 lds
  v_add_f32 v130, v130, v80
  v_add_f32 v131, v131, v81
  v_cvt_pk_bf16_f32 v118, v128, v129
  v_cvt_pk_bf16_f32 v119, v130, v131
  v_mfma_f32_16x16x32_bf16 v[176:179], a[128:131], v[42:45], v[176:179]
  s_waitcnt lgkmcnt(9)
  ds_read_b64_tr_b16 v[40:41], v24 offset:42336
  ds_write_b128 v8, v[116:119] offset:1024
  v_fma_f32 v78, v132, s88, v76
  v_fma_f32 v79, v133, s88, v76
  v_mfma_f32_16x16x32_bf16 v[180:183], a[48:51], v[46:49], v[180:183]
  ds_read_b64_tr_b16 v[42:43], v24 offset:41088
  v_fma_f32 v80, v134, s88, v76
  v_fma_f32 v81, v135, s88, v76
  v_exp_f32_e64 v78, v78 clamp
  v_mfma_f32_16x16x32_bf16 v[184:187], a[128:131], v[46:49], v[184:187]
  s_waitcnt lgkmcnt(10)
  ds_read_b64_tr_b16 v[44:45], v24 offset:42368
  v_max_f32 v132, 0x358637bd, v132
  v_exp_f32_e64 v79, v79 clamp
  v_mfma_f32_16x16x32_bf16 v[188:191], a[48:51], v[50:53], v[188:191]
  ds_read_b64_tr_b16 v[46:47], v26 offset:40960
  v_max_f32 v133, 0x358637bd, v133
  v_exp_f32_e64 v80, v80 clamp
  v_mfma_f32_16x16x32_bf16 v[192:195], a[128:131], v[50:53], v[192:195]
  s_waitcnt lgkmcnt(10)
  ds_read_b64_tr_b16 v[48:49], v26 offset:42240
  v_max_f32 v134, 0x358637bd, v134
  v_exp_f32_e64 v81, v81 clamp
  v_mfma_f32_16x16x32_bf16 v[156:159], a[52:55], v[54:57], v[156:159]
  ds_read_b64_tr_b16 v[50:51], v26 offset:40992
  buffer_load_dwordx4 v13, s[32:35], s75 offen offset:3072 lds
  v_max_f32 v135, 0x358637bd, v135
  v_add_f32 v132, v132, v78
  v_add_f32 v133, v133, v79
  v_mfma_f32_16x16x32_bf16 v[160:163], a[132:135], v[54:57], v[160:163]
  s_waitcnt lgkmcnt(10)
  ds_read_b64_tr_b16 v[52:53], v26 offset:42272
  s_add_u32 m0, s74, 0x15000
  v_add_f32 v134, v134, v80
  v_add_f32 v135, v135, v81
  v_cvt_pk_bf16_f32 v112, v132, v133
  v_cvt_pk_bf16_f32 v113, v134, v135
  v_mfma_f32_16x16x32_bf16 v[164:167], a[52:55], v[58:61], v[164:167]
  ds_read_b64_tr_b16 v[54:55], v26 offset:41024
  v_fma_f32 v78, v136, s88, v76
  v_fma_f32 v79, v137, s88, v76
  v_fma_f32 v80, v138, s88, v76
  v_mfma_f32_16x16x32_bf16 v[168:171], a[132:135], v[58:61], v[168:171]
  s_waitcnt lgkmcnt(10)
  ds_read_b64_tr_b16 v[56:57], v26 offset:42304
  v_fma_f32 v81, v139, s88, v76
  v_exp_f32_e64 v78, v78 clamp
  v_mfma_f32_16x16x32_bf16 v[172:175], a[52:55], v[62:65], v[172:175]
  ds_read_b64_tr_b16 v[58:59], v26 offset:41056
  v_max_f32 v136, 0x358637bd, v136
  v_exp_f32_e64 v79, v79 clamp
  v_mfma_f32_16x16x32_bf16 v[176:179], a[132:135], v[62:65], v[176:179]
  s_waitcnt lgkmcnt(10)
  ds_read_b64_tr_b16 v[60:61], v26 offset:42336
  v_max_f32 v137, 0x358637bd, v137
  v_exp_f32_e64 v80, v80 clamp
  v_mfma_f32_16x16x32_bf16 v[180:183], a[52:55], v[38:41], v[180:183]
  ds_read_b64_tr_b16 v[62:63], v26 offset:41088
  buffer_load_dwordx4 v14, s[32:35], s75 offen lds
  v_max_f32 v138, 0x358637bd, v138
  v_exp_f32_e64 v81, v81 clamp
  v_mfma_f32_16x16x32_bf16 v[184:187], a[132:135], v[38:41], v[184:187]
  s_waitcnt lgkmcnt(9)
  ds_read_b64_tr_b16 v[64:65], v26 offset:42368
  s_mul_i32 s75, s77, 0x780
  s_add_u32 s75, s75, s81
  v_max_f32 v139, 0x358637bd, v139
  v_add_f32 v136, v136, v78
  v_add_f32 v137, v137, v79
  v_mfma_f32_16x16x32_bf16 v[188:191], a[52:55], v[42:45], v[188:191]
  ds_read_b64_tr_b16 v[38:39], v28 offset:40960
  s_add_u32 m0, s74, 0x19000
  v_add_f32 v138, v138, v80
  v_add_f32 v139, v139, v81
  v_cvt_pk_bf16_f32 v114, v136, v137
  v_cvt_pk_bf16_f32 v115, v138, v139
  v_mfma_f32_16x16x32_bf16 v[192:195], a[132:135], v[42:45], v[192:195]
  s_waitcnt lgkmcnt(9)
  ds_read_b64_tr_b16 v[40:41], v28 offset:42240
  ds_write_b128 v8, v[112:115] offset:2048
  v_fma_f32 v78, v140, s88, v76
  v_fma_f32 v79, v141, s88, v76
  v_mfma_f32_16x16x32_bf16 v[156:159], a[56:59], v[46:49], v[156:159]
  ds_read_b64_tr_b16 v[42:43], v28 offset:40992
  v_fma_f32 v80, v142, s88, v76
  v_fma_f32 v81, v143, s88, v76
  v_exp_f32_e64 v78, v78 clamp
  v_mfma_f32_16x16x32_bf16 v[160:163], a[136:139], v[46:49], v[160:163]
  s_waitcnt lgkmcnt(10)
  ds_read_b64_tr_b16 v[44:45], v28 offset:42272
  v_max_f32 v140, 0x358637bd, v140
  v_exp_f32_e64 v79, v79 clamp
  v_mfma_f32_16x16x32_bf16 v[164:167], a[56:59], v[50:53], v[164:167]
  ds_read_b64_tr_b16 v[46:47], v28 offset:41024
  buffer_load_dwordx4 v10, s[32:35], s75 offen lds
  v_max_f32 v141, 0x358637bd, v141
  v_exp_f32_e64 v80, v80 clamp
  v_mfma_f32_16x16x32_bf16 v[168:171], a[136:139], v[50:53], v[168:171]
  s_waitcnt lgkmcnt(10)
  ds_read_b64_tr_b16 v[48:49], v28 offset:42304
  v_max_f32 v142, 0x358637bd, v142
  v_exp_f32_e64 v81, v81 clamp
  v_mfma_f32_16x16x32_bf16 v[172:175], a[56:59], v[54:57], v[172:175]
  ds_read_b64_tr_b16 v[50:51], v28 offset:41056
  v_max_f32 v143, 0x358637bd, v143
  v_add_f32 v140, v140, v78
  v_add_f32 v141, v141, v79
  v_mfma_f32_16x16x32_bf16 v[176:179], a[136:139], v[54:57], v[176:179]
  s_waitcnt lgkmcnt(10)
  ds_read_b64_tr_b16 v[52:53], v28 offset:42336
  v_add_f32 v142, v142, v80
  v_add_f32 v143, v143, v81
  v_cvt_pk_bf16_f32 v116, v140, v141
  v_cvt_pk_bf16_f32 v117, v142, v143
  v_mfma_f32_16x16x32_bf16 v[180:183], a[56:59], v[58:61], v[180:183]
  ds_read_b64_tr_b16 v[54:55], v28 offset:41088
  v_fma_f32 v78, v144, s88, v76
  v_fma_f32 v79, v145, s88, v76
  v_fma_f32 v80, v146, s88, v76
  v_mfma_f32_16x16x32_bf16 v[184:187], a[136:139], v[58:61], v[184:187]
  s_waitcnt lgkmcnt(10)
  ds_read_b64_tr_b16 v[56:57], v28 offset:42368
  v_fma_f32 v81, v147, s88, v76
  v_exp_f32_e64 v78, v78 clamp
  v_mfma_f32_16x16x32_bf16 v[188:191], a[56:59], v[62:65], v[188:191]
  s_waitcnt vmcnt(6)
  s_waitcnt lgkmcnt(8)
  s_barrier
  ds_read_b64_tr_b16 v[58:59], v23
  buffer_load_dwordx4 v11, s[32:35], s75 offen offset:1024 lds
  v_max_f32 v144, 0x358637bd, v144
  v_exp_f32_e64 v79, v79 clamp
  v_mfma_f32_16x16x32_bf16 v[192:195], a[136:139], v[62:65], v[192:195]
  ds_read_b64_tr_b16 v[60:61], v23 offset:1280
  v_max_f32 v145, 0x358637bd, v145
  v_exp_f32_e64 v80, v80 clamp
  v_mfma_f32_16x16x32_bf16 v[156:159], a[60:63], v[38:41], v[156:159]
  ds_read_b64_tr_b16 v[62:63], v23 offset:32
  v_max_f32 v146, 0x358637bd, v146
  v_exp_f32_e64 v81, v81 clamp
  v_mfma_f32_16x16x32_bf16 v[160:163], a[140:143], v[38:41], v[160:163]
  s_waitcnt lgkmcnt(9)
  ds_read_b64_tr_b16 v[64:65], v23 offset:1312
  v_max_f32 v147, 0x358637bd, v147
  v_add_f32 v144, v144, v78
  v_add_f32 v145, v145, v79
  v_mfma_f32_16x16x32_bf16 v[164:167], a[60:63], v[42:45], v[164:167]
  ds_read_b64_tr_b16 v[38:39], v23 offset:64
  v_add_f32 v146, v146, v80
  v_add_f32 v147, v147, v81
  v_cvt_pk_bf16_f32 v118, v144, v145
  v_cvt_pk_bf16_f32 v119, v146, v147
  v_mfma_f32_16x16x32_bf16 v[168:171], a[140:143], v[42:45], v[168:171]
  s_waitcnt lgkmcnt(9)
  ds_read_b64_tr_b16 v[40:41], v23 offset:1344
  ds_write_b128 v8, v[116:119] offset:3072
  v_fma_f32 v78, v148, s88, v76
  v_fma_f32 v79, v149, s88, v76
  v_mfma_f32_16x16x32_bf16 v[172:175], a[60:63], v[46:49], v[172:175]
  ds_read_b64_tr_b16 v[42:43], v23 offset:96
  buffer_load_dwordx4 v12, s[32:35], s75 offen offset:2048 lds
  v_fma_f32 v80, v150, s88, v76
  v_fma_f32 v81, v151, s88, v76
  v_exp_f32_e64 v78, v78 clamp
  v_mfma_f32_16x16x32_bf16 v[176:179], a[140:143], v[46:49], v[176:179]
  s_waitcnt lgkmcnt(10)
  ds_read_b64_tr_b16 v[44:45], v23 offset:1376
  v_max_f32 v148, 0x358637bd, v148
  v_exp_f32_e64 v79, v79 clamp
  v_mfma_f32_16x16x32_bf16 v[180:183], a[60:63], v[50:53], v[180:183]
  ds_read_b64_tr_b16 v[46:47], v23 offset:128
  v_max_f32 v149, 0x358637bd, v149
  v_exp_f32_e64 v80, v80 clamp
  v_mfma_f32_16x16x32_bf16 v[184:187], a[140:143], v[50:53], v[184:187]
  s_waitcnt lgkmcnt(10)
  ds_read_b64_tr_b16 v[48:49], v23 offset:1408
  v_max_f32 v150, 0x358637bd, v150
  v_exp_f32_e64 v81, v81 clamp
  v_mfma_f32_16x16x32_bf16 v[188:191], a[60:63], v[54:57], v[188:191]
  ds_read_b64_tr_b16 v[50:51], v25
  v_max_f32 v151, 0x358637bd, v151
  v_add_f32 v148, v148, v78
  v_add_f32 v149, v149, v79
  v_mfma_f32_16x16x32_bf16 v[192:195], a[140:143], v[54:57], v[192:195]
  s_waitcnt lgkmcnt(10)
  ds_read_b64_tr_b16 v[52:53], v25 offset:1280
  v_add_f32 v150, v150, v80
  v_add_f32 v151, v151, v81
  v_cvt_pk_bf16_f32 v112, v148, v149
  v_cvt_pk_bf16_f32 v113, v150, v151
  v_mfma_f32_16x16x32_bf16 v[156:159], a[64:67], v[58:61], v[156:159]
  ds_read_b64_tr_b16 v[54:55], v27
  buffer_load_dwordx4 v13, s[32:35], s75 offen offset:3072 lds
  v_fma_f32 v78, v152, s88, v76
  v_fma_f32 v79, v153, s88, v76
  v_fma_f32 v80, v154, s88, v76
  v_mfma_f32_16x16x32_bf16 v[160:163], a[144:147], v[58:61], v[160:163]
  s_waitcnt lgkmcnt(10)
  ds_read_b64_tr_b16 v[56:57], v27 offset:1280
  s_add_u32 m0, s74, 0x1a000
  v_fma_f32 v81, v155, s88, v76
  v_exp_f32_e64 v78, v78 clamp
  v_mfma_f32_16x16x32_bf16 v[164:167], a[64:67], v[62:65], v[164:167]
  ds_read_b64_tr_b16 v[58:59], v29
  v_max_f32 v152, 0x358637bd, v152
  v_exp_f32_e64 v79, v79 clamp
  v_mfma_f32_16x16x32_bf16 v[168:171], a[144:147], v[62:65], v[168:171]
  s_waitcnt lgkmcnt(10)
  ds_read_b64_tr_b16 v[60:61], v29 offset:1280
  v_max_f32 v153, 0x358637bd, v153
  v_exp_f32_e64 v80, v80 clamp
  v_mfma_f32_16x16x32_bf16 v[172:175], a[64:67], v[38:41], v[172:175]
  ds_read_b64_tr_b16 v[62:63], v25 offset:32
  v_max_f32 v154, 0x358637bd, v154
  v_exp_f32_e64 v81, v81 clamp
  v_mfma_f32_16x16x32_bf16 v[176:179], a[144:147], v[38:41], v[176:179]
  s_waitcnt lgkmcnt(9)
  ds_read_b64_tr_b16 v[64:65], v25 offset:1312
  v_max_f32 v155, 0x358637bd, v155
  v_add_f32 v152, v152, v78
  v_add_f32 v153, v153, v79
  v_mfma_f32_16x16x32_bf16 v[180:183], a[64:67], v[42:45], v[180:183]
  ds_read_b64_tr_b16 v[38:39], v27 offset:32
  buffer_load_dwordx4 v14, s[32:35], s75 offen lds
  v_add_f32 v154, v154, v80
  v_add_f32 v155, v155, v81
  v_cvt_pk_bf16_f32 v114, v152, v153
  v_cvt_pk_bf16_f32 v115, v154, v155
  v_mfma_f32_16x16x32_bf16 v[184:187], a[144:147], v[42:45], v[184:187]
  s_waitcnt lgkmcnt(9)
  ds_read_b64_tr_b16 v[40:41], v27 offset:1312
  s_mul_i32 s75, s78, 0x780
  s_add_u32 s75, s75, s81
  ds_write_b128 v8, v[112:115] offset:4096
  ds_write_b128 v8, v[104:107] offset:5120
  v_mfma_f32_16x16x32_bf16 v[188:191], a[64:67], v[46:49], v[188:191]
  ds_read_b64_tr_b16 v[42:43], v29 offset:32
  s_add_u32 m0, s74, 0
  v_mfma_f32_16x16x32_bf16 v[192:195], a[144:147], v[46:49], v[192:195]
  s_waitcnt lgkmcnt(11)
  ds_read_b64_tr_b16 v[44:45], v29 offset:1312
  s_waitcnt lgkmcnt(3)
  s_waitcnt lgkmcnt(2)
  s_barrier
  ds_read_b128 a[200:203], v82
  ds_read_b128 a[204:207], v83
  ds_read_b128 a[208:211], v84
  v_mfma_f32_16x16x32_bf16 v[156:159], a[68:71], v[50:53], v[156:159]
  ds_read_b64_tr_b16 v[46:47], v25 offset:64
  ds_read_b128 a[212:215], v82 offset:10240
  ds_read_b128 a[216:219], v83 offset:10240
  ds_read_b128 a[220:223], v84 offset:10240
  v_mfma_f32_16x16x32_bf16 v[160:163], a[148:151], v[50:53], v[160:163]
  ds_read_b64_tr_b16 v[48:49], v25 offset:1344
  ds_read_b128 a[224:227], v82 offset:20480
  ds_read_b128 a[228:231], v83 offset:20480
  ds_read_b128 a[232:235], v84 offset:20480
  v_mfma_f32_16x16x32_bf16 v[156:159], a[72:75], v[54:57], v[156:159]
  ds_read_b64_tr_b16 v[50:51], v27 offset:64
  buffer_load_dwordx4 v10, s[32:35], s75 offen lds
  ds_read_b128 a[236:239], v82 offset:30720
  ds_read_b128 a[240:243], v83 offset:30720
  ds_read_b128 a[244:247], v84 offset:30720
  v_mfma_f32_16x16x32_bf16 v[160:163], a[152:155], v[54:57], v[160:163]
  ds_read_b64_tr_b16 v[52:53], v27 offset:1344
  v_mov_b32 v112, 0x3f803f80
  v_mov_b32 v113, 0x3f803f80
  v_mov_b32 v114, 0x3f803f80
  v_mov_b32 v115, 0x3f803f80
  v_mfma_f32_16x16x32_bf16 v[156:159], a[76:79], v[58:61], v[156:159]
  ds_read_b64_tr_b16 v[54:55], v29 offset:64
  v_mfma_f32_16x16x32_bf16 v[160:163], a[156:159], v[58:61], v[160:163]
  ds_read_b64_tr_b16 v[56:57], v29 offset:1344
  v_mfma_f32_16x16x32_bf16 v[164:167], a[68:71], v[62:65], v[164:167]
  ds_read_b64_tr_b16 v[58:59], v25 offset:96
  v_mfma_f32_16x16x32_bf16 v[168:171], a[148:151], v[62:65], v[168:171]
  ds_read_b64_tr_b16 v[60:61], v25 offset:1376
  v_mfma_f32_16x16x32_bf16 v[164:167], a[72:75], v[38:41], v[164:167]
  ds_read_b64_tr_b16 v[62:63], v27 offset:96
  buffer_load_dwordx4 v11, s[32:35], s75 offen offset:1024 lds
  v_mfma_f32_16x16x32_bf16 v[168:171], a[152:155], v[38:41], v[168:171]
  s_waitcnt lgkmcnt(15)
  ds_read_b64_tr_b16 v[64:65], v27 offset:1376
  v_mfma_f32_16x16x32_bf16 v[164:167], a[76:79], v[42:45], v[164:167]
  ds_read_b64_tr_b16 v[38:39], v29 offset:96
  v_mfma_f32_16x16x32_bf16 v[168:171], a[156:159], v[42:45], v[168:171]
  s_waitcnt lgkmcnt(15)
  ds_read_b64_tr_b16 v[40:41], v29 offset:1376
  v_mfma_f32_16x16x32_bf16 v[172:175], a[68:71], v[46:49], v[172:175]
  ds_read_b64_tr_b16 v[42:43], v25 offset:128
  v_mfma_f32_16x16x32_bf16 v[176:179], a[148:151], v[46:49], v[176:179]
  s_waitcnt lgkmcnt(9)
  ds_read_b64_tr_b16 v[44:45], v25 offset:1408
  v_mfma_f32_16x16x32_bf16 v[172:175], a[72:75], v[50:53], v[172:175]
  ds_read_b64_tr_b16 v[46:47], v27 offset:128
  buffer_load_dwordx4 v12, s[32:35], s75 offen offset:2048 lds
  v_mfma_f32_16x16x32_bf16 v[176:179], a[152:155], v[50:53], v[176:179]
  s_waitcnt lgkmcnt(9)
  ds_read_b64_tr_b16 v[48:49], v27 offset:1408
  v_mfma_f32_16x16x32_bf16 v[172:175], a[76:79], v[54:57], v[172:175]
  ds_read_b64_tr_b16 v[50:51], v29 offset:128
  v_mfma_f32_16x16x32_bf16 v[176:179], a[156:159], v[54:57], v[176:179]
  s_waitcnt lgkmcnt(9)
  ds_read_b64_tr_b16 v[52:53], v29 offset:1408
  v_mfma_f32_16x16x32_bf16 v[180:183], a[68:71], v[58:61], v[180:183]
  s_waitcnt vmcnt(8)
  s_barrier
  ds_read_b64_tr_b16 v[54:55], v23 offset:20480
  ds_write_b128 v8, v[112:115]
  v_cvt_pk_bf16_f32 v16, v156, v157
  v_cvt_pk_bf16_f32 v17, v158, v159
  v_mfma_f32_16x16x32_bf16 v[184:187], a[148:151], v[58:61], v[184:187]
  s_waitcnt lgkmcnt(10)
  ds_read_b64_tr_b16 v[56:57], v23 offset:21760
  v_cvt_pk_bf16_f32 v18, v160, v161
  v_cvt_pk_bf16_f32 v19, v162, v163
  ds_write_b128 v8, v[16:19] offset:5120
  v_mfma_f32_16x16x32_bf16 v[180:183], a[72:75], v[62:65], v[180:183]
  ds_read_b64_tr_b16 v[58:59], v23 offset:20512
  buffer_load_dwordx4 v13, s[32:35], s75 offen offset:3072 lds
  buffer_load_dword v97, v98, s[44:47], 0 offen sc1
  v_cvt_pk_bf16_f32 v100, v164, v165
  v_cvt_pk_bf16_f32 v101, v166, v167
  v_cvt_pk_bf16_f32 v102, v168, v169
  v_cvt_pk_bf16_f32 v103, v170, v171
  v_mfma_f32_16x16x32_bf16 v[184:187], a[152:155], v[62:65], v[184:187]
  s_waitcnt lgkmcnt(11)
  ds_read_b64_tr_b16 v[60:61], v23 offset:21792
  s_add_u32 m0, s74, 0x1000
  ds_write_b128 v8, v[100:103] offset:6144
  v_cvt_pk_bf16_f32 v108, v172, v173
  v_cvt_pk_bf16_f32 v109, v174, v175
  v_mfma_f32_16x16x32_bf16 v[180:183], a[76:79], v[38:41], v[180:183]
  ds_read_b64_tr_b16 v[62:63], v23 offset:20544
  v_cvt_pk_bf16_f32 v110, v176, v177
  v_cvt_pk_bf16_f32 v111, v178, v179
  ds_write_b128 v8, v[108:111] offset:7168
  v_mfma_f32_16x16x32_bf16 v[184:187], a[156:159], v[38:41], v[184:187]
  s_waitcnt lgkmcnt(13)
  ds_read_b64_tr_b16 v[64:65], v23 offset:21824
  v_mfma_f32_16x16x32_bf16 v[188:191], a[68:71], v[42:45], v[188:191]
  ds_read_b64_tr_b16 v[38:39], v23 offset:20576
  v_mfma_f32_16x16x32_bf16 v[192:195], a[148:151], v[42:45], v[192:195]
  s_waitcnt lgkmcnt(13)
  ds_read_b64_tr_b16 v[40:41], v23 offset:21856
  v_cvt_pk_bf16_f32 v120, v180, v181
  v_cvt_pk_bf16_f32 v121, v182, v183
  v_cvt_pk_bf16_f32 v122, v184, v185
  v_cvt_pk_bf16_f32 v123, v186, v187
  v_mfma_f32_16x16x32_bf16 v[188:191], a[72:75], v[46:49], v[188:191]
  ds_read_b64_tr_b16 v[42:43], v23 offset:20608
  buffer_load_dwordx4 v14, s[32:35], s75 offen lds
  ds_write_b128 v8, v[120:123] offset:8192
  v_mfma_f32_16x16x32_bf16 v[192:195], a[152:155], v[46:49], v[192:195]
  s_waitcnt lgkmcnt(14)
  ds_read_b64_tr_b16 v[44:45], v23 offset:21888
  s_mul_i32 s75, s79, 0x780
  s_add_u32 s75, s75, s81
  v_mfma_f32_16x16x32_bf16 v[188:191], a[76:79], v[50:53], v[188:191]
  ds_read_b64_tr_b16 v[46:47], v25 offset:20480
  s_add_u32 m0, s74, 0x5000
  v_mfma_f32_16x16x32_bf16 v[192:195], a[156:159], v[50:53], v[192:195]
  s_waitcnt lgkmcnt(13)
  ds_read_b64_tr_b16 v[48:49], v25 offset:21760
  v_mfma_f32_16x16x32_bf16 v[124:127], v[54:57], a[0:3], v[34:37]
  ds_read_b64_tr_b16 v[50:51], v25 offset:20512
  v_mfma_f32_16x16x32_bf16 v[128:131], v[54:57], a[80:83], v[34:37]
  s_waitcnt lgkmcnt(12)
  ds_read_b64_tr_b16 v[52:53], v25 offset:21792
  v_cvt_pk_bf16_f32 v132, v188, v189
  v_cvt_pk_bf16_f32 v133, v190, v191
  v_cvt_pk_bf16_f32 v134, v192, v193
  v_cvt_pk_bf16_f32 v135, v194, v195
  ds_write_b128 v8, v[132:135] offset:9216
  v_mfma_f32_16x16x32_bf16 v[136:139], v[58:61], a[0:3], v[34:37]
  ds_read_b64_tr_b16 v[54:55], v25 offset:20544
  buffer_load_dwordx4 v10, s[32:35], s75 offen lds
  v_mfma_f32_16x16x32_bf16 v[140:143], v[58:61], a[80:83], v[34:37]
  s_waitcnt lgkmcnt(11)
  ds_read_b64_tr_b16 v[56:57], v25 offset:21824
  s_waitcnt lgkmcnt(8)
  s_waitcnt lgkmcnt(2)
  s_barrier
  ds_read_b128 v[16:19], v82 offset:5120
  ds_read_b128 v[100:103], v85 offset:5120
  ds_read_b128 v[108:111], v82 offset:15360
  ds_read_b128 v[112:115], v85 offset:15360
  ds_read_b128 v[116:119], v82 offset:25600
  ds_read_b128 v[120:123], v85 offset:25600
  ds_read_b128 v[132:135], v82 offset:35840
  ds_read_b128 v[144:147], v85 offset:35840
  v_mfma_f32_16x16x32_bf16 v[160:163], v[62:65], a[0:3], v[34:37]
  ds_read_b64_tr_b16 v[58:59], v25 offset:20576
  v_mfma_f32_16x16x32_bf16 v[164:167], v[62:65], a[80:83], v[34:37]
  ds_read_b64_tr_b16 v[60:61], v25 offset:21856
  v_mfma_f32_16x16x32_bf16 v[168:171], v[38:41], a[0:3], v[34:37]
  ds_read_b64_tr_b16 v[62:63], v25 offset:20608
  s_waitcnt lgkmcnt(9)
  v_mfma_f32_16x16x32_bf16 v[148:151], a[200:203], v[16:19], 0
  v_mfma_f32_16x16x32_bf16 v[156:159], a[204:207], v[16:19], 0
  v_mfma_f32_16x16x32_bf16 v[152:155], a[200:203], v[100:103], 0
  v_mfma_f32_16x16x32_bf16 v[156:159], a[208:211], v[100:103], v[156:159]
  s_waitcnt lgkmcnt(7)
  v_mfma_f32_16x16x32_bf16 v[148:151], a[212:215], v[108:111], v[148:151]
  v_mfma_f32_16x16x32_bf16 v[156:159], a[216:219], v[108:111], v[156:159]
  v_mfma_f32_16x16x32_bf16 v[152:155], a[212:215], v[112:115], v[152:155]
  v_mfma_f32_16x16x32_bf16 v[156:159], a[220:223], v[112:115], v[156:159]
  s_waitcnt lgkmcnt(5)
  v_mfma_f32_16x16x32_bf16 v[148:151], a[224:227], v[116:119], v[148:151]
  v_mfma_f32_16x16x32_bf16 v[156:159], a[228:231], v[116:119], v[156:159]
  v_mfma_f32_16x16x32_bf16 v[152:155], a[224:227], v[120:123], v[152:155]
  v_mfma_f32_16x16x32_bf16 v[156:159], a[232:235], v[120:123], v[156:159]
  s_waitcnt lgkmcnt(3)
  v_mfma_f32_16x16x32_bf16 v[148:151], a[236:239], v[132:135], v[148:151]
  v_mfma_f32_16x16x32_bf16 v[156:159], a[240:243], v[132:135], v[156:159]
  v_mfma_f32_16x16x32_bf16 v[152:155], a[236:239], v[144:147], v[152:155]
  v_mfma_f32_16x16x32_bf16 v[156:159], a[244:247], v[144:147], v[156:159]
  s_waitcnt vmcnt(2)
  s_mov_b32 s92, 0
L_hsk_spin:
  v_readfirstlane_b32 s26, v97
  s_nop 2
  s_cmp_ge_u32 s26, 16
  s_nop 0
  s_cbranch_scc1 L_hsk_done
  s_add_u32 s92, s92, 1
  s_cmp_gt_u32 s92, 0xfa0
  s_cbranch_scc1 L_hsk_done
  s_sleep 1
  buffer_load_dword v97, v98, s[44:47], 0 offen sc1
  s_waitcnt vmcnt(0)
  s_branch L_hsk_spin
L_hsk_done:
  buffer_store_dwordx4 v[148:151], v86, s[36:39], s98 offen sc1
  v_mfma_f32_16x16x32_bf16 v[16:19], v[38:41], a[80:83], v[34:37]
  ds_read_b64_tr_b16 v[64:65], v25 offset:21888
  v_mfma_f32_16x16x32_bf16 v[82:85], v[42:45], a[0:3], v[34:37]
  ds_read_b64_tr_b16 v[38:39], v27 offset:20480
  buffer_store_dwordx4 v[152:155], v89, s[36:39], s98 offen sc1
  v_mfma_f32_16x16x32_bf16 v[98:101], v[42:45], a[80:83], v[34:37]
  ds_read_b64_tr_b16 v[40:41], v27 offset:21760
  v_mfma_f32_16x16x32_bf16 v[124:127], v[46:49], a[4:7], v[124:127]
  ds_read_b64_tr_b16 v[42:43], v27 offset:20512
  buffer_store_dwordx4 v[156:159], v90, s[36:39], s98 offen sc1
  v_mfma_f32_16x16x32_bf16 v[128:131], v[46:49], a[84:87], v[128:131]
  ds_read_b64_tr_b16 v[44:45], v27 offset:21792
  v_mfma_f32_16x16x32_bf16 v[136:139], v[50:53], a[4:7], v[136:139]
  ds_read_b64_tr_b16 v[46:47], v27 offset:20544
  v_mfma_f32_16x16x32_bf16 v[140:143], v[50:53], a[84:87], v[140:143]
  ds_read_b64_tr_b16 v[48:49], v27 offset:21824
  v_mfma_f32_16x16x32_bf16 v[160:163], v[54:57], a[4:7], v[160:163]
  ds_read_b64_tr_b16 v[50:51], v27 offset:20576
  v_mfma_f32_16x16x32_bf16 v[164:167], v[54:57], a[84:87], v[164:167]
  s_waitcnt lgkmcnt(9)
  ds_read_b64_tr_b16 v[52:53], v27 offset:21856
  v_mfma_f32_16x16x32_bf16 v[168:171], v[58:61], a[4:7], v[168:171]
  ds_read_b64_tr_b16 v[54:55], v27 offset:20608
  buffer_load_dwordx4 v11, s[32:35], s75 offen offset:1024 lds
  v_mfma_f32_16x16x32_bf16 v[16:19], v[58:61], a[84:87], v[16:19]
  s_waitcnt lgkmcnt(9)
  ds_read_b64_tr_b16 v[56:57], v27 offset:21888
  v_mfma_f32_16x16x32_bf16 v[82:85], v[62:65], a[4:7], v[82:85]
  ds_read_b64_tr_b16 v[58:59], v29 offset:20480
  v_mfma_f32_16x16x32_bf16 v[98:101], v[62:65], a[84:87], v[98:101]
  s_waitcnt lgkmcnt(9)
  ds_read_b64_tr_b16 v[60:61], v29 offset:21760
  v_mfma_f32_16x16x32_bf16 v[124:127], v[38:41], a[8:11], v[124:127]
  ds_read_b64_tr_b16 v[62:63], v29 offset:20512
  v_mfma_f32_16x16x32_bf16 v[128:131], v[38:41], a[88:91], v[128:131]
  s_waitcnt lgkmcnt(9)
  ds_read_b64_tr_b16 v[64:65], v29 offset:21792
  v_mfma_f32_16x16x32_bf16 v[136:139], v[42:45], a[8:11], v[136:139]
  ds_read_b64_tr_b16 v[38:39], v29 offset:20544
  buffer_load_dwordx4 v12, s[32:35], s75 offen offset:2048 lds
  v_mfma_f32_16x16x32_bf16 v[140:143], v[42:45], a[88:91], v[140:143]
  s_waitcnt lgkmcnt(9)
  ds_read_b64_tr_b16 v[40:41], v29 offset:21824
  v_mfma_f32_16x16x32_bf16 v[160:163], v[46:49], a[8:11], v[160:163]
  ds_read_b64_tr_b16 v[42:43], v29 offset:20576
  v_mfma_f32_16x16x32_bf16 v[164:167], v[46:49], a[88:91], v[164:167]
  s_waitcnt lgkmcnt(9)
  ds_read_b64_tr_b16 v[44:45], v29 offset:21856
  v_mfma_f32_16x16x32_bf16 v[168:171], v[50:53], a[8:11], v[168:171]
  ds_read_b64_tr_b16 v[46:47], v29 offset:20608
  v_mfma_f32_16x16x32_bf16 v[16:19], v[50:53], a[88:91], v[16:19]
  s_waitcnt lgkmcnt(9)
  ds_read_b64_tr_b16 v[48:49], v29 offset:21888
  v_mfma_f32_16x16x32_bf16 v[82:85], v[54:57], a[8:11], v[82:85]
  s_barrier
  ds_read_b64_tr_b16 v[50:51], v23 offset:40960
  buffer_load_dwordx4 v13, s[32:35], s75 offen offset:3072 lds
  ds_write_b128 v96, v[104:107]
  ds_write_b128 v96, v[104:107] offset:4096
  ds_write_b128 v96, v[104:107] offset:8192
  v_mfma_f32_16x16x32_bf16 v[98:101], v[54:57], a[88:91], v[98:101]
  s_waitcnt lgkmcnt(12)
  ds_read_b64_tr_b16 v[52:53], v23 offset:42240
  s_add_u32 m0, s74, 0x6000
  ds_write_b128 v96, v[104:107] offset:12288
  ds_write_b128 v96, v[104:107] offset:16384
  v_mov_b64 v[154:155], 0
  v_mov_b64 v[182:183], 0
  v_mfma_f32_16x16x32_bf16 v[124:127], v[58:61], a[12:15], v[124:127]
  ds_read_b64_tr_b16 v[54:55], v23 offset:40992
  v_mfma_f32_16x16x32_bf16 v[128:131], v[58:61], a[92:95], v[128:131]
  s_waitcnt lgkmcnt(14)
  ds_read_b64_tr_b16 v[56:57], v23 offset:42272
  v_mfma_f32_16x16x32_bf16 v[136:139], v[62:65], a[12:15], v[136:139]
  ds_read_b64_tr_b16 v[58:59], v23 offset:41024
  v_mfma_f32_16x16x32_bf16 v[140:143], v[62:65], a[92:95], v[140:143]
  s_waitcnt lgkmcnt(14)
  ds_read_b64_tr_b16 v[60:61], v23 offset:42304
  v_mfma_f32_16x16x32_bf16 v[160:163], v[38:41], a[12:15], v[160:163]
  ds_read_b64_tr_b16 v[62:63], v23 offset:41056
  buffer_load_dwordx4 v14, s[32:35], s75 offen lds
  v_mfma_f32_16x16x32_bf16 v[164:167], v[38:41], a[92:95], v[164:167]
  s_waitcnt lgkmcnt(14)
  ds_read_b64_tr_b16 v[64:65], v23 offset:42336
  s_mul_i32 s75, s80, 0x780
  s_add_u32 s75, s75, s81
  v_mfma_f32_16x16x32_bf16 v[168:171], v[42:45], a[12:15], v[168:171]
  ds_read_b64_tr_b16 v[38:39], v23 offset:41088
  s_add_u32 m0, s74, 0xa000
  v_mfma_f32_16x16x32_bf16 v[16:19], v[42:45], a[92:95], v[16:19]
  s_waitcnt lgkmcnt(14)
  ds_read_b64_tr_b16 v[40:41], v23 offset:42368
  v_mfma_f32_16x16x32_bf16 v[82:85], v[46:49], a[12:15], v[82:85]
  ds_read_b64_tr_b16 v[42:43], v25 offset:40960
  v_mfma_f32_16x16x32_bf16 v[98:101], v[46:49], a[92:95], v[98:101]
  s_waitcnt lgkmcnt(11)
  ds_read_b64_tr_b16 v[44:45], v25 offset:42240
  v_mfma_f32_16x16x32_bf16 v[124:127], v[50:53], a[16:19], v[124:127]
  ds_read_b64_tr_b16 v[46:47], v25 offset:40992
  buffer_load_dwordx4 v10, s[32:35], s75 offen lds
  v_mfma_f32_16x16x32_bf16 v[128:131], v[50:53], a[96:99], v[128:131]
  s_waitcnt lgkmcnt(9)
  ds_read_b64_tr_b16 v[48:49], v25 offset:42272
  v_mfma_f32_16x16x32_bf16 v[136:139], v[54:57], a[16:19], v[136:139]
  ds_read_b64_tr_b16 v[50:51], v25 offset:41024
  v_mfma_f32_16x16x32_bf16 v[140:143], v[54:57], a[96:99], v[140:143]
  s_waitcnt lgkmcnt(9)
  ds_read_b64_tr_b16 v[52:53], v25 offset:42304
  v_mfma_f32_16x16x32_bf16 v[160:163], v[58:61], a[16:19], v[160:163]
  ds_read_b64_tr_b16 v[54:55], v25 offset:41056
  v_mfma_f32_16x16x32_bf16 v[164:167], v[58:61], a[96:99], v[164:167]
  s_waitcnt lgkmcnt(9)
  ds_read_b64_tr_b16 v[56:57], v25 offset:42336
  v_mfma_f32_16x16x32_bf16 v[168:171], v[62:65], a[16:19], v[168:171]
  ds_read_b64_tr_b16 v[58:59], v25 offset:41088
  buffer_load_dwordx4 v11, s[32:35], s75 offen offset:1024 lds
  v_mfma_f32_16x16x32_bf16 v[16:19], v[62:65], a[96:99], v[16:19]
  s_waitcnt lgkmcnt(9)
  ds_read_b64_tr_b16 v[60:61], v25 offset:42368
  v_mfma_f32_16x16x32_bf16 v[82:85], v[38:41], a[16:19], v[82:85]
  ds_read_b64_tr_b16 v[62:63], v27 offset:40960
  v_mfma_f32_16x16x32_bf16 v[98:101], v[38:41], a[96:99], v[98:101]
  s_waitcnt lgkmcnt(9)
  ds_read_b64_tr_b16 v[64:65], v27 offset:42240
  v_mfma_f32_16x16x32_bf16 v[124:127], v[42:45], a[20:23], v[124:127]
  ds_read_b64_tr_b16 v[38:39], v27 offset:40992
  v_mfma_f32_16x16x32_bf16 v[128:131], v[42:45], a[100:103], v[128:131]
  s_waitcnt lgkmcnt(9)
  ds_read_b64_tr_b16 v[40:41], v27 offset:42272
  v_mfma_f32_16x16x32_bf16 v[136:139], v[46:49], a[20:23], v[136:139]
  ds_read_b64_tr_b16 v[42:43], v27 offset:41024
  buffer_load_dwordx4 v12, s[32:35], s75 offen offset:2048 lds
  v_mfma_f32_16x16x32_bf16 v[140:143], v[46:49], a[100:103], v[140:143]
  s_waitcnt lgkmcnt(9)
  ds_read_b64_tr_b16 v[44:45], v27 offset:42304
  v_mfma_f32_16x16x32_bf16 v[160:163], v[50:53], a[20:23], v[160:163]
  ds_read_b64_tr_b16 v[46:47], v27 offset:41056
  v_mfma_f32_16x16x32_bf16 v[164:167], v[50:53], a[100:103], v[164:167]
  s_waitcnt lgkmcnt(9)
  ds_read_b64_tr_b16 v[48:49], v27 offset:42336
  v_mfma_f32_16x16x32_bf16 v[168:171], v[54:57], a[20:23], v[168:171]
  ds_read_b64_tr_b16 v[50:51], v27 offset:41088
  v_mfma_f32_16x16x32_bf16 v[16:19], v[54:57], a[100:103], v[16:19]
  s_waitcnt lgkmcnt(9)
  ds_read_b64_tr_b16 v[52:53], v27 offset:42368
  v_mfma_f32_16x16x32_bf16 v[82:85], v[58:61], a[20:23], v[82:85]
  ds_read_b64_tr_b16 v[54:55], v29 offset:40960
  buffer_load_dwordx4 v13, s[32:35], s75 offen offset:3072 lds
  v_mfma_f32_16x16x32_bf16 v[98:101], v[58:61], a[100:103], v[98:101]
  s_waitcnt lgkmcnt(9)
  ds_read_b64_tr_b16 v[56:57], v29 offset:42240
  s_add_u32 m0, s74, 0xb000
  v_mfma_f32_16x16x32_bf16 v[124:127], v[62:65], a[24:27], v[124:127]
  ds_read_b64_tr_b16 v[58:59], v29 offset:40992
  v_mfma_f32_16x16x32_bf16 v[128:131], v[62:65], a[104:107], v[128:131]
  s_waitcnt lgkmcnt(9)
  ds_read_b64_tr_b16 v[60:61], v29 offset:42272
  v_mfma_f32_16x16x32_bf16 v[136:139], v[38:41], a[24:27], v[136:139]
  ds_read_b64_tr_b16 v[62:63], v29 offset:41024
  v_mfma_f32_16x16x32_bf16 v[140:143], v[38:41], a[104:107], v[140:143]
  s_waitcnt lgkmcnt(9)
  ds_read_b64_tr_b16 v[64:65], v29 offset:42304
  v_mfma_f32_16x16x32_bf16 v[160:163], v[42:45], a[24:27], v[160:163]
  ds_read_b64_tr_b16 v[38:39], v29 offset:41056
  buffer_load_dwordx4 v14, s[32:35], s75 offen lds
  v_mfma_f32_16x16x32_bf16 v[164:167], v[42:45], a[104:107], v[164:167]
  s_waitcnt lgkmcnt(9)
  ds_read_b64_tr_b16 v[40:41], v29 offset:42336
  v_mfma_f32_16x16x32_bf16 v[168:171], v[46:49], a[24:27], v[168:171]
  ds_read_b64_tr_b16 v[42:43], v29 offset:41088
  v_mfma_f32_16x16x32_bf16 v[16:19], v[46:49], a[104:107], v[16:19]
  s_waitcnt lgkmcnt(9)
  ds_read_b64_tr_b16 v[44:45], v29 offset:42368
  v_lshrrev_b32 v15, 1, v1
  v_mul_u32_u24 v15, 0x500, v15
  v_and_b32 v20, 1, v1
  v_mul_u32_u24 v20, 0x9c, v20
  v_add_u32 v15, v15, v20
  s_mul_i32 s93, s22, 0x32000
  s_add_u32 s93, s93, 0x14000
  v_lshrrev_b32 v20, 5, v1
  v_mul_u32_u24 v20, 0x14000, v20
  v_add_u32 v20, v15, v20
  s_mul_i32 s21, s73, 0xa0
  s_add_u32 s93, s93, s21
  buffer_load_dword v21, v20, s[40:43], s93 offen
  v_mfma_f32_16x16x32_bf16 v[82:85], v[50:53], a[24:27], v[82:85]
  s_waitcnt vmcnt(14)
  s_barrier
  ds_read_b64_tr_b16 v[46:47], v9
  v_mfma_f32_16x16x32_bf16 v[98:101], v[50:53], a[104:107], v[98:101]
  s_waitcnt lgkmcnt(9)
  ds_read_b64_tr_b16 v[48:49], v9 offset:1280
  buffer_load_dwordx4 v[108:111], v68, s[36:39], s85 offen sc1
  v_mfma_f32_16x16x32_bf16 v[124:127], v[54:57], a[28:31], v[124:127]
  ds_read_b64_tr_b16 v[50:51], v24
  v_mfma_f32_16x16x32_bf16 v[128:131], v[54:57], a[108:111], v[128:131]
  s_waitcnt lgkmcnt(9)
  ds_read_b64_tr_b16 v[52:53], v24 offset:1280
  buffer_load_dwordx4 v[112:115], v68, s[36:39], s85 offen offset:1024 sc1
  v_mfma_f32_16x16x32_bf16 v[136:139], v[58:61], a[28:31], v[136:139]
  ds_read_b64_tr_b16 v[54:55], v26
  v_mfma_f32_16x16x32_bf16 v[140:143], v[58:61], a[108:111], v[140:143]
  s_waitcnt lgkmcnt(9)
  ds_read_b64_tr_b16 v[56:57], v26 offset:1280
  v_mfma_f32_16x16x32_bf16 v[160:163], v[62:65], a[28:31], v[160:163]
  ds_read_b64_tr_b16 v[58:59], v28
  v_mfma_f32_16x16x32_bf16 v[164:167], v[62:65], a[108:111], v[164:167]
  s_waitcnt lgkmcnt(9)
  ds_read_b64_tr_b16 v[60:61], v28 offset:1280
  v_mfma_f32_16x16x32_bf16 v[168:171], v[38:41], a[28:31], v[168:171]
  s_waitcnt vmcnt(8)
  s_barrier
  ds_read_b64_tr_b16 v[62:63], v9 offset:20480
  v_mfma_f32_16x16x32_bf16 v[16:19], v[38:41], a[108:111], v[16:19]
  s_waitcnt lgkmcnt(9)
  ds_read_b64_tr_b16 v[64:65], v9 offset:21760
  v_mfma_f32_16x16x32_bf16 v[82:85], v[42:45], a[28:31], v[82:85]
  ds_read_b64_tr_b16 v[38:39], v24 offset:20480
  s_mul_i32 s90, s22, 0x32000
  s_add_u32 s93, s72, 0
  s_and_b32 s21, s93, 1
  s_mul_i32 s21, s21, 0xa000
  s_add_u32 s90, s90, s21
  s_bfe_u32 s21, s93, 0x10001
  s_mul_i32 s21, s21, 0x19000
  s_add_u32 s90, s90, s21
  s_add_u32 m0, s74, 0xf000
  s_nop 0
  buffer_load_dwordx4 v70, s[40:43], s90 offen lds
  v_mfma_f32_16x16x32_bf16 v[98:101], v[42:45], a[108:111], v[98:101]
  s_waitcnt lgkmcnt(9)
  ds_read_b64_tr_b16 v[40:41], v24 offset:21760
  v_mfma_f32_16x16x32_bf16 v[124:127], v[46:49], a[32:35], v[124:127]
  ds_read_b64_tr_b16 v[42:43], v26 offset:20480
  v_mfma_f32_16x16x32_bf16 v[128:131], v[46:49], a[112:115], v[128:131]
  s_waitcnt lgkmcnt(9)
  ds_read_b64_tr_b16 v[44:45], v26 offset:21760
  v_mfma_f32_16x16x32_bf16 v[124:127], v[50:53], a[36:39], v[124:127]
  ds_read_b64_tr_b16 v[46:47], v28 offset:20480
  v_mfma_f32_16x16x32_bf16 v[128:131], v[50:53], a[116:119], v[128:131]
  s_waitcnt lgkmcnt(9)
  ds_read_b64_tr_b16 v[48:49], v28 offset:21760
  v_mfma_f32_16x16x32_bf16 v[124:127], v[54:57], a[40:43], v[124:127]
  s_waitcnt vmcnt(4)
  s_barrier
  ds_read_b64_tr_b16 v[50:51], v9 offset:40960
  v_mfma_f32_16x16x32_bf16 v[128:131], v[54:57], a[120:123], v[128:131]
  s_waitcnt lgkmcnt(9)
  ds_read_b64_tr_b16 v[52:53], v9 offset:42240
  buffer_load_dwordx4 v71, s[40:43], s90 offen offset:1024 lds
  v_mfma_f32_16x16x32_bf16 v[124:127], v[58:61], a[44:47], v[124:127]
  ds_read_b64_tr_b16 v[54:55], v24 offset:40960
  v_mfma_f32_16x16x32_bf16 v[128:131], v[58:61], a[124:127], v[128:131]
  s_waitcnt lgkmcnt(9)
  ds_read_b64_tr_b16 v[56:57], v24 offset:42240
  v_mfma_f32_16x16x32_bf16 v[124:127], v[62:65], a[48:51], v[124:127]
  ds_read_b64_tr_b16 v[58:59], v26 offset:40960
  v_mfma_f32_16x16x32_bf16 v[128:131], v[62:65], a[128:131], v[128:131]
  s_waitcnt lgkmcnt(9)
  ds_read_b64_tr_b16 v[60:61], v26 offset:42240
  v_mfma_f32_16x16x32_bf16 v[124:127], v[38:41], a[52:55], v[124:127]
  ds_read_b64_tr_b16 v[62:63], v28 offset:40960
  v_mfma_f32_16x16x32_bf16 v[128:131], v[38:41], a[132:135], v[128:131]
  s_waitcnt lgkmcnt(9)
  ds_read_b64_tr_b16 v[64:65], v28 offset:42240
  v_mfma_f32_16x16x32_bf16 v[124:127], v[42:45], a[56:59], v[124:127]
  ds_read_b64_tr_b16 v[38:39], v9 offset:32
  buffer_load_dwordx4 v72, s[40:43], s90 offen offset:2048 lds
  v_mfma_f32_16x16x32_bf16 v[128:131], v[42:45], a[136:139], v[128:131]
  s_waitcnt lgkmcnt(9)
  ds_read_b64_tr_b16 v[40:41], v9 offset:1312
  v_mfma_f32_16x16x32_bf16 v[124:127], v[46:49], a[60:63], v[124:127]
  ds_read_b64_tr_b16 v[42:43], v24 offset:32
  v_mfma_f32_16x16x32_bf16 v[128:131], v[46:49], a[140:143], v[128:131]
  s_waitcnt lgkmcnt(9)
  ds_read_b64_tr_b16 v[44:45], v24 offset:1312
  v_mfma_f32_16x16x32_bf16 v[124:127], v[50:53], a[64:67], v[124:127]
  ds_read_b64_tr_b16 v[46:47], v26 offset:32
  v_mfma_f32_16x16x32_bf16 v[128:131], v[50:53], a[144:147], v[128:131]
  s_waitcnt lgkmcnt(9)
  ds_read_b64_tr_b16 v[48:49], v26 offset:1312
  v_mfma_f32_16x16x32_bf16 v[124:127], v[54:57], a[68:71], v[124:127]
  ds_read_b64_tr_b16 v[50:51], v28 offset:32
  v_mfma_f32_16x16x32_bf16 v[128:131], v[54:57], a[148:151], v[128:131]
  s_waitcnt lgkmcnt(9)
  ds_read_b64_tr_b16 v[52:53], v28 offset:1312
  buffer_load_dwordx4 v73, s[40:43], s90 offen offset:3072 lds
  v_mfma_f32_16x16x32_bf16 v[124:127], v[58:61], a[72:75], v[124:127]
  ds_read_b64_tr_b16 v[54:55], v9 offset:20512
  v_mfma_f32_16x16x32_bf16 v[128:131], v[58:61], a[152:155], v[128:131]
  s_waitcnt lgkmcnt(9)
  ds_read_b64_tr_b16 v[56:57], v9 offset:21792
  v_mfma_f32_16x16x32_bf16 v[124:127], v[62:65], a[76:79], v[124:127]
  ds_read_b64_tr_b16 v[58:59], v24 offset:20512
  v_mfma_f32_16x16x32_bf16 v[128:131], v[62:65], a[156:159], v[128:131]
  s_waitcnt lgkmcnt(9)
  ds_read_b64_tr_b16 v[60:61], v24 offset:21792
  v_mfma_f32_16x16x32_bf16 v[136:139], v[38:41], a[32:35], v[136:139]
  ds_read_b64_tr_b16 v[62:63], v26 offset:20512
  v_mfma_f32_16x16x32_bf16 v[140:143], v[38:41], a[112:115], v[140:143]
  s_waitcnt lgkmcnt(9)
  ds_read_b64_tr_b16 v[64:65], v26 offset:21792
  v_fma_f32 v78, v124, s88, v76
  v_fma_f32 v79, v125, s88, v76
  v_fma_f32 v80, v126, s88, v76
  v_mfma_f32_16x16x32_bf16 v[136:139], v[42:45], a[36:39], v[136:139]
  ds_read_b64_tr_b16 v[38:39], v28 offset:20512
  s_add_u32 m0, s74, 0x10000
  s_nop 0
  buffer_load_dwordx4 v74, s[40:43], s90 offen lds
  v_fma_f32 v81, v127, s88, v76
  v_exp_f32_e64 v78, v78 clamp
  v_mfma_f32_16x16x32_bf16 v[140:143], v[42:45], a[116:119], v[140:143]
  s_waitcnt lgkmcnt(9)
  ds_read_b64_tr_b16 v[40:41], v28 offset:21792
  v_max_f32 v124, 0x358637bd, v124
  v_exp_f32_e64 v79, v79 clamp
  v_mfma_f32_16x16x32_bf16 v[136:139], v[46:49], a[40:43], v[136:139]
  ds_read_b64_tr_b16 v[42:43], v9 offset:40992
  v_max_f32 v125, 0x358637bd, v125
  v_exp_f32_e64 v80, v80 clamp
  v_mfma_f32_16x16x32_bf16 v[140:143], v[46:49], a[120:123], v[140:143]
  s_waitcnt lgkmcnt(9)
  ds_read_b64_tr_b16 v[44:45], v9 offset:42272
  v_max_f32 v126, 0x358637bd, v126
  v_exp_f32_e64 v81, v81 clamp
  v_mfma_f32_16x16x32_bf16 v[136:139], v[50:53], a[44:47], v[136:139]
  ds_read_b64_tr_b16 v[46:47], v24 offset:40992
  v_max_f32 v127, 0x358637bd, v127
  v_add_f32 v124, v124, v78
  v_add_f32 v125, v125, v79
  v_mfma_f32_16x16x32_bf16 v[140:143], v[50:53], a[124:127], v[140:143]
  s_waitcnt lgkmcnt(9)
  ds_read_b64_tr_b16 v[48:49], v24 offset:42272
  v_add_f32 v126, v126, v80
  v_add_f32 v127, v127, v81
  v_cvt_pk_bf16_f32 v144, v124, v125
  v_cvt_pk_bf16_f32 v145, v126, v127
  v_mfma_f32_16x16x32_bf16 v[136:139], v[54:57], a[48:51], v[136:139]
  ds_read_b64_tr_b16 v[50:51], v26 offset:40992
  v_fma_f32 v78, v128, s88, v76
  v_fma_f32 v79, v129, s88, v76
  v_fma_f32 v80, v130, s88, v76
  v_mfma_f32_16x16x32_bf16 v[140:143], v[54:57], a[128:131], v[140:143]
  s_waitcnt lgkmcnt(9)
  ds_read_b64_tr_b16 v[52:53], v26 offset:42272
  s_mul_i32 s90, s22, 0x32000
  s_add_u32 s93, s72, 1
  s_and_b32 s21, s93, 1
  s_mul_i32 s21, s21, 0xa000
  s_add_u32 s90, s90, s21
  s_bfe_u32 s21, s93, 0x10001
  s_mul_i32 s21, s21, 0x19000
  s_add_u32 s90, s90, s21
  s_add_u32 m0, s74, 0x14000
  s_nop 0
  buffer_load_dwordx4 v70, s[40:43], s90 offen lds
  v_fma_f32 v81, v131, s88, v76
  v_exp_f32_e64 v78, v78 clamp
  v_mfma_f32_16x16x32_bf16 v[136:139], v[58:61], a[52:55], v[136:139]
  ds_read_b64_tr_b16 v[54:55], v28 offset:40992
  v_max_f32 v128, 0x358637bd, v128
  v_exp_f32_e64 v79, v79 clamp
  v_mfma_f32_16x16x32_bf16 v[140:143], v[58:61], a[132:135], v[140:143]
  s_waitcnt lgkmcnt(9)
  ds_read_b64_tr_b16 v[56:57], v28 offset:42272
  v_max_f32 v129, 0x358637bd, v129
  v_exp_f32_e64 v80, v80 clamp
  v_mfma_f32_16x16x32_bf16 v[136:139], v[62:65], a[56:59], v[136:139]
  ds_read_b64_tr_b16 v[58:59], v9 offset:64
  v_max_f32 v130, 0x358637bd, v130
  v_exp_f32_e64 v81, v81 clamp
  v_mfma_f32_16x16x32_bf16 v[140:143], v[62:65], a[136:139], v[140:143]
  s_waitcnt lgkmcnt(9)
  ds_read_b64_tr_b16 v[60:61], v9 offset:1344
  v_max_f32 v131, 0x358637bd, v131
  v_add_f32 v128, v128, v78
  v_add_f32 v129, v129, v79
  v_mfma_f32_16x16x32_bf16 v[136:139], v[38:41], a[60:63], v[136:139]
  ds_read_b64_tr_b16 v[62:63], v24 offset:64
  v_add_f32 v130, v130, v80
  v_add_f32 v131, v131, v81
  v_cvt_pk_bf16_f32 v172, v128, v129
  v_cvt_pk_bf16_f32 v173, v130, v131
  v_mfma_f32_16x16x32_bf16 v[140:143], v[38:41], a[140:143], v[140:143]
  s_waitcnt lgkmcnt(9)
  ds_read_b64_tr_b16 v[64:65], v24 offset:1344
  s_waitcnt vmcnt(6)
  s_mov_b32 s92, 0
L_ko_spin:
  v_add_f32 v108, v108, v112
  v_add_f32 v109, v109, v113
  v_add_f32 v110, v110, v114
  v_add_f32 v111, v111, v115
  s_nop 0
  v_permlane32_swap_b32 v108, v110
  v_permlane32_swap_b32 v109, v111
  v_add_f32 v108, v108, v110
  v_add_f32 v109, v109, v111
  s_nop 1
  v_permlane16_swap_b32 v108, v109
  v_add_f32 v108, v108, v109
  s_nop 1
  v_add_f32_dpp v109, v108, v108 row_ror:8 row_mask:0xf bank_mask:0xf
  v_cmp_u_f32 vcc, v109, v109
  s_nop 4
  s_cbranch_vccz L_ko_done
  s_add_u32 s92, s92, 1
  s_cmp_gt_u32 s92, 0xfa0
  s_cbranch_scc1 L_ko_done
  s_sleep 2
  buffer_load_dwordx4 v[108:111], v68, s[36:39], s85 offen sc1
  buffer_load_dwordx4 v[112:115], v68, s[36:39], s85 offen offset:1024 sc1
  s_waitcnt vmcnt(0)
  s_branch L_ko_spin
L_ko_done:
  buffer_store_dword v109, v69, s[36:39], s86 offen sc1
  v_mfma_f32_16x16x32_bf16 v[136:139], v[42:45], a[64:67], v[136:139]
  ds_read_b64_tr_b16 v[38:39], v26 offset:64
  v_mfma_f32_16x16x32_bf16 v[140:143], v[42:45], a[144:147], v[140:143]
  s_waitcnt lgkmcnt(9)
  ds_read_b64_tr_b16 v[40:41], v26 offset:1344
  v_mfma_f32_16x16x32_bf16 v[136:139], v[46:49], a[68:71], v[136:139]
  ds_read_b64_tr_b16 v[42:43], v28 offset:64
  v_mfma_f32_16x16x32_bf16 v[140:143], v[46:49], a[148:151], v[140:143]
  s_waitcnt lgkmcnt(9)
  ds_read_b64_tr_b16 v[44:45], v28 offset:1344
  v_mfma_f32_16x16x32_bf16 v[136:139], v[50:53], a[72:75], v[136:139]
  ds_read_b64_tr_b16 v[46:47], v9 offset:20544
  v_mfma_f32_16x16x32_bf16 v[140:143], v[50:53], a[152:155], v[140:143]
  s_waitcnt lgkmcnt(9)
  ds_read_b64_tr_b16 v[48:49], v9 offset:21824
  v_mfma_f32_16x16x32_bf16 v[136:139], v[54:57], a[76:79], v[136:139]
  ds_read_b64_tr_b16 v[50:51], v24 offset:20544
  buffer_load_dwordx4 v71, s[40:43], s90 offen offset:1024 lds
  v_mfma_f32_16x16x32_bf16 v[140:143], v[54:57], a[156:159], v[140:143]
  s_waitcnt lgkmcnt(9)
  ds_read_b64_tr_b16 v[52:53], v24 offset:21824
  v_mfma_f32_16x16x32_bf16 v[160:163], v[58:61], a[32:35], v[160:163]
  ds_read_b64_tr_b16 v[54:55], v26 offset:20544
  v_mfma_f32_16x16x32_bf16 v[164:167], v[58:61], a[112:115], v[164:167]
  s_waitcnt lgkmcnt(9)
  ds_read_b64_tr_b16 v[56:57], v26 offset:21824
  v_fma_f32 v78, v136, s88, v76
  v_fma_f32 v79, v137, s88, v76
  v_fma_f32 v80, v138, s88, v76
  v_mfma_f32_16x16x32_bf16 v[160:163], v[62:65], a[36:39], v[160:163]
  ds_read_b64_tr_b16 v[58:59], v28 offset:20544
  v_fma_f32 v81, v139, s88, v76
  v_exp_f32_e64 v78, v78 clamp
  v_mfma_f32_16x16x32_bf16 v[164:167], v[62:65], a[116:119], v[164:167]
  s_waitcnt lgkmcnt(9)
  ds_read_b64_tr_b16 v[60:61], v28 offset:21824
  v_max_f32 v136, 0x358637bd, v136
  v_exp_f32_e64 v79, v79 clamp
  v_mfma_f32_16x16x32_bf16 v[160:163], v[38:41], a[40:43], v[160:163]
  ds_read_b64_tr_b16 v[62:63], v9 offset:41024
  v_max_f32 v137, 0x358637bd, v137
  v_exp_f32_e64 v80, v80 clamp
  v_mfma_f32_16x16x32_bf16 v[164:167], v[38:41], a[120:123], v[164:167]
  s_waitcnt lgkmcnt(9)
  ds_read_b64_tr_b16 v[64:65], v9 offset:42304
  buffer_load_dwordx4 v72, s[40:43], s90 offen offset:2048 lds
  v_max_f32 v138, 0x358637bd, v138
  v_exp_f32_e64 v81, v81 clamp
  v_mfma_f32_16x16x32_bf16 v[160:163], v[42:45], a[44:47], v[160:163]
  ds_read_b64_tr_b16 v[38:39], v24 offset:41024
  v_max_f32 v139, 0x358637bd, v139
  v_add_f32 v136, v136, v78
  v_add_f32 v137, v137, v79
  v_mfma_f32_16x16x32_bf16 v[164:167], v[42:45], a[124:127], v[164:167]
  s_waitcnt lgkmcnt(9)
  ds_read_b64_tr_b16 v[40:41], v24 offset:42304
  v_add_f32 v138, v138, v80
  v_add_f32 v139, v139, v81
  v_cvt_pk_bf16_f32 v146, v136, v137
  v_cvt_pk_bf16_f32 v147, v138, v139
  v_mfma_f32_16x16x32_bf16 v[160:163], v[46:49], a[48:51], v[160:163]
  ds_read_b64_tr_b16 v[42:43], v26 offset:41024
  v_fma_f32 v78, v140, s88, v76
  v_fma_f32 v79, v141, s88, v76
  v_fma_f32 v80, v142, s88, v76
  v_mfma_f32_16x16x32_bf16 v[164:167], v[46:49], a[128:131], v[164:167]
  s_waitcnt lgkmcnt(9)
  ds_read_b64_tr_b16 v[44:45], v26 offset:42304
  v_fma_f32 v81, v143, s88, v76
  v_exp_f32_e64 v78, v78 clamp
  v_mfma_f32_16x16x32_bf16 v[160:163], v[50:53], a[52:55], v[160:163]
  ds_read_b64_tr_b16 v[46:47], v28 offset:41024
  v_max_f32 v140, 0x358637bd, v140
  v_exp_f32_e64 v79, v79 clamp
  v_mfma_f32_16x16x32_bf16 v[164:167], v[50:53], a[132:135], v[164:167]
  s_waitcnt lgkmcnt(9)
  ds_read_b64_tr_b16 v[48:49], v28 offset:42304
  v_max_f32 v141, 0x358637bd, v141
  v_exp_f32_e64 v80, v80 clamp
  v_mfma_f32_16x16x32_bf16 v[160:163], v[54:57], a[56:59], v[160:163]
  ds_read_b64_tr_b16 v[50:51], v9 offset:96
  buffer_load_dwordx4 v73, s[40:43], s90 offen offset:3072 lds
  v_max_f32 v142, 0x358637bd, v142
  v_exp_f32_e64 v81, v81 clamp
  v_mfma_f32_16x16x32_bf16 v[164:167], v[54:57], a[136:139], v[164:167]
  s_waitcnt lgkmcnt(9)
  ds_read_b64_tr_b16 v[52:53], v9 offset:1376
  v_max_f32 v143, 0x358637bd, v143
  v_add_f32 v140, v140, v78
  v_add_f32 v141, v141, v79
  v_mfma_f32_16x16x32_bf16 v[160:163], v[58:61], a[60:63], v[160:163]
  ds_read_b64_tr_b16 v[54:55], v24 offset:96
  v_add_f32 v142, v142, v80
  v_add_f32 v143, v143, v81
  v_cvt_pk_bf16_f32 v174, v140, v141
  v_cvt_pk_bf16_f32 v175, v142, v143
  v_mfma_f32_16x16x32_bf16 v[164:167], v[58:61], a[140:143], v[164:167]
  s_waitcnt lgkmcnt(9)
  ds_read_b64_tr_b16 v[56:57], v24 offset:1376
  v_mfma_f32_16x16x32_bf16 v[160:163], v[62:65], a[64:67], v[160:163]
  ds_read_b64_tr_b16 v[58:59], v26 offset:96
  v_mfma_f32_16x16x32_bf16 v[164:167], v[62:65], a[144:147], v[164:167]
  s_waitcnt lgkmcnt(9)
  ds_read_b64_tr_b16 v[60:61], v26 offset:1376
  v_mfma_f32_16x16x32_bf16 v[160:163], v[38:41], a[68:71], v[160:163]
  ds_read_b64_tr_b16 v[62:63], v28 offset:96
  v_mfma_f32_16x16x32_bf16 v[164:167], v[38:41], a[148:151], v[164:167]
  s_waitcnt lgkmcnt(9)
  ds_read_b64_tr_b16 v[64:65], v28 offset:1376
  s_add_u32 m0, s74, 0x15000
  s_nop 0
  buffer_load_dwordx4 v74, s[40:43], s90 offen lds
  v_mfma_f32_16x16x32_bf16 v[160:163], v[42:45], a[72:75], v[160:163]
  ds_read_b64_tr_b16 v[38:39], v9 offset:20576
  v_mfma_f32_16x16x32_bf16 v[164:167], v[42:45], a[152:155], v[164:167]
  s_waitcnt lgkmcnt(9)
  ds_read_b64_tr_b16 v[40:41], v9 offset:21856
  v_mfma_f32_16x16x32_bf16 v[160:163], v[46:49], a[76:79], v[160:163]
  ds_read_b64_tr_b16 v[42:43], v24 offset:20576
  v_mfma_f32_16x16x32_bf16 v[164:167], v[46:49], a[156:159], v[164:167]
  s_waitcnt lgkmcnt(9)
  ds_read_b64_tr_b16 v[44:45], v24 offset:21856
  v_mfma_f32_16x16x32_bf16 v[168:171], v[50:53], a[32:35], v[168:171]
  ds_read_b64_tr_b16 v[46:47], v26 offset:20576
  v_mfma_f32_16x16x32_bf16 v[16:19], v[50:53], a[112:115], v[16:19]
  s_waitcnt lgkmcnt(9)
  ds_read_b64_tr_b16 v[48:49], v26 offset:21856
  v_fma_f32 v78, v160, s88, v76
  v_fma_f32 v79, v161, s88, v76
  v_fma_f32 v80, v162, s88, v76
  v_mfma_f32_16x16x32_bf16 v[168:171], v[54:57], a[36:39], v[168:171]
  ds_read_b64_tr_b16 v[50:51], v28 offset:20576
  s_mul_i32 s90, s22, 0x32000
  s_add_u32 s93, s72, 2
  s_and_b32 s21, s93, 1
  s_mul_i32 s21, s21, 0xa000
  s_add_u32 s90, s90, s21
  s_bfe_u32 s21, s93, 0x10001
  s_mul_i32 s21, s21, 0x19000
  s_add_u32 s90, s90, s21
  s_add_u32 m0, s74, 0x19000
  s_nop 0
  buffer_load_dwordx4 v70, s[40:43], s90 offen lds
  v_fma_f32 v81, v163, s88, v76
  v_exp_f32_e64 v78, v78 clamp
  v_mfma_f32_16x16x32_bf16 v[16:19], v[54:57], a[116:119], v[16:19]
  s_waitcnt lgkmcnt(9)
  ds_read_b64_tr_b16 v[52:53], v28 offset:21856
  v_max_f32 v160, 0x358637bd, v160
  v_exp_f32_e64 v79, v79 clamp
  v_mfma_f32_16x16x32_bf16 v[168:171], v[58:61], a[40:43], v[168:171]
  ds_read_b64_tr_b16 v[54:55], v9 offset:41056
  v_max_f32 v161, 0x358637bd, v161
  v_exp_f32_e64 v80, v80 clamp
  v_mfma_f32_16x16x32_bf16 v[16:19], v[58:61], a[120:123], v[16:19]
  s_waitcnt lgkmcnt(9)
  ds_read_b64_tr_b16 v[56:57], v9 offset:42336
  v_max_f32 v162, 0x358637bd, v162
  v_exp_f32_e64 v81, v81 clamp
  v_mfma_f32_16x16x32_bf16 v[168:171], v[62:65], a[44:47], v[168:171]
  ds_read_b64_tr_b16 v[58:59], v24 offset:41056
  v_max_f32 v163, 0x358637bd, v163
  v_add_f32 v160, v160, v78
  v_add_f32 v161, v161, v79
  v_mfma_f32_16x16x32_bf16 v[16:19], v[62:65], a[124:127], v[16:19]
  s_waitcnt lgkmcnt(9)
  ds_read_b64_tr_b16 v[60:61], v24 offset:42336
  v_add_f32 v162, v162, v80
  v_add_f32 v163, v163, v81
  v_cvt_pk_bf16_f32 v148, v160, v161
  v_cvt_pk_bf16_f32 v149, v162, v163
  v_mfma_f32_16x16x32_bf16 v[168:171], v[38:41], a[48:51], v[168:171]
  ds_read_b64_tr_b16 v[62:63], v26 offset:41056
  v_fma_f32 v78, v164, s88, v76
  v_fma_f32 v79, v165, s88, v76
  v_fma_f32 v80, v166, s88, v76
  v_mfma_f32_16x16x32_bf16 v[16:19], v[38:41], a[128:131], v[16:19]
  s_waitcnt lgkmcnt(9)
  ds_read_b64_tr_b16 v[64:65], v26 offset:42336
  buffer_load_dwordx4 v71, s[40:43], s90 offen offset:1024 lds
  v_fma_f32 v81, v167, s88, v76
  v_exp_f32_e64 v78, v78 clamp
  v_mfma_f32_16x16x32_bf16 v[168:171], v[42:45], a[52:55], v[168:171]
  ds_read_b64_tr_b16 v[38:39], v28 offset:41056
  v_max_f32 v164, 0x358637bd, v164
  v_exp_f32_e64 v79, v79 clamp
  v_mfma_f32_16x16x32_bf16 v[16:19], v[42:45], a[132:135], v[16:19]
  s_waitcnt lgkmcnt(9)
  ds_read_b64_tr_b16 v[40:41], v28 offset:42336
  v_max_f32 v165, 0x358637bd, v165
  v_exp_f32_e64 v80, v80 clamp
  v_mfma_f32_16x16x32_bf16 v[168:171], v[46:49], a[56:59], v[168:171]
  ds_read_b64_tr_b16 v[42:43], v9 offset:128
  v_max_f32 v166, 0x358637bd, v166
  v_exp_f32_e64 v81, v81 clamp
  v_mfma_f32_16x16x32_bf16 v[16:19], v[46:49], a[136:139], v[16:19]
  s_waitcnt lgkmcnt(9)
  ds_read_b64_tr_b16 v[44:45], v9 offset:1408
  v_max_f32 v167, 0x358637bd, v167
  v_add_f32 v164, v164, v78
  v_add_f32 v165, v165, v79
  v_mfma_f32_16x16x32_bf16 v[168:171], v[50:53], a[60:63], v[168:171]
  ds_read_b64_tr_b16 v[46:47], v24 offset:128
  v_add_f32 v166, v166, v80
  v_add_f32 v167, v167, v81
  v_cvt_pk_bf16_f32 v176, v164, v165
  v_cvt_pk_bf16_f32 v177, v166, v167
  v_mfma_f32_16x16x32_bf16 v[16:19], v[50:53], a[140:143], v[16:19]
  s_waitcnt lgkmcnt(9)
  ds_read_b64_tr_b16 v[48:49], v24 offset:1408
  v_mfma_f32_16x16x32_bf16 v[168:171], v[54:57], a[64:67], v[168:171]
  ds_read_b64_tr_b16 v[50:51], v26 offset:128
  buffer_load_dwordx4 v72, s[40:43], s90 offen offset:2048 lds
  v_mfma_f32_16x16x32_bf16 v[16:19], v[54:57], a[144:147], v[16:19]
  s_waitcnt lgkmcnt(9)
  ds_read_b64_tr_b16 v[52:53], v26 offset:1408
  v_mfma_f32_16x16x32_bf16 v[168:171], v[58:61], a[68:71], v[168:171]
  ds_read_b64_tr_b16 v[54:55], v28 offset:128
  v_mfma_f32_16x16x32_bf16 v[16:19], v[58:61], a[148:151], v[16:19]
  s_waitcnt lgkmcnt(9)
  ds_read_b64_tr_b16 v[56:57], v28 offset:1408
  v_mfma_f32_16x16x32_bf16 v[168:171], v[62:65], a[72:75], v[168:171]
  ds_read_b64_tr_b16 v[58:59], v9 offset:20608
  v_mfma_f32_16x16x32_bf16 v[16:19], v[62:65], a[152:155], v[16:19]
  s_waitcnt lgkmcnt(9)
  ds_read_b64_tr_b16 v[60:61], v9 offset:21888
  v_mfma_f32_16x16x32_bf16 v[168:171], v[38:41], a[76:79], v[168:171]
  ds_read_b64_tr_b16 v[62:63], v24 offset:20608
  buffer_load_dwordx4 v[108:111], v6, s[36:39], s86 offen sc1
  v_mfma_f32_16x16x32_bf16 v[16:19], v[38:41], a[156:159], v[16:19]
  s_waitcnt lgkmcnt(9)
  ds_read_b64_tr_b16 v[64:65], v24 offset:21888
  v_mfma_f32_16x16x32_bf16 v[82:85], v[42:45], a[32:35], v[82:85]
  ds_read_b64_tr_b16 v[38:39], v26 offset:20608
  buffer_load_dwordx4 v[112:115], v87, s[36:39], s86 offen sc1
  v_mfma_f32_16x16x32_bf16 v[98:101], v[42:45], a[112:115], v[98:101]
  s_waitcnt lgkmcnt(9)
  ds_read_b64_tr_b16 v[40:41], v26 offset:21888
  v_mfma_f32_16x16x32_bf16 v[82:85], v[46:49], a[36:39], v[82:85]
  ds_read_b64_tr_b16 v[42:43], v28 offset:20608
  buffer_load_dwordx4 v[116:119], v88, s[36:39], s86 offen sc1
  v_mfma_f32_16x16x32_bf16 v[98:101], v[46:49], a[116:119], v[98:101]
  s_waitcnt lgkmcnt(9)
  ds_read_b64_tr_b16 v[44:45], v28 offset:21888
  v_mfma_f32_16x16x32_bf16 v[82:85], v[50:53], a[40:43], v[82:85]
  ds_read_b64_tr_b16 v[46:47], v9 offset:41088
  buffer_load_dword v67, v66, s[44:47], 0 offen sc1
  v_mfma_f32_16x16x32_bf16 v[98:101], v[50:53], a[120:123], v[98:101]
  s_waitcnt lgkmcnt(9)
  ds_read_b64_tr_b16 v[48:49], v9 offset:42368
  v_fma_f32 v78, v168, s88, v76
  v_fma_f32 v79, v169, s88, v76
  v_fma_f32 v80, v170, s88, v76
  v_mfma_f32_16x16x32_bf16 v[82:85], v[54:57], a[44:47], v[82:85]
  ds_read_b64_tr_b16 v[50:51], v24 offset:41088
  v_fma_f32 v81, v171, s88, v76
  v_exp_f32_e64 v78, v78 clamp
  v_mfma_f32_16x16x32_bf16 v[98:101], v[54:57], a[124:127], v[98:101]
  s_waitcnt lgkmcnt(9)
  ds_read_b64_tr_b16 v[52:53], v24 offset:42368
  v_max_f32 v168, 0x358637bd, v168
  v_exp_f32_e64 v79, v79 clamp
  v_mfma_f32_16x16x32_bf16 v[82:85], v[58:61], a[48:51], v[82:85]
  ds_read_b64_tr_b16 v[54:55], v26 offset:41088
  v_max_f32 v169, 0x358637bd, v169
  v_exp_f32_e64 v80, v80 clamp
  v_mfma_f32_16x16x32_bf16 v[98:101], v[58:61], a[128:131], v[98:101]
  s_waitcnt lgkmcnt(9)
  ds_read_b64_tr_b16 v[56:57], v26 offset:42368
  buffer_load_dwordx4 v73, s[40:43], s90 offen offset:3072 lds
  v_max_f32 v170, 0x358637bd, v170
  v_exp_f32_e64 v81, v81 clamp
  v_mfma_f32_16x16x32_bf16 v[82:85], v[62:65], a[52:55], v[82:85]
  ds_read_b64_tr_b16 v[58:59], v28 offset:41088
  v_max_f32 v171, 0x358637bd, v171
  v_add_f32 v168, v168, v78
  v_add_f32 v169, v169, v79
  v_mfma_f32_16x16x32_bf16 v[98:101], v[62:65], a[132:135], v[98:101]
  s_waitcnt lgkmcnt(9)
  ds_read_b64_tr_b16 v[60:61], v28 offset:42368
  v_add_f32 v170, v170, v80
  v_add_f32 v171, v171, v81
  v_cvt_pk_bf16_f32 v150, v168, v169
  v_cvt_pk_bf16_f32 v151, v170, v171
  v_mfma_f32_16x16x32_bf16 v[82:85], v[38:41], a[56:59], v[82:85]
  v_fma_f32 v78, v16, s88, v76
  v_fma_f32 v79, v17, s88, v76
  v_fma_f32 v80, v18, s88, v76
  v_mfma_f32_16x16x32_bf16 v[98:101], v[38:41], a[136:139], v[98:101]
  s_waitcnt lgkmcnt(8)
  v_fma_f32 v81, v19, s88, v76
  v_exp_f32_e64 v78, v78 clamp
  v_mfma_f32_16x16x32_bf16 v[82:85], v[42:45], a[60:63], v[82:85]
  v_max_f32 v16, 0x358637bd, v16
  v_exp_f32_e64 v79, v79 clamp
  v_mfma_f32_16x16x32_bf16 v[98:101], v[42:45], a[140:143], v[98:101]
  s_waitcnt lgkmcnt(6)
  v_max_f32 v17, 0x358637bd, v17
  v_exp_f32_e64 v80, v80 clamp
  v_mfma_f32_16x16x32_bf16 v[82:85], v[46:49], a[64:67], v[82:85]
  s_add_u32 m0, s74, 0x1a000
  s_nop 0
  buffer_load_dwordx4 v74, s[40:43], s90 offen lds
  v_max_f32 v18, 0x358637bd, v18
  v_exp_f32_e64 v81, v81 clamp
  v_mfma_f32_16x16x32_bf16 v[98:101], v[46:49], a[144:147], v[98:101]
  s_waitcnt lgkmcnt(4)
  v_max_f32 v19, 0x358637bd, v19
  v_add_f32 v16, v16, v78
  v_add_f32 v17, v17, v79
  v_mfma_f32_16x16x32_bf16 v[82:85], v[50:53], a[68:71], v[82:85]
  v_add_f32 v18, v18, v80
  v_add_f32 v19, v19, v81
  v_cvt_pk_bf16_f32 v178, v16, v17
  v_cvt_pk_bf16_f32 v179, v18, v19
  v_mfma_f32_16x16x32_bf16 v[98:101], v[50:53], a[148:151], v[98:101]
  s_waitcnt lgkmcnt(2)
  v_mfma_f32_16x16x32_bf16 v[82:85], v[54:57], a[72:75], v[82:85]
  v_mfma_f32_16x16x32_bf16 v[98:101], v[54:57], a[152:155], v[98:101]
  s_waitcnt lgkmcnt(0)
  v_mfma_f32_16x16x32_bf16 v[82:85], v[58:61], a[76:79], v[82:85]
  v_mfma_f32_16x16x32_bf16 v[98:101], v[58:61], a[156:159], v[98:101]
  s_waitcnt vmcnt(3)
  s_mov_b32 s92, 0
  s_mov_b32 s99, 0xcf000000
L_kv_spin:
  v_max3_u32 v4, v108, v109, v110
  v_max3_u32 v5, v111, v112, v113
  v_max3_u32 v4, v4, v114, v115
  v_max3_u32 v5, v5, v116, v117
  v_max3_u32 v4, v4, v118, v119
  v_max_u32 v4, v4, v5
  v_cmp_eq_u32 vcc, -1, v4
  s_nop 4
  s_cbranch_vccz L_kv_done
  s_add_u32 s92, s92, 1
  s_cmp_gt_u32 s92, 0xfa0
  s_cbranch_scc1 L_kv_done
  s_sleep 2
  buffer_load_dwordx4 v[108:111], v6, s[36:39], s86 offen sc1
  buffer_load_dwordx4 v[112:115], v87, s[36:39], s86 offen sc1
  buffer_load_dwordx4 v[116:119], v88, s[36:39], s86 offen sc1
  s_waitcnt vmcnt(0)
  s_branch L_kv_spin
L_kv_done:
  v_cvt_pk_bf16_f32 v108, v108, v109
  v_cvt_pk_bf16_f32 v109, v110, v111
  ds_write_b64 v91, v[108:109]
  v_cvt_pk_bf16_f32 v112, v112, v113
  v_cvt_pk_bf16_f32 v113, v114, v115
  ds_write_b64 v92, v[112:113]
  v_cvt_pk_bf16_f32 v116, v116, v117
  v_cvt_pk_bf16_f32 v117, v118, v119
  ds_write_b64 v93, v[116:117]
  s_waitcnt lgkmcnt(2)
  s_waitcnt lgkmcnt(1)
  s_waitcnt lgkmcnt(0)
  s_barrier
  ds_read_b128 a[200:203], v95
  ds_read_b128 a[204:207], v94
  ds_read_b128 a[208:211], v94 offset:3328
  ds_read_b128 a[212:215], v94 offset:6656
  ds_read_b128 a[216:219], v95 offset:64
  ds_read_b128 a[220:223], v94 offset:3392
  ds_read_b128 a[224:227], v94 offset:6720
  ds_read_b128 a[228:231], v94 offset:10048
  ds_read_b128 a[232:235], v94 offset:13376
  ds_read_b128 a[236:239], v95 offset:128
  ds_read_b128 a[240:243], v94 offset:10112
  ds_read_b128 a[244:247], v94 offset:13440
  s_waitcnt lgkmcnt(11)
  v_mfma_f32_16x16x32_bf16 v[8:11], a[200:203], v[144:147], v[34:37]
  v_mfma_f32_16x16x32_bf16 v[12:15], a[200:203], v[172:175], v[34:37]
  s_waitcnt lgkmcnt(10)
  v_mfma_f32_16x16x32_bf16 v[16:19], a[204:207], v[144:147], 0
  v_mfma_f32_16x16x32_bf16 v[20:23], a[204:207], v[172:175], 0
  s_waitcnt lgkmcnt(9)
  v_mfma_f32_16x16x32_bf16 v[24:27], a[208:211], v[144:147], 0
  v_mfma_f32_16x16x32_bf16 v[28:31], a[208:211], v[172:175], 0
  s_waitcnt lgkmcnt(8)
  v_mfma_f32_16x16x32_bf16 v[38:41], a[212:215], v[144:147], 0
  v_mfma_f32_16x16x32_bf16 v[42:45], a[212:215], v[172:175], 0
  s_waitcnt lgkmcnt(7)
  v_mfma_f32_16x16x32_bf16 v[8:11], a[216:219], v[148:151], v[8:11]
  v_mfma_f32_16x16x32_bf16 v[12:15], a[216:219], v[176:179], v[12:15]
  s_waitcnt lgkmcnt(6)
  v_mfma_f32_16x16x32_bf16 v[24:27], a[220:223], v[148:151], v[24:27]
  v_mfma_f32_16x16x32_bf16 v[28:31], a[220:223], v[176:179], v[28:31]
  s_waitcnt lgkmcnt(5)
  v_mfma_f32_16x16x32_bf16 v[38:41], a[224:227], v[148:151], v[38:41]
  v_mfma_f32_16x16x32_bf16 v[42:45], a[224:227], v[176:179], v[42:45]
  s_waitcnt lgkmcnt(4)
  v_mfma_f32_16x16x32_bf16 v[46:49], a[228:231], v[148:151], 0
  v_mfma_f32_16x16x32_bf16 v[50:53], a[228:231], v[176:179], 0
  s_waitcnt lgkmcnt(3)
  v_mfma_f32_16x16x32_bf16 v[54:57], a[232:235], v[148:151], 0
  v_mfma_f32_16x16x32_bf16 v[58:61], a[232:235], v[176:179], 0
  v_fma_f32 v78, v82, s88, v76
  v_fma_f32 v79, v83, s88, v76
  v_fma_f32 v80, v84, s88, v76
  v_fma_f32 v81, v85, s88, v76
  v_exp_f32_e64 v78, v78 clamp
  v_max_f32 v82, 0x358637bd, v82
  v_exp_f32_e64 v79, v79 clamp
  v_max_f32 v83, 0x358637bd, v83
  v_exp_f32_e64 v80, v80 clamp
  v_max_f32 v84, 0x358637bd, v84
  v_exp_f32_e64 v81, v81 clamp
  v_max_f32 v85, 0x358637bd, v85
  v_add_f32 v82, v82, v78
  v_add_f32 v83, v83, v79
  v_add_f32 v84, v84, v80
  v_add_f32 v85, v85, v81
  v_cvt_pk_bf16_f32 v152, v82, v83
  v_cvt_pk_bf16_f32 v153, v84, v85
  v_fma_f32 v78, v98, s88, v76
  v_fma_f32 v79, v99, s88, v76
  v_fma_f32 v80, v100, s88, v76
  v_fma_f32 v81, v101, s88, v76
  v_exp_f32_e64 v78, v78 clamp
  v_max_f32 v98, 0x358637bd, v98
  v_exp_f32_e64 v79, v79 clamp
  v_max_f32 v99, 0x358637bd, v99
  v_exp_f32_e64 v80, v80 clamp
  v_max_f32 v100, 0x358637bd, v100
  v_exp_f32_e64 v81, v81 clamp
  v_max_f32 v101, 0x358637bd, v101
  v_add_f32 v98, v98, v78
  v_add_f32 v99, v99, v79
  v_add_f32 v100, v100, v80
  v_add_f32 v101, v101, v81
  v_cvt_pk_bf16_f32 v180, v98, v99
  v_cvt_pk_bf16_f32 v181, v100, v101
  s_waitcnt lgkmcnt(2)
  v_mfma_f32_16x16x32_bf16 v[8:11], a[236:239], v[152:155], v[8:11]
  v_mfma_f32_16x16x32_bf16 v[12:15], a[236:239], v[180:183], v[12:15]
  s_waitcnt lgkmcnt(1)
  v_mfma_f32_16x16x32_bf16 v[46:49], a[240:243], v[152:155], v[46:49]
  v_mfma_f32_16x16x32_bf16 v[50:53], a[240:243], v[180:183], v[50:53]
  s_waitcnt lgkmcnt(0)
  v_mfma_f32_16x16x32_bf16 v[54:57], a[244:247], v[152:155], v[54:57]
  v_mfma_f32_16x16x32_bf16 v[58:61], a[244:247], v[180:183], v[58:61]
  s_nop 0
  v_rcp_f32 v8, v8
  v_rcp_f32 v9, v9
  v_rcp_f32 v10, v10
  v_rcp_f32 v11, v11
  v_rcp_f32 v12, v12
  v_rcp_f32 v13, v13
  v_rcp_f32 v14, v14
  v_rcp_f32 v15, v15
  v_cndmask_b32_e64 v63, v8, v9, s[52:53]
  v_cndmask_b32_e64 v64, v9, v10, s[54:55]
  v_cndmask_b32_e64 v65, v10, v11, s[56:57]
  v_pk_mul_f32 v[16:17], v[16:17], v[8:9] op_sel_hi:[1,0]
  v_pk_mul_f32 v[18:19], v[18:19], v[8:9] op_sel_hi:[1,0]
  v_cvt_pk_bf16_f32 v82, v16, v17
  v_cvt_pk_bf16_f32 v83, v18, v19
  v_pk_mul_f32 v[24:25], v[24:25], v[62:63] op_sel:[0,1] op_sel_hi:[1,1]
  v_pk_mul_f32 v[26:27], v[26:27], v[62:63] op_sel:[0,1] op_sel_hi:[1,1]
  v_cvt_pk_bf16_f32 v84, v24, v25
  v_cvt_pk_bf16_f32 v85, v26, v27
  v_pk_mul_f32 v[38:39], v[38:39], v[64:65] op_sel_hi:[1,0]
  v_pk_mul_f32 v[40:41], v[40:41], v[64:65] op_sel_hi:[1,0]
  v_cvt_pk_bf16_f32 v86, v38, v39
  v_cvt_pk_bf16_f32 v87, v40, v41
  v_pk_mul_f32 v[46:47], v[46:47], v[64:65] op_sel:[0,1] op_sel_hi:[1,1]
  v_pk_mul_f32 v[48:49], v[48:49], v[64:65] op_sel:[0,1] op_sel_hi:[1,1]
  v_cvt_pk_bf16_f32 v88, v46, v47
  v_cvt_pk_bf16_f32 v89, v48, v49
  v_pk_mul_f32 v[54:55], v[54:55], v[10:11] op_sel:[0,1] op_sel_hi:[1,1]
  v_pk_mul_f32 v[56:57], v[56:57], v[10:11] op_sel:[0,1] op_sel_hi:[1,1]
  v_cvt_pk_bf16_f32 v90, v54, v55
  v_cvt_pk_bf16_f32 v91, v56, v57
  buffer_store_dwordx4 v[82:85], v6, s[36:39], s94 offen sc1
  buffer_store_dwordx4 v[86:89], v6, s[36:39], s94 offen offset:1024 sc1
  v_lshrrev_b32 v4, 1, v3
  v_lshlrev_b32 v4, 8, v4
  v_lshl_add_u32 v4, v2, 4, v4
  v_and_b32 v5, 1, v3
  v_lshl_add_u32 v32, v5, 3, v4
  buffer_store_dwordx2 v[90:91], v32, s[36:39], s96 offen sc1
  v_cndmask_b32_e64 v63, v12, v13, s[52:53]
  v_cndmask_b32_e64 v64, v13, v14, s[54:55]
  v_cndmask_b32_e64 v65, v14, v15, s[56:57]
  v_pk_mul_f32 v[20:21], v[20:21], v[12:13] op_sel_hi:[1,0]
  v_pk_mul_f32 v[22:23], v[22:23], v[12:13] op_sel_hi:[1,0]
  v_cvt_pk_bf16_f32 v96, v20, v21
  v_cvt_pk_bf16_f32 v97, v22, v23
  v_pk_mul_f32 v[28:29], v[28:29], v[62:63] op_sel:[0,1] op_sel_hi:[1,1]
  v_pk_mul_f32 v[30:31], v[30:31], v[62:63] op_sel:[0,1] op_sel_hi:[1,1]
  v_cvt_pk_bf16_f32 v98, v28, v29
  v_cvt_pk_bf16_f32 v99, v30, v31
  v_pk_mul_f32 v[42:43], v[42:43], v[64:65] op_sel_hi:[1,0]
  v_pk_mul_f32 v[44:45], v[44:45], v[64:65] op_sel_hi:[1,0]
  v_cvt_pk_bf16_f32 v100, v42, v43
  v_cvt_pk_bf16_f32 v101, v44, v45
  v_pk_mul_f32 v[50:51], v[50:51], v[64:65] op_sel:[0,1] op_sel_hi:[1,1]
  v_pk_mul_f32 v[52:53], v[52:53], v[64:65] op_sel:[0,1] op_sel_hi:[1,1]
  v_cvt_pk_bf16_f32 v102, v50, v51
  v_cvt_pk_bf16_f32 v103, v52, v53
  v_pk_mul_f32 v[58:59], v[58:59], v[14:15] op_sel:[0,1] op_sel_hi:[1,1]
  v_pk_mul_f32 v[60:61], v[60:61], v[14:15] op_sel:[0,1] op_sel_hi:[1,1]
  v_cvt_pk_bf16_f32 v104, v58, v59
  v_cvt_pk_bf16_f32 v105, v60, v61
  buffer_store_dwordx4 v[96:99], v6, s[36:39], s95 offen sc1
  buffer_store_dwordx4 v[100:103], v6, s[36:39], s95 offen offset:1024 sc1
  buffer_store_dwordx2 v[104:105], v32, s[36:39], s97 offen sc1
  s_waitcnt vmcnt(6)
  s_barrier
  s_mul_i32 s90, s22, 0x32000
  s_add_u32 s93, s72, 3
  s_and_b32 s21, s93, 1
  s_mul_i32 s21, s21, 0xa000
  s_add_u32 s90, s90, s21
  s_bfe_u32 s21, s93, 0x10001
  s_mul_i32 s21, s21, 0x19000
  s_add_u32 s90, s90, s21
  s_add_u32 m0, s74, 0
  s_nop 0
  buffer_load_dwordx4 v70, s[40:43], s90 offen lds
  buffer_load_dwordx4 v71, s[40:43], s90 offen offset:1024 lds
  buffer_load_dwordx4 v72, s[40:43], s90 offen offset:2048 lds
  buffer_load_dwordx4 v73, s[40:43], s90 offen offset:3072 lds
  s_add_u32 m0, s74, 0x1000
  s_nop 0
  buffer_load_dwordx4 v74, s[40:43], s90 offen lds
  s_mul_i32 s90, s22, 0x32000
  s_add_u32 s90, s90, 0x14000
  s_add_u32 m0, s74, 0x5000
  s_nop 0
  buffer_load_dwordx4 v70, s[40:43], s90 offen lds
  buffer_load_dwordx4 v71, s[40:43], s90 offen offset:1024 lds
  buffer_load_dwordx4 v75, s[40:43], s90 offen offset:2048 lds
  s_add_u32 s90, s90, 0x14000
  buffer_load_dwordx4 v73, s[40:43], s90 offen offset:3072 lds
  s_add_u32 m0, s74, 0x6000
  s_nop 0
  buffer_load_dwordx4 v74, s[40:43], s90 offen lds
  v_lshrrev_b32 v4, 1, v1
  v_mul_u32_u24 v4, 0x1400, v4
  v_and_b32 v5, 1, v1
  v_lshl_add_u32 v4, v5, 9, v4
  v_add_u32 v4, 0x61fc, v4
  v_mov_b32 v11, 0x40000000
  v_cmp_gt_u32 vcc, 8, v1
  s_nop 1
  v_cndmask_b32_e64 v9, v11, v4, vcc
  s_mov_b32 s92, 0
L_hsoB_spin:
  v_readfirstlane_b32 s26, v67
  s_nop 2
  s_cmp_ge_u32 s26, 8
  s_nop 0
  s_cbranch_scc1 L_hsoB_done
  s_add_u32 s92, s92, 1
  s_cmp_gt_u32 s92, 0xfa0
  s_cbranch_scc1 L_hsoB_done
  s_sleep 1
  buffer_load_dword v67, v66, s[44:47], 0 offen sc1
  s_waitcnt vmcnt(0)
  s_branch L_hsoB_spin
L_hsoB_done:
  v_mov_b32 v8, -1
  buffer_load_dword v8, v9, s[36:39], s91 offen sc1
  v_lshrrev_b32 v4, 2, v1
  v_mul_u32_u24 v4, 0xa0, v4
  v_and_b32 v5, 3, v1
  s_and_b32 s93, s73, 1
  s_lshl_b32 s93, s93, 5
  s_lshl_b32 s21, s93, 2
  s_sub_u32 s21, 0x80, s21
  v_lshl_add_u32 v107, v5, 3, v4
  v_lshl_add_u32 v4, v5, 4, v4
  v_lshrrev_b32 v5, 1, v5
  v_lshlrev_b32 v5, 3, v5
  v_add3_u32 v33, v4, v5, s93
  v_xor_b32 v81, 8, v33
  v_add_u32 v107, s21, v107
  v_add_u32 v80, 0xf000, v33
  v_add_u32 v106, 0xf000, v81
  v_add_u32 v108, 0xf000, v107
  v_mul_u32_u24 v5, 0x280, v3
  v_add_u32 v109, v5, v33
  v_add_u32 v110, v5, v81
  v_add_u32 v111, v5, v107
  ds_read_b64_tr_b16 v[54:55], v80
  ds_read_b64_tr_b16 v[56:57], v80 offset:2560
  ds_read_b64_tr_b16 v[58:59], v106
  ds_read_b64_tr_b16 v[60:61], v106 offset:2560
  ds_read_b64_tr_b16 v[62:63], v80 offset:64
  ds_read_b64_tr_b16 v[64:65], v80 offset:2624
  ds_read_b64_tr_b16 v[68:69], v106 offset:64
  ds_read_b64_tr_b16 v[70:71], v106 offset:2624
  ds_read_b64_tr_b16 v[72:73], v108
  ds_read_b64_tr_b16 v[74:75], v108 offset:2560
  ds_read_b64_tr_b16 v[76:77], v80 offset:5120
  ds_read_b64_tr_b16 v[78:79], v80 offset:7680
  v_add_u32 v112, 0x1000, v6
  v_add_u32 v113, 0x2000, v6
  v_add_u32 v114, 0x3000, v6
  v_add_u32 v115, 0x4000, v6
  v_add_u32 v116, 0x5000, v6
  v_add_u32 v117, 0x6000, v6
  v_add_u32 v118, 0x7000, v6
  v_add_u32 v119, 0x8000, v6
  v_add_u32 v120, 0x9000, v6
  s_lshl_b32 s26, s72, 7
  s_lshr_b32 s27, s22, 1
  s_lshl_b32 s27, s27, 6
  s_add_u32 s26, s26, s27
  s_and_b32 s27, s22, 1
  s_add_u32 s26, s26, s27
  v_lshl_add_u32 v4, v2, 1, s26
  v_mul_u32_u24 v4, 0xa00, v4
  s_mul_i32 s26, s73, 0xa0
  s_add_u32 s26, s26, 0x500
  s_add_u32 s93, s93, s26
  s_add_u32 s21, s21, s26
  v_lshl_add_u32 v5, v3, 4, v4
  v_add_u32 v121, s93, v5
  v_lshl_add_u32 v5, v3, 3, v4
  v_add_u32 v122, s21, v5
  s_mov_b32 s62, 0
  s_mov_b32 s63, 0xffffffff
  s_add_u32 s26, s72, 0
  s_and_b32 s26, s26, 3
  s_lshl_b32 s26, s26, 10
  s_add_u32 s76, s91, s26
  s_add_u32 s26, s72, 1
  s_and_b32 s26, s26, 3
  s_lshl_b32 s26, s26, 10
  s_add_u32 s77, s91, s26
  s_add_u32 s26, s72, 2
  s_and_b32 s26, s26, 3
  s_lshl_b32 s26, s26, 10
  s_add_u32 s78, s91, s26
  s_add_u32 s26, s72, 3
  s_and_b32 s26, s26, 3
  s_lshl_b32 s26, s26, 10
  s_add_u32 s79, s91, s26
  s_add_u32 s80, s91, 0x1000
  s_mov_b32 s92, 0
L_opB:
  v_cmp_eq_u32 vcc, -1, v8
  s_nop 4
  s_cbranch_vccz L_opdB
  s_add_u32 s92, s92, 1
  s_cmp_gt_u32 s92, 0xfa0
  s_cbranch_scc1 L_opdB
  s_sleep 1
  s_and_b32 s26, s92, 3
  s_cbranch_scc1 L_opB
  s_waitcnt vmcnt(40)
  v_cndmask_b32_e64 v10, v11, v9, vcc
  buffer_load_dword v8, v10, s[36:39], s91 offen sc1
  s_nop 0
  s_branch L_opB
L_opdB:
  s_mov_b32 s92, 0
  buffer_load_dwordx4 a[0:3], v6, s[36:39], s76 offen sc1
  buffer_load_dwordx4 a[80:83], v116, s[36:39], s76 offen sc1
  buffer_load_dwordx4 a[20:23], v112, s[36:39], s76 offen offset:1024 sc1
  buffer_load_dwordx4 a[100:103], v117, s[36:39], s76 offen offset:1024 sc1
  buffer_load_dwordx4 a[40:43], v113, s[36:39], s76 offen offset:2048 sc1
  buffer_load_dwordx4 a[120:123], v118, s[36:39], s76 offen offset:2048 sc1
  buffer_load_dwordx4 a[60:63], v114, s[36:39], s76 offen offset:3072 sc1
  buffer_load_dwordx4 a[140:143], v119, s[36:39], s76 offen offset:3072 sc1
  s_mov_b32 s27, 0x14000
  s_waitcnt lgkmcnt(10)
  s_waitcnt vmcnt(7)
  v_mfma_f32_16x16x32_bf16 v[12:15], v[54:57], a[0:3], 0
  ds_read_b64_tr_b16 v[92:93], v106 offset:5120
  buffer_load_dwordx4 a[4:7], v6, s[36:39], s77 offen sc1
  s_waitcnt vmcnt(7)
  v_mfma_f32_16x16x32_bf16 v[34:37], v[54:57], a[80:83], 0
  s_waitcnt lgkmcnt(9)
  ds_read_b64_tr_b16 v[94:95], v106 offset:7680
  v_mfma_f32_16x16x32_bf16 v[16:19], v[58:61], a[0:3], 0
  ds_read_b64_tr_b16 v[54:55], v80 offset:5184
  v_mfma_f32_16x16x32_bf16 v[38:41], v[58:61], a[80:83], 0
  s_waitcnt lgkmcnt(9)
  ds_read_b64_tr_b16 v[56:57], v80 offset:7744
  v_mfma_f32_16x16x32_bf16 v[20:23], v[62:65], a[0:3], 0
  ds_read_b64_tr_b16 v[58:59], v106 offset:5184
  buffer_load_dwordx4 a[84:87], v116, s[36:39], s77 offen sc1
  v_mfma_f32_16x16x32_bf16 v[42:45], v[62:65], a[80:83], 0
  s_waitcnt lgkmcnt(9)
  ds_read_b64_tr_b16 v[60:61], v106 offset:7744
  v_mfma_f32_16x16x32_bf16 v[24:27], v[68:71], a[0:3], 0
  ds_read_b64_tr_b16 v[62:63], v108 offset:5120
  v_mfma_f32_16x16x32_bf16 v[46:49], v[68:71], a[80:83], 0
  s_waitcnt lgkmcnt(9)
  ds_read_b64_tr_b16 v[64:65], v108 offset:7680
  v_mfma_f32_16x16x32_bf16 v[28:31], v[72:75], a[0:3], 0
  ds_read_b64_tr_b16 v[68:69], v80 offset:10240
  v_mfma_f32_16x16x32_bf16 v[50:53], v[72:75], a[80:83], 0
  s_waitcnt lgkmcnt(9)
  ds_read_b64_tr_b16 v[70:71], v80 offset:12800
  s_waitcnt vmcnt(7)
  v_mfma_f32_16x16x32_bf16 v[12:15], v[76:79], a[20:23], v[12:15]
  ds_read_b64_tr_b16 v[72:73], v106 offset:10240
  buffer_load_dwordx4 a[24:27], v112, s[36:39], s77 offen offset:1024 sc1
  s_waitcnt vmcnt(7)
  v_mfma_f32_16x16x32_bf16 v[34:37], v[76:79], a[100:103], v[34:37]
  s_waitcnt lgkmcnt(9)
  ds_read_b64_tr_b16 v[74:75], v106 offset:12800
  v_mfma_f32_16x16x32_bf16 v[16:19], v[92:95], a[20:23], v[16:19]
  ds_read_b64_tr_b16 v[76:77], v80 offset:10304
  v_mfma_f32_16x16x32_bf16 v[38:41], v[92:95], a[100:103], v[38:41]
  s_waitcnt lgkmcnt(9)
  ds_read_b64_tr_b16 v[78:79], v80 offset:12864
  v_mfma_f32_16x16x32_bf16 v[20:23], v[54:57], a[20:23], v[20:23]
  ds_read_b64_tr_b16 v[92:93], v106 offset:10304
  buffer_load_dwordx4 a[104:107], v117, s[36:39], s77 offen offset:1024 sc1
  v_mfma_f32_16x16x32_bf16 v[42:45], v[54:57], a[100:103], v[42:45]
  s_waitcnt lgkmcnt(9)
  ds_read_b64_tr_b16 v[94:95], v106 offset:12864
  v_mfma_f32_16x16x32_bf16 v[24:27], v[58:61], a[20:23], v[24:27]
  ds_read_b64_tr_b16 v[54:55], v108 offset:10240
  v_mfma_f32_16x16x32_bf16 v[46:49], v[58:61], a[100:103], v[46:49]
  s_waitcnt lgkmcnt(9)
  ds_read_b64_tr_b16 v[56:57], v108 offset:12800
  v_mfma_f32_16x16x32_bf16 v[28:31], v[62:65], a[20:23], v[28:31]
  ds_read_b64_tr_b16 v[58:59], v80 offset:15360
  v_mfma_f32_16x16x32_bf16 v[50:53], v[62:65], a[100:103], v[50:53]
  s_waitcnt lgkmcnt(9)
  ds_read_b64_tr_b16 v[60:61], v80 offset:17920
  s_waitcnt vmcnt(7)
  v_mfma_f32_16x16x32_bf16 v[12:15], v[68:71], a[40:43], v[12:15]
  ds_read_b64_tr_b16 v[62:63], v106 offset:15360
  buffer_load_dwordx4 a[44:47], v113, s[36:39], s77 offen offset:2048 sc1
  s_waitcnt vmcnt(7)
  v_mfma_f32_16x16x32_bf16 v[34:37], v[68:71], a[120:123], v[34:37]
  s_waitcnt lgkmcnt(9)
  ds_read_b64_tr_b16 v[64:65], v106 offset:17920
  v_mfma_f32_16x16x32_bf16 v[16:19], v[72:75], a[40:43], v[16:19]
  ds_read_b64_tr_b16 v[68:69], v80 offset:15424
  v_mfma_f32_16x16x32_bf16 v[38:41], v[72:75], a[120:123], v[38:41]
  s_waitcnt lgkmcnt(9)
  ds_read_b64_tr_b16 v[70:71], v80 offset:17984
  v_mfma_f32_16x16x32_bf16 v[20:23], v[76:79], a[40:43], v[20:23]
  ds_read_b64_tr_b16 v[72:73], v106 offset:15424
  buffer_load_dwordx4 a[124:127], v118, s[36:39], s77 offen offset:2048 sc1
  v_mfma_f32_16x16x32_bf16 v[42:45], v[76:79], a[120:123], v[42:45]
  s_waitcnt lgkmcnt(9)
  ds_read_b64_tr_b16 v[74:75], v106 offset:17984
  v_mfma_f32_16x16x32_bf16 v[24:27], v[92:95], a[40:43], v[24:27]
  ds_read_b64_tr_b16 v[76:77], v108 offset:15360
  v_mfma_f32_16x16x32_bf16 v[46:49], v[92:95], a[120:123], v[46:49]
  s_waitcnt lgkmcnt(9)
  ds_read_b64_tr_b16 v[78:79], v108 offset:17920
  v_mfma_f32_16x16x32_bf16 v[28:31], v[54:57], a[40:43], v[28:31]
  ds_read_b64_tr_b16 v[92:93], v80 offset:20480
  v_mfma_f32_16x16x32_bf16 v[50:53], v[54:57], a[120:123], v[50:53]
  s_waitcnt lgkmcnt(9)
  ds_read_b64_tr_b16 v[94:95], v80 offset:23040
  s_waitcnt vmcnt(7)
  v_mfma_f32_16x16x32_bf16 v[12:15], v[58:61], a[60:63], v[12:15]
  ds_read_b64_tr_b16 v[54:55], v106 offset:20480
  buffer_load_dwordx4 a[64:67], v114, s[36:39], s77 offen offset:3072 sc1
  s_waitcnt vmcnt(7)
  v_mfma_f32_16x16x32_bf16 v[34:37], v[58:61], a[140:143], v[34:37]
  s_waitcnt lgkmcnt(9)
  ds_read_b64_tr_b16 v[56:57], v106 offset:23040
  v_mfma_f32_16x16x32_bf16 v[16:19], v[62:65], a[60:63], v[16:19]
  ds_read_b64_tr_b16 v[58:59], v80 offset:20544
  v_mfma_f32_16x16x32_bf16 v[38:41], v[62:65], a[140:143], v[38:41]
  s_waitcnt lgkmcnt(9)
  ds_read_b64_tr_b16 v[60:61], v80 offset:23104
  v_mfma_f32_16x16x32_bf16 v[20:23], v[68:71], a[60:63], v[20:23]
  ds_read_b64_tr_b16 v[62:63], v106 offset:20544
  buffer_load_dwordx4 a[144:147], v119, s[36:39], s77 offen offset:3072 sc1
  v_mfma_f32_16x16x32_bf16 v[42:45], v[68:71], a[140:143], v[42:45]
  s_waitcnt lgkmcnt(9)
  ds_read_b64_tr_b16 v[64:65], v106 offset:23104
  v_mfma_f32_16x16x32_bf16 v[24:27], v[72:75], a[60:63], v[24:27]
  ds_read_b64_tr_b16 v[68:69], v108 offset:20480
  v_mfma_f32_16x16x32_bf16 v[46:49], v[72:75], a[140:143], v[46:49]
  s_waitcnt lgkmcnt(9)
  ds_read_b64_tr_b16 v[70:71], v108 offset:23040
  v_mfma_f32_16x16x32_bf16 v[28:31], v[76:79], a[60:63], v[28:31]
  ds_read_b64_tr_b16 v[72:73], v80 offset:25600
  v_mfma_f32_16x16x32_bf16 v[50:53], v[76:79], a[140:143], v[50:53]
  s_waitcnt lgkmcnt(9)
  ds_read_b64_tr_b16 v[74:75], v80 offset:28160
  s_waitcnt vmcnt(7)
  v_mfma_f32_16x16x32_bf16 v[12:15], v[92:95], a[4:7], v[12:15]
  ds_read_b64_tr_b16 v[76:77], v106 offset:25600
  buffer_load_dwordx4 a[8:11], v6, s[36:39], s78 offen sc1
  s_waitcnt vmcnt(7)
  v_mfma_f32_16x16x32_bf16 v[34:37], v[92:95], a[84:87], v[34:37]
  s_waitcnt lgkmcnt(9)
  ds_read_b64_tr_b16 v[78:79], v106 offset:28160
  v_mfma_f32_16x16x32_bf16 v[16:19], v[54:57], a[4:7], v[16:19]
  ds_read_b64_tr_b16 v[92:93], v80 offset:25664
  v_mfma_f32_16x16x32_bf16 v[38:41], v[54:57], a[84:87], v[38:41]
  s_waitcnt lgkmcnt(9)
  ds_read_b64_tr_b16 v[94:95], v80 offset:28224
  v_mfma_f32_16x16x32_bf16 v[20:23], v[58:61], a[4:7], v[20:23]
  ds_read_b64_tr_b16 v[54:55], v106 offset:25664
  buffer_load_dwordx4 a[88:91], v116, s[36:39], s78 offen sc1
  v_mfma_f32_16x16x32_bf16 v[42:45], v[58:61], a[84:87], v[42:45]
  s_waitcnt lgkmcnt(9)
  ds_read_b64_tr_b16 v[56:57], v106 offset:28224
  v_mfma_f32_16x16x32_bf16 v[24:27], v[62:65], a[4:7], v[24:27]
  ds_read_b64_tr_b16 v[58:59], v108 offset:25600
  v_mfma_f32_16x16x32_bf16 v[46:49], v[62:65], a[84:87], v[46:49]
  s_waitcnt lgkmcnt(9)
  ds_read_b64_tr_b16 v[60:61], v108 offset:28160
  v_mfma_f32_16x16x32_bf16 v[28:31], v[68:71], a[4:7], v[28:31]
  ds_read_b64_tr_b16 v[62:63], v80 offset:30720
  v_mfma_f32_16x16x32_bf16 v[50:53], v[68:71], a[84:87], v[50:53]
  s_waitcnt lgkmcnt(9)
  ds_read_b64_tr_b16 v[64:65], v80 offset:33280
  s_waitcnt vmcnt(7)
  v_mfma_f32_16x16x32_bf16 v[12:15], v[72:75], a[24:27], v[12:15]
  ds_read_b64_tr_b16 v[68:69], v106 offset:30720
  buffer_load_dwordx4 a[28:31], v112, s[36:39], s78 offen offset:1024 sc1
  s_waitcnt vmcnt(7)
  v_mfma_f32_16x16x32_bf16 v[34:37], v[72:75], a[104:107], v[34:37]
  s_waitcnt lgkmcnt(9)
  ds_read_b64_tr_b16 v[70:71], v106 offset:33280
  v_mfma_f32_16x16x32_bf16 v[16:19], v[76:79], a[24:27], v[16:19]
  ds_read_b64_tr_b16 v[72:73], v80 offset:30784
  v_mfma_f32_16x16x32_bf16 v[38:41], v[76:79], a[104:107], v[38:41]
  s_waitcnt lgkmcnt(9)
  ds_read_b64_tr_b16 v[74:75], v80 offset:33344
  v_mfma_f32_16x16x32_bf16 v[20:23], v[92:95], a[24:27], v[20:23]
  ds_read_b64_tr_b16 v[76:77], v106 offset:30784
  buffer_load_dwordx4 a[108:111], v117, s[36:39], s78 offen offset:1024 sc1
  v_mfma_f32_16x16x32_bf16 v[42:45], v[92:95], a[104:107], v[42:45]
  s_waitcnt lgkmcnt(9)
  ds_read_b64_tr_b16 v[78:79], v106 offset:33344
  v_mfma_f32_16x16x32_bf16 v[24:27], v[54:57], a[24:27], v[24:27]
  ds_read_b64_tr_b16 v[92:93], v108 offset:30720
  v_mfma_f32_16x16x32_bf16 v[46:49], v[54:57], a[104:107], v[46:49]
  s_waitcnt lgkmcnt(9)
  ds_read_b64_tr_b16 v[94:95], v108 offset:33280
  v_mfma_f32_16x16x32_bf16 v[28:31], v[58:61], a[24:27], v[28:31]
  ds_read_b64_tr_b16 v[54:55], v80 offset:35840
  v_mfma_f32_16x16x32_bf16 v[50:53], v[58:61], a[104:107], v[50:53]
  s_waitcnt lgkmcnt(9)
  ds_read_b64_tr_b16 v[56:57], v80 offset:38400
  s_waitcnt vmcnt(7)
  v_mfma_f32_16x16x32_bf16 v[12:15], v[62:65], a[44:47], v[12:15]
  ds_read_b64_tr_b16 v[58:59], v106 offset:35840
  buffer_load_dwordx4 a[48:51], v113, s[36:39], s78 offen offset:2048 sc1
  s_waitcnt vmcnt(7)
  v_mfma_f32_16x16x32_bf16 v[34:37], v[62:65], a[124:127], v[34:37]
  s_waitcnt lgkmcnt(9)
  ds_read_b64_tr_b16 v[60:61], v106 offset:38400
  v_mfma_f32_16x16x32_bf16 v[16:19], v[68:71], a[44:47], v[16:19]
  ds_read_b64_tr_b16 v[62:63], v80 offset:35904
  v_mfma_f32_16x16x32_bf16 v[38:41], v[68:71], a[124:127], v[38:41]
  s_waitcnt lgkmcnt(9)
  ds_read_b64_tr_b16 v[64:65], v80 offset:38464
  v_mfma_f32_16x16x32_bf16 v[20:23], v[72:75], a[44:47], v[20:23]
  ds_read_b64_tr_b16 v[68:69], v106 offset:35904
  buffer_load_dwordx4 a[128:131], v118, s[36:39], s78 offen offset:2048 sc1
  v_mfma_f32_16x16x32_bf16 v[42:45], v[72:75], a[124:127], v[42:45]
  s_waitcnt lgkmcnt(9)
  ds_read_b64_tr_b16 v[70:71], v106 offset:38464
  v_mfma_f32_16x16x32_bf16 v[24:27], v[76:79], a[44:47], v[24:27]
  ds_read_b64_tr_b16 v[72:73], v108 offset:35840
  v_mfma_f32_16x16x32_bf16 v[46:49], v[76:79], a[124:127], v[46:49]
  s_waitcnt lgkmcnt(9)
  ds_read_b64_tr_b16 v[74:75], v108 offset:38400
  v_mfma_f32_16x16x32_bf16 v[28:31], v[92:95], a[44:47], v[28:31]
  ds_read_b64_tr_b16 v[76:77], v80 offset:40960
  v_mfma_f32_16x16x32_bf16 v[50:53], v[92:95], a[124:127], v[50:53]
  s_waitcnt lgkmcnt(9)
  ds_read_b64_tr_b16 v[78:79], v80 offset:43520
  s_waitcnt vmcnt(7)
  v_mfma_f32_16x16x32_bf16 v[12:15], v[54:57], a[64:67], v[12:15]
  ds_read_b64_tr_b16 v[92:93], v106 offset:40960
  buffer_load_dwordx4 a[68:71], v114, s[36:39], s78 offen offset:3072 sc1
  s_waitcnt vmcnt(7)
  v_mfma_f32_16x16x32_bf16 v[34:37], v[54:57], a[144:147], v[34:37]
  s_waitcnt lgkmcnt(9)
  ds_read_b64_tr_b16 v[94:95], v106 offset:43520
  v_mfma_f32_16x16x32_bf16 v[16:19], v[58:61], a[64:67], v[16:19]
  ds_read_b64_tr_b16 v[54:55], v80 offset:41024
  v_mfma_f32_16x16x32_bf16 v[38:41], v[58:61], a[144:147], v[38:41]
  s_waitcnt lgkmcnt(9)
  ds_read_b64_tr_b16 v[56:57], v80 offset:43584
  v_mfma_f32_16x16x32_bf16 v[20:23], v[62:65], a[64:67], v[20:23]
  ds_read_b64_tr_b16 v[58:59], v106 offset:41024
  buffer_load_dwordx4 a[148:151], v119, s[36:39], s78 offen offset:3072 sc1
  v_mfma_f32_16x16x32_bf16 v[42:45], v[62:65], a[144:147], v[42:45]
  s_waitcnt lgkmcnt(9)
  ds_read_b64_tr_b16 v[60:61], v106 offset:43584
  v_mfma_f32_16x16x32_bf16 v[24:27], v[68:71], a[64:67], v[24:27]
  ds_read_b64_tr_b16 v[62:63], v108 offset:40960
  v_mfma_f32_16x16x32_bf16 v[46:49], v[68:71], a[144:147], v[46:49]
  s_waitcnt lgkmcnt(9)
  ds_read_b64_tr_b16 v[64:65], v108 offset:43520
  v_mfma_f32_16x16x32_bf16 v[28:31], v[72:75], a[64:67], v[28:31]
  ds_read_b64_tr_b16 v[68:69], v80 offset:46080
  v_mfma_f32_16x16x32_bf16 v[50:53], v[72:75], a[144:147], v[50:53]
  s_waitcnt lgkmcnt(9)
  ds_read_b64_tr_b16 v[70:71], v80 offset:48640
  s_waitcnt vmcnt(7)
  v_mfma_f32_16x16x32_bf16 v[12:15], v[76:79], a[8:11], v[12:15]
  ds_read_b64_tr_b16 v[72:73], v106 offset:46080
  buffer_load_dwordx4 a[12:15], v6, s[36:39], s79 offen sc1
  s_waitcnt vmcnt(7)
  v_mfma_f32_16x16x32_bf16 v[34:37], v[76:79], a[88:91], v[34:37]
  s_waitcnt lgkmcnt(9)
  ds_read_b64_tr_b16 v[74:75], v106 offset:48640
  v_mfma_f32_16x16x32_bf16 v[16:19], v[92:95], a[8:11], v[16:19]
  ds_read_b64_tr_b16 v[76:77], v80 offset:46144
  v_mfma_f32_16x16x32_bf16 v[38:41], v[92:95], a[88:91], v[38:41]
  s_waitcnt lgkmcnt(9)
  ds_read_b64_tr_b16 v[78:79], v80 offset:48704
  v_mfma_f32_16x16x32_bf16 v[20:23], v[54:57], a[8:11], v[20:23]
  ds_read_b64_tr_b16 v[92:93], v106 offset:46144
  buffer_load_dwordx4 a[92:95], v116, s[36:39], s79 offen sc1
  v_mfma_f32_16x16x32_bf16 v[42:45], v[54:57], a[88:91], v[42:45]
  s_waitcnt lgkmcnt(9)
  ds_read_b64_tr_b16 v[94:95], v106 offset:48704
  v_mfma_f32_16x16x32_bf16 v[24:27], v[58:61], a[8:11], v[24:27]
  ds_read_b64_tr_b16 v[54:55], v108 offset:46080
  v_mfma_f32_16x16x32_bf16 v[46:49], v[58:61], a[88:91], v[46:49]
  s_waitcnt lgkmcnt(9)
  ds_read_b64_tr_b16 v[56:57], v108 offset:48640
  v_mfma_f32_16x16x32_bf16 v[28:31], v[62:65], a[8:11], v[28:31]
  ds_read_b64_tr_b16 v[58:59], v80 offset:51200
  v_mfma_f32_16x16x32_bf16 v[50:53], v[62:65], a[88:91], v[50:53]
  s_waitcnt lgkmcnt(9)
  ds_read_b64_tr_b16 v[60:61], v80 offset:53760
  s_waitcnt vmcnt(7)
  v_mfma_f32_16x16x32_bf16 v[12:15], v[68:71], a[28:31], v[12:15]
  ds_read_b64_tr_b16 v[62:63], v106 offset:51200
  buffer_load_dwordx4 a[32:35], v112, s[36:39], s79 offen offset:1024 sc1
  s_waitcnt vmcnt(7)
  v_mfma_f32_16x16x32_bf16 v[34:37], v[68:71], a[108:111], v[34:37]
  s_waitcnt lgkmcnt(9)
  ds_read_b64_tr_b16 v[64:65], v106 offset:53760
  v_mfma_f32_16x16x32_bf16 v[16:19], v[72:75], a[28:31], v[16:19]
  ds_read_b64_tr_b16 v[68:69], v80 offset:51264
  v_mfma_f32_16x16x32_bf16 v[38:41], v[72:75], a[108:111], v[38:41]
  s_waitcnt lgkmcnt(9)
  ds_read_b64_tr_b16 v[70:71], v80 offset:53824
  v_mfma_f32_16x16x32_bf16 v[20:23], v[76:79], a[28:31], v[20:23]
  ds_read_b64_tr_b16 v[72:73], v106 offset:51264
  buffer_load_dwordx4 a[112:115], v117, s[36:39], s79 offen offset:1024 sc1
  v_mfma_f32_16x16x32_bf16 v[42:45], v[76:79], a[108:111], v[42:45]
  s_waitcnt lgkmcnt(9)
  ds_read_b64_tr_b16 v[74:75], v106 offset:53824
  v_mfma_f32_16x16x32_bf16 v[24:27], v[92:95], a[28:31], v[24:27]
  ds_read_b64_tr_b16 v[76:77], v108 offset:51200
  v_mfma_f32_16x16x32_bf16 v[46:49], v[92:95], a[108:111], v[46:49]
  s_waitcnt lgkmcnt(9)
  ds_read_b64_tr_b16 v[78:79], v108 offset:53760
  v_mfma_f32_16x16x32_bf16 v[28:31], v[54:57], a[28:31], v[28:31]
  ds_read_b64_tr_b16 v[92:93], v80 offset:56320
  v_mfma_f32_16x16x32_bf16 v[50:53], v[54:57], a[108:111], v[50:53]
  s_waitcnt lgkmcnt(9)
  ds_read_b64_tr_b16 v[94:95], v80 offset:58880
  s_waitcnt vmcnt(7)
  v_mfma_f32_16x16x32_bf16 v[12:15], v[58:61], a[48:51], v[12:15]
  ds_read_b64_tr_b16 v[54:55], v106 offset:56320
  buffer_load_dwordx4 a[52:55], v113, s[36:39], s79 offen offset:2048 sc1
  s_waitcnt vmcnt(7)
  v_mfma_f32_16x16x32_bf16 v[34:37], v[58:61], a[128:131], v[34:37]
  s_waitcnt lgkmcnt(9)
  ds_read_b64_tr_b16 v[56:57], v106 offset:58880
  v_mfma_f32_16x16x32_bf16 v[16:19], v[62:65], a[48:51], v[16:19]
  ds_read_b64_tr_b16 v[58:59], v80 offset:56384
  v_mfma_f32_16x16x32_bf16 v[38:41], v[62:65], a[128:131], v[38:41]
  s_waitcnt lgkmcnt(9)
  ds_read_b64_tr_b16 v[60:61], v80 offset:58944
  v_mfma_f32_16x16x32_bf16 v[20:23], v[68:71], a[48:51], v[20:23]
  ds_read_b64_tr_b16 v[62:63], v106 offset:56384
  buffer_load_dwordx4 a[132:135], v118, s[36:39], s79 offen offset:2048 sc1
  v_mfma_f32_16x16x32_bf16 v[42:45], v[68:71], a[128:131], v[42:45]
  s_waitcnt lgkmcnt(9)
  ds_read_b64_tr_b16 v[64:65], v106 offset:58944
  v_mfma_f32_16x16x32_bf16 v[24:27], v[72:75], a[48:51], v[24:27]
  ds_read_b64_tr_b16 v[68:69], v108 offset:56320
  v_mfma_f32_16x16x32_bf16 v[46:49], v[72:75], a[128:131], v[46:49]
  s_waitcnt lgkmcnt(9)
  ds_read_b64_tr_b16 v[70:71], v108 offset:58880
  v_mfma_f32_16x16x32_bf16 v[28:31], v[76:79], a[48:51], v[28:31]
  s_barrier
  ds_read_b64_tr_b16 v[72:73], v33
  v_mfma_f32_16x16x32_bf16 v[50:53], v[76:79], a[128:131], v[50:53]
  s_waitcnt lgkmcnt(9)
  ds_read_b64_tr_b16 v[74:75], v33 offset:2560
  s_waitcnt vmcnt(7)
  v_mfma_f32_16x16x32_bf16 v[12:15], v[92:95], a[68:71], v[12:15]
  ds_read_b64_tr_b16 v[76:77], v81
  buffer_load_dwordx4 a[72:75], v114, s[36:39], s79 offen offset:3072 sc1
  s_waitcnt vmcnt(7)
  v_mfma_f32_16x16x32_bf16 v[34:37], v[92:95], a[148:151], v[34:37]
  s_waitcnt lgkmcnt(9)
  ds_read_b64_tr_b16 v[78:79], v81 offset:2560
  v_mfma_f32_16x16x32_bf16 v[16:19], v[54:57], a[68:71], v[16:19]
  ds_read_b64_tr_b16 v[92:93], v33 offset:64
  v_mfma_f32_16x16x32_bf16 v[38:41], v[54:57], a[148:151], v[38:41]
  s_waitcnt lgkmcnt(9)
  ds_read_b64_tr_b16 v[94:95], v33 offset:2624
  v_mfma_f32_16x16x32_bf16 v[20:23], v[58:61], a[68:71], v[20:23]
  ds_read_b64_tr_b16 v[54:55], v81 offset:64
  buffer_load_dwordx4 a[152:155], v119, s[36:39], s79 offen offset:3072 sc1
  v_mfma_f32_16x16x32_bf16 v[42:45], v[58:61], a[148:151], v[42:45]
  s_waitcnt lgkmcnt(9)
  ds_read_b64_tr_b16 v[56:57], v81 offset:2624
  v_mfma_f32_16x16x32_bf16 v[24:27], v[62:65], a[68:71], v[24:27]
  ds_read_b64_tr_b16 v[58:59], v107
  v_mfma_f32_16x16x32_bf16 v[46:49], v[62:65], a[148:151], v[46:49]
  s_waitcnt lgkmcnt(9)
  ds_read_b64_tr_b16 v[60:61], v107 offset:2560
  v_mfma_f32_16x16x32_bf16 v[28:31], v[68:71], a[68:71], v[28:31]
  ds_read_b64_tr_b16 v[62:63], v33 offset:5120
  v_mfma_f32_16x16x32_bf16 v[50:53], v[68:71], a[148:151], v[50:53]
  s_waitcnt lgkmcnt(9)
  ds_read_b64_tr_b16 v[64:65], v33 offset:7680
  s_waitcnt vmcnt(7)
  v_mfma_f32_16x16x32_bf16 v[12:15], v[72:75], a[12:15], v[12:15]
  ds_read_b64_tr_b16 v[68:69], v81 offset:5120
  buffer_load_dwordx4 a[16:19], v6, s[36:39], s80 offen sc1
  s_waitcnt vmcnt(7)
  v_mfma_f32_16x16x32_bf16 v[34:37], v[72:75], a[92:95], v[34:37]
  s_waitcnt lgkmcnt(9)
  ds_read_b64_tr_b16 v[70:71], v81 offset:7680
  v_mfma_f32_16x16x32_bf16 v[16:19], v[76:79], a[12:15], v[16:19]
  ds_read_b64_tr_b16 v[72:73], v33 offset:5184
  v_mfma_f32_16x16x32_bf16 v[38:41], v[76:79], a[92:95], v[38:41]
  s_waitcnt lgkmcnt(9)
  ds_read_b64_tr_b16 v[74:75], v33 offset:7744
  v_mfma_f32_16x16x32_bf16 v[20:23], v[92:95], a[12:15], v[20:23]
  ds_read_b64_tr_b16 v[76:77], v81 offset:5184
  buffer_load_dwordx4 a[96:99], v116, s[36:39], s80 offen sc1
  v_mfma_f32_16x16x32_bf16 v[42:45], v[92:95], a[92:95], v[42:45]
  s_waitcnt lgkmcnt(9)
  ds_read_b64_tr_b16 v[78:79], v81 offset:7744
  v_mfma_f32_16x16x32_bf16 v[24:27], v[54:57], a[12:15], v[24:27]
  ds_read_b64_tr_b16 v[92:93], v107 offset:5120
  v_mfma_f32_16x16x32_bf16 v[46:49], v[54:57], a[92:95], v[46:49]
  s_waitcnt lgkmcnt(9)
  ds_read_b64_tr_b16 v[94:95], v107 offset:7680
  v_mfma_f32_16x16x32_bf16 v[28:31], v[58:61], a[12:15], v[28:31]
  ds_read_b64_tr_b16 v[54:55], v33 offset:10240
  v_mfma_f32_16x16x32_bf16 v[50:53], v[58:61], a[92:95], v[50:53]
  s_waitcnt lgkmcnt(9)
  ds_read_b64_tr_b16 v[56:57], v33 offset:12800
  s_waitcnt vmcnt(7)
  v_mfma_f32_16x16x32_bf16 v[12:15], v[62:65], a[32:35], v[12:15]
  ds_read_b64_tr_b16 v[58:59], v81 offset:10240
  buffer_load_dwordx4 a[36:39], v112, s[36:39], s80 offen offset:1024 sc1
  s_waitcnt vmcnt(7)
  v_mfma_f32_16x16x32_bf16 v[34:37], v[62:65], a[112:115], v[34:37]
  s_waitcnt lgkmcnt(9)
  ds_read_b64_tr_b16 v[60:61], v81 offset:12800
  v_mfma_f32_16x16x32_bf16 v[16:19], v[68:71], a[32:35], v[16:19]
  ds_read_b64_tr_b16 v[62:63], v33 offset:10304
  v_mfma_f32_16x16x32_bf16 v[38:41], v[68:71], a[112:115], v[38:41]
  s_waitcnt lgkmcnt(9)
  ds_read_b64_tr_b16 v[64:65], v33 offset:12864
  v_mfma_f32_16x16x32_bf16 v[20:23], v[72:75], a[32:35], v[20:23]
  ds_read_b64_tr_b16 v[68:69], v81 offset:10304
  buffer_load_dwordx4 a[116:119], v117, s[36:39], s80 offen offset:1024 sc1
  v_mfma_f32_16x16x32_bf16 v[42:45], v[72:75], a[112:115], v[42:45]
  s_waitcnt lgkmcnt(9)
  ds_read_b64_tr_b16 v[70:71], v81 offset:12864
  v_mfma_f32_16x16x32_bf16 v[24:27], v[76:79], a[32:35], v[24:27]
  ds_read_b64_tr_b16 v[72:73], v107 offset:10240
  v_mfma_f32_16x16x32_bf16 v[46:49], v[76:79], a[112:115], v[46:49]
  s_waitcnt lgkmcnt(9)
  ds_read_b64_tr_b16 v[74:75], v107 offset:12800
  v_mfma_f32_16x16x32_bf16 v[28:31], v[92:95], a[32:35], v[28:31]
  ds_read_b64_tr_b16 v[76:77], v33 offset:15360
  v_mfma_f32_16x16x32_bf16 v[50:53], v[92:95], a[112:115], v[50:53]
  s_waitcnt lgkmcnt(9)
  ds_read_b64_tr_b16 v[78:79], v33 offset:17920
  s_waitcnt vmcnt(7)
  v_mfma_f32_16x16x32_bf16 v[12:15], v[54:57], a[52:55], v[12:15]
  ds_read_b64_tr_b16 v[92:93], v81 offset:15360
  buffer_load_dwordx4 a[56:59], v113, s[36:39], s80 offen offset:2048 sc1
  s_waitcnt vmcnt(7)
  v_mfma_f32_16x16x32_bf16 v[34:37], v[54:57], a[132:135], v[34:37]
  s_waitcnt lgkmcnt(9)
  ds_read_b64_tr_b16 v[94:95], v81 offset:17920
  v_mfma_f32_16x16x32_bf16 v[16:19], v[58:61], a[52:55], v[16:19]
  ds_read_b64_tr_b16 v[54:55], v33 offset:15424
  v_mfma_f32_16x16x32_bf16 v[38:41], v[58:61], a[132:135], v[38:41]
  s_waitcnt lgkmcnt(9)
  ds_read_b64_tr_b16 v[56:57], v33 offset:17984
  v_mfma_f32_16x16x32_bf16 v[20:23], v[62:65], a[52:55], v[20:23]
  ds_read_b64_tr_b16 v[58:59], v81 offset:15424
  buffer_load_dwordx4 a[136:139], v118, s[36:39], s80 offen offset:2048 sc1
  v_mfma_f32_16x16x32_bf16 v[42:45], v[62:65], a[132:135], v[42:45]
  s_waitcnt lgkmcnt(9)
  ds_read_b64_tr_b16 v[60:61], v81 offset:17984
  v_mfma_f32_16x16x32_bf16 v[24:27], v[68:71], a[52:55], v[24:27]
  ds_read_b64_tr_b16 v[62:63], v107 offset:15360
  v_mfma_f32_16x16x32_bf16 v[46:49], v[68:71], a[132:135], v[46:49]
  s_waitcnt lgkmcnt(9)
  ds_read_b64_tr_b16 v[64:65], v107 offset:17920
  v_mfma_f32_16x16x32_bf16 v[28:31], v[72:75], a[52:55], v[28:31]
  ds_read_b64_tr_b16 v[68:69], v109 offset:20480
  v_mfma_f32_16x16x32_bf16 v[50:53], v[72:75], a[132:135], v[50:53]
  s_waitcnt lgkmcnt(9)
  ds_read_b64_tr_b16 v[70:71], v109 offset:21120
  s_waitcnt vmcnt(7)
  v_mfma_f32_16x16x32_bf16 v[12:15], v[76:79], a[72:75], v[12:15]
  ds_read_b64_tr_b16 v[72:73], v110 offset:20480
  buffer_load_dwordx4 a[76:79], v114, s[36:39], s80 offen offset:3072 sc1
  s_waitcnt vmcnt(7)
  v_mfma_f32_16x16x32_bf16 v[34:37], v[76:79], a[152:155], v[34:37]
  s_waitcnt lgkmcnt(9)
  ds_read_b64_tr_b16 v[74:75], v110 offset:21120
  v_mfma_f32_16x16x32_bf16 v[16:19], v[92:95], a[72:75], v[16:19]
  ds_read_b64_tr_b16 v[76:77], v109 offset:20544
  v_mfma_f32_16x16x32_bf16 v[38:41], v[92:95], a[152:155], v[38:41]
  s_waitcnt lgkmcnt(9)
  ds_read_b64_tr_b16 v[78:79], v109 offset:21184
  v_mfma_f32_16x16x32_bf16 v[20:23], v[54:57], a[72:75], v[20:23]
  ds_read_b64_tr_b16 v[92:93], v110 offset:20544
  buffer_load_dwordx4 a[156:159], v119, s[36:39], s80 offen offset:3072 sc1
  v_mfma_f32_16x16x32_bf16 v[42:45], v[54:57], a[152:155], v[42:45]
  s_waitcnt lgkmcnt(9)
  ds_read_b64_tr_b16 v[94:95], v110 offset:21184
  v_mfma_f32_16x16x32_bf16 v[24:27], v[58:61], a[72:75], v[24:27]
  ds_read_b64_tr_b16 v[54:55], v111 offset:20480
  v_mfma_f32_16x16x32_bf16 v[46:49], v[58:61], a[152:155], v[46:49]
  s_waitcnt lgkmcnt(9)
  ds_read_b64_tr_b16 v[56:57], v111 offset:21120
  v_mfma_f32_16x16x32_bf16 v[28:31], v[62:65], a[72:75], v[28:31]
  ds_read_b64_tr_b16 v[58:59], v109 offset:25600
  v_mfma_f32_16x16x32_bf16 v[50:53], v[62:65], a[152:155], v[50:53]
  s_waitcnt lgkmcnt(9)
  ds_read_b64_tr_b16 v[60:61], v109 offset:26240
  s_waitcnt vmcnt(7)
  v_mfma_f32_16x16x32_bf16 v[12:15], v[68:71], a[16:19], v[12:15]
  ds_read_b64_tr_b16 v[62:63], v110 offset:25600
  s_waitcnt vmcnt(6)
  v_mfma_f32_16x16x32_bf16 v[34:37], v[68:71], a[96:99], v[34:37]
  s_waitcnt lgkmcnt(9)
  ds_read_b64_tr_b16 v[64:65], v110 offset:26240
  v_mfma_f32_16x16x32_bf16 v[16:19], v[72:75], a[16:19], v[16:19]
  ds_read_b64_tr_b16 v[68:69], v109 offset:25664
  v_mfma_f32_16x16x32_bf16 v[38:41], v[72:75], a[96:99], v[38:41]
  s_waitcnt lgkmcnt(9)
  ds_read_b64_tr_b16 v[70:71], v109 offset:26304
  v_mfma_f32_16x16x32_bf16 v[20:23], v[76:79], a[16:19], v[20:23]
  ds_read_b64_tr_b16 v[72:73], v110 offset:25664
  v_mfma_f32_16x16x32_bf16 v[42:45], v[76:79], a[96:99], v[42:45]
  s_waitcnt lgkmcnt(9)
  ds_read_b64_tr_b16 v[74:75], v110 offset:26304
  v_mfma_f32_16x16x32_bf16 v[24:27], v[92:95], a[16:19], v[24:27]
  ds_read_b64_tr_b16 v[76:77], v111 offset:25600
  v_mfma_f32_16x16x32_bf16 v[46:49], v[92:95], a[96:99], v[46:49]
  s_waitcnt lgkmcnt(9)
  ds_read_b64_tr_b16 v[78:79], v111 offset:26240
  v_mfma_f32_16x16x32_bf16 v[28:31], v[54:57], a[16:19], v[28:31]
  ds_read_b64_tr_b16 v[92:93], v109 offset:30720
  v_mfma_f32_16x16x32_bf16 v[50:53], v[54:57], a[96:99], v[50:53]
  s_waitcnt lgkmcnt(9)
  ds_read_b64_tr_b16 v[94:95], v109 offset:31360
  s_waitcnt vmcnt(5)
  v_mfma_f32_16x16x32_bf16 v[12:15], v[58:61], a[36:39], v[12:15]
  ds_read_b64_tr_b16 v[54:55], v110 offset:30720
  s_waitcnt vmcnt(4)
  v_mfma_f32_16x16x32_bf16 v[34:37], v[58:61], a[116:119], v[34:37]
  s_waitcnt lgkmcnt(9)
  ds_read_b64_tr_b16 v[56:57], v110 offset:31360
  v_mfma_f32_16x16x32_bf16 v[16:19], v[62:65], a[36:39], v[16:19]
  ds_read_b64_tr_b16 v[58:59], v109 offset:30784
  v_mfma_f32_16x16x32_bf16 v[38:41], v[62:65], a[116:119], v[38:41]
  s_waitcnt lgkmcnt(9)
  ds_read_b64_tr_b16 v[60:61], v109 offset:31424
  v_mfma_f32_16x16x32_bf16 v[20:23], v[68:71], a[36:39], v[20:23]
  ds_read_b64_tr_b16 v[62:63], v110 offset:30784
  v_mfma_f32_16x16x32_bf16 v[42:45], v[68:71], a[116:119], v[42:45]
  s_waitcnt lgkmcnt(9)
  ds_read_b64_tr_b16 v[64:65], v110 offset:31424
  v_mfma_f32_16x16x32_bf16 v[24:27], v[72:75], a[36:39], v[24:27]
  ds_read_b64_tr_b16 v[68:69], v111 offset:30720
  v_mfma_f32_16x16x32_bf16 v[46:49], v[72:75], a[116:119], v[46:49]
  s_waitcnt lgkmcnt(9)
  ds_read_b64_tr_b16 v[70:71], v111 offset:31360
  v_mfma_f32_16x16x32_bf16 v[28:31], v[76:79], a[36:39], v[28:31]
  ds_read_b64_tr_b16 v[72:73], v109 offset:35840
  v_mfma_f32_16x16x32_bf16 v[50:53], v[76:79], a[116:119], v[50:53]
  s_waitcnt lgkmcnt(9)
  ds_read_b64_tr_b16 v[74:75], v109 offset:36480
  s_waitcnt vmcnt(3)
  v_mfma_f32_16x16x32_bf16 v[12:15], v[92:95], a[56:59], v[12:15]
  ds_read_b64_tr_b16 v[76:77], v110 offset:35840
  s_waitcnt vmcnt(2)
  v_mfma_f32_16x16x32_bf16 v[34:37], v[92:95], a[136:139], v[34:37]
  s_waitcnt lgkmcnt(9)
  ds_read_b64_tr_b16 v[78:79], v110 offset:36480
  v_mfma_f32_16x16x32_bf16 v[16:19], v[54:57], a[56:59], v[16:19]
  ds_read_b64_tr_b16 v[92:93], v109 offset:35904
  v_mfma_f32_16x16x32_bf16 v[38:41], v[54:57], a[136:139], v[38:41]
  s_waitcnt lgkmcnt(9)
  ds_read_b64_tr_b16 v[94:95], v109 offset:36544
  v_mfma_f32_16x16x32_bf16 v[20:23], v[58:61], a[56:59], v[20:23]
  ds_read_b64_tr_b16 v[54:55], v110 offset:35904
  v_mfma_f32_16x16x32_bf16 v[42:45], v[58:61], a[136:139], v[42:45]
  s_waitcnt lgkmcnt(9)
  ds_read_b64_tr_b16 v[56:57], v110 offset:36544
  v_mfma_f32_16x16x32_bf16 v[24:27], v[62:65], a[56:59], v[24:27]
  ds_read_b64_tr_b16 v[58:59], v111 offset:35840
  v_mfma_f32_16x16x32_bf16 v[46:49], v[62:65], a[136:139], v[46:49]
  s_waitcnt lgkmcnt(9)
  ds_read_b64_tr_b16 v[60:61], v111 offset:36480
  v_mfma_f32_16x16x32_bf16 v[28:31], v[68:71], a[56:59], v[28:31]
  v_mfma_f32_16x16x32_bf16 v[50:53], v[68:71], a[136:139], v[50:53]
  s_waitcnt lgkmcnt(8)
  s_waitcnt vmcnt(1)
  v_mfma_f32_16x16x32_bf16 v[12:15], v[72:75], a[76:79], v[12:15]
  s_waitcnt vmcnt(0)
  v_mfma_f32_16x16x32_bf16 v[34:37], v[72:75], a[156:159], v[34:37]
  s_waitcnt lgkmcnt(6)
  v_mfma_f32_16x16x32_bf16 v[16:19], v[76:79], a[76:79], v[16:19]
  v_mfma_f32_16x16x32_bf16 v[38:41], v[76:79], a[156:159], v[38:41]
  s_waitcnt lgkmcnt(4)
  v_mfma_f32_16x16x32_bf16 v[20:23], v[92:95], a[76:79], v[20:23]
  v_mfma_f32_16x16x32_bf16 v[42:45], v[92:95], a[156:159], v[42:45]
  s_waitcnt lgkmcnt(2)
  v_mfma_f32_16x16x32_bf16 v[24:27], v[54:57], a[76:79], v[24:27]
  v_mfma_f32_16x16x32_bf16 v[46:49], v[54:57], a[156:159], v[46:49]
  s_waitcnt lgkmcnt(0)
  v_mfma_f32_16x16x32_bf16 v[28:31], v[58:61], a[76:79], v[28:31]
  v_mfma_f32_16x16x32_bf16 v[50:53], v[58:61], a[156:159], v[50:53]
  v_cvt_pk_bf16_f32 v124, v12, v13
  v_cvt_pk_bf16_f32 v125, v14, v15
  v_cvt_pk_bf16_f32 v126, v16, v17
  v_cvt_pk_bf16_f32 v127, v18, v19
  v_cvt_pk_bf16_f32 v128, v20, v21
  v_cvt_pk_bf16_f32 v129, v22, v23
  v_cvt_pk_bf16_f32 v130, v24, v25
  v_cvt_pk_bf16_f32 v131, v26, v27
  v_cmp_u_f32 vcc, v12, v34
  s_nop 4
  s_cbranch_vccnz L_redoB
L_stB:
  v_cndmask_b32_e64 v144, v124, v126, s[62:63]
  v_cndmask_b32_e64 v145, v125, v127, s[62:63]
  v_cndmask_b32_e64 v146, v126, v124, s[62:63]
  v_cndmask_b32_e64 v147, v127, v125, s[62:63]
  buffer_store_dwordx4 v[144:147], v121, s[48:51], 0 offen
  v_cndmask_b32_e64 v148, v128, v130, s[62:63]
  v_cndmask_b32_e64 v149, v129, v131, s[62:63]
  v_cndmask_b32_e64 v150, v130, v128, s[62:63]
  v_cndmask_b32_e64 v151, v131, v129, s[62:63]
  buffer_store_dwordx4 v[148:151], v121, s[48:51], 0 offen offset:64
  v_cvt_pk_bf16_f32 v132, v28, v29
  v_cvt_pk_bf16_f32 v133, v30, v31
  buffer_store_dwordx2 v[132:133], v122, s[48:51], 0 offen
  v_cvt_pk_bf16_f32 v134, v34, v35
  v_cvt_pk_bf16_f32 v135, v36, v37
  v_cvt_pk_bf16_f32 v136, v38, v39
  v_cvt_pk_bf16_f32 v137, v40, v41
  v_cvt_pk_bf16_f32 v138, v42, v43
  v_cvt_pk_bf16_f32 v139, v44, v45
  v_cvt_pk_bf16_f32 v140, v46, v47
  v_cvt_pk_bf16_f32 v141, v48, v49
  v_cndmask_b32_e64 v152, v134, v136, s[62:63]
  v_cndmask_b32_e64 v153, v135, v137, s[62:63]
  v_cndmask_b32_e64 v154, v136, v134, s[62:63]
  v_cndmask_b32_e64 v155, v137, v135, s[62:63]
  buffer_store_dwordx4 v[152:155], v121, s[48:51], s27 offen
  v_cndmask_b32_e64 v156, v138, v140, s[62:63]
  v_cndmask_b32_e64 v157, v139, v141, s[62:63]
  v_cndmask_b32_e64 v158, v140, v138, s[62:63]
  v_cndmask_b32_e64 v159, v141, v139, s[62:63]
  buffer_store_dwordx4 v[156:159], v121, s[48:51], s27 offen offset:64
  v_cvt_pk_bf16_f32 v142, v50, v51
  v_cvt_pk_bf16_f32 v143, v52, v53
  buffer_store_dwordx2 v[142:143], v122, s[48:51], s27 offen
  s_endpgm
L_redoB:
  s_add_u32 s92, s92, 1
  s_cmp_gt_u32 s92, 0xc8
  s_cbranch_scc1 L_stB
  s_sleep 8
  buffer_load_dwordx4 a[0:3], v6, s[36:39], s76 offen sc1
  buffer_load_dwordx4 a[80:83], v116, s[36:39], s76 offen sc1
  buffer_load_dwordx4 a[20:23], v112, s[36:39], s76 offen offset:1024 sc1
  buffer_load_dwordx4 a[100:103], v117, s[36:39], s76 offen offset:1024 sc1
  buffer_load_dwordx4 a[40:43], v113, s[36:39], s76 offen offset:2048 sc1
  buffer_load_dwordx4 a[120:123], v118, s[36:39], s76 offen offset:2048 sc1
  buffer_load_dwordx4 a[60:63], v114, s[36:39], s76 offen offset:3072 sc1
  buffer_load_dwordx4 a[140:143], v119, s[36:39], s76 offen offset:3072 sc1
  buffer_load_dwordx4 a[4:7], v6, s[36:39], s77 offen sc1
  buffer_load_dwordx4 a[84:87], v116, s[36:39], s77 offen sc1
  buffer_load_dwordx4 a[24:27], v112, s[36:39], s77 offen offset:1024 sc1
  buffer_load_dwordx4 a[104:107], v117, s[36:39], s77 offen offset:1024 sc1
  buffer_load_dwordx4 a[44:47], v113, s[36:39], s77 offen offset:2048 sc1
  buffer_load_dwordx4 a[124:127], v118, s[36:39], s77 offen offset:2048 sc1
  buffer_load_dwordx4 a[64:67], v114, s[36:39], s77 offen offset:3072 sc1
  buffer_load_dwordx4 a[144:147], v119, s[36:39], s77 offen offset:3072 sc1
  buffer_load_dwordx4 a[8:11], v6, s[36:39], s78 offen sc1
  buffer_load_dwordx4 a[88:91], v116, s[36:39], s78 offen sc1
  buffer_load_dwordx4 a[28:31], v112, s[36:39], s78 offen offset:1024 sc1
  buffer_load_dwordx4 a[108:111], v117, s[36:39], s78 offen offset:1024 sc1
  buffer_load_dwordx4 a[48:51], v113, s[36:39], s78 offen offset:2048 sc1
  buffer_load_dwordx4 a[128:131], v118, s[36:39], s78 offen offset:2048 sc1
  buffer_load_dwordx4 a[68:71], v114, s[36:39], s78 offen offset:3072 sc1
  buffer_load_dwordx4 a[148:151], v119, s[36:39], s78 offen offset:3072 sc1
  buffer_load_dwordx4 a[12:15], v6, s[36:39], s79 offen sc1
  buffer_load_dwordx4 a[92:95], v116, s[36:39], s79 offen sc1
  buffer_load_dwordx4 a[32:35], v112, s[36:39], s79 offen offset:1024 sc1
  buffer_load_dwordx4 a[112:115], v117, s[36:39], s79 offen offset:1024 sc1
  buffer_load_dwordx4 a[52:55], v113, s[36:39], s79 offen offset:2048 sc1
  buffer_load_dwordx4 a[132:135], v118, s[36:39], s79 offen offset:2048 sc1
  buffer_load_dwordx4 a[72:75], v114, s[36:39], s79 offen offset:3072 sc1
  buffer_load_dwordx4 a[152:155], v119, s[36:39], s79 offen offset:3072 sc1
  buffer_load_dwordx4 a[16:19], v6, s[36:39], s80 offen sc1
  buffer_load_dwordx4 a[96:99], v116, s[36:39], s80 offen sc1
  buffer_load_dwordx4 a[36:39], v112, s[36:39], s80 offen offset:1024 sc1
  buffer_load_dwordx4 a[116:119], v117, s[36:39], s80 offen offset:1024 sc1
  buffer_load_dwordx4 a[56:59], v113, s[36:39], s80 offen offset:2048 sc1
  buffer_load_dwordx4 a[136:139], v118, s[36:39], s80 offen offset:2048 sc1
  buffer_load_dwordx4 a[76:79], v114, s[36:39], s80 offen offset:3072 sc1
  buffer_load_dwordx4 a[156:159], v119, s[36:39], s80 offen offset:3072 sc1
  s_waitcnt vmcnt(0)
  ds_read_b64_tr_b16 v[54:55], v80
  ds_read_b64_tr_b16 v[56:57], v80 offset:2560
  ds_read_b64_tr_b16 v[58:59], v106
  ds_read_b64_tr_b16 v[60:61], v106 offset:2560
  ds_read_b64_tr_b16 v[62:63], v80 offset:64
  ds_read_b64_tr_b16 v[64:65], v80 offset:2624
  s_waitcnt lgkmcnt(4)
  v_mfma_f32_16x16x32_bf16 v[12:15], v[54:57], a[0:3], 0
  v_mfma_f32_16x16x32_bf16 v[34:37], v[54:57], a[80:83], 0
  ds_read_b64_tr_b16 v[68:69], v106 offset:64
  ds_read_b64_tr_b16 v[70:71], v106 offset:2624
  s_waitcnt lgkmcnt(4)
  v_mfma_f32_16x16x32_bf16 v[16:19], v[58:61], a[0:3], 0
  v_mfma_f32_16x16x32_bf16 v[38:41], v[58:61], a[80:83], 0
  ds_read_b64_tr_b16 v[72:73], v108
  ds_read_b64_tr_b16 v[74:75], v108 offset:2560
  s_waitcnt lgkmcnt(4)
  v_mfma_f32_16x16x32_bf16 v[20:23], v[62:65], a[0:3], 0
  v_mfma_f32_16x16x32_bf16 v[42:45], v[62:65], a[80:83], 0
  ds_read_b64_tr_b16 v[76:77], v80 offset:5120
  ds_read_b64_tr_b16 v[78:79], v80 offset:7680
  s_waitcnt lgkmcnt(4)
  v_mfma_f32_16x16x32_bf16 v[24:27], v[68:71], a[0:3], 0
  v_mfma_f32_16x16x32_bf16 v[46:49], v[68:71], a[80:83], 0
  ds_read_b64_tr_b16 v[92:93], v106 offset:5120
  ds_read_b64_tr_b16 v[94:95], v106 offset:7680
  s_waitcnt lgkmcnt(4)
  v_mfma_f32_16x16x32_bf16 v[28:31], v[72:75], a[0:3], 0
  v_mfma_f32_16x16x32_bf16 v[50:53], v[72:75], a[80:83], 0
  ds_read_b64_tr_b16 v[54:55], v80 offset:5184
  ds_read_b64_tr_b16 v[56:57], v80 offset:7744
  s_waitcnt lgkmcnt(4)
  v_mfma_f32_16x16x32_bf16 v[12:15], v[76:79], a[20:23], v[12:15]
  v_mfma_f32_16x16x32_bf16 v[34:37], v[76:79], a[100:103], v[34:37]
  ds_read_b64_tr_b16 v[58:59], v106 offset:5184
  ds_read_b64_tr_b16 v[60:61], v106 offset:7744
  s_waitcnt lgkmcnt(4)
  v_mfma_f32_16x16x32_bf16 v[16:19], v[92:95], a[20:23], v[16:19]
  v_mfma_f32_16x16x32_bf16 v[38:41], v[92:95], a[100:103], v[38:41]
  ds_read_b64_tr_b16 v[62:63], v108 offset:5120
  ds_read_b64_tr_b16 v[64:65], v108 offset:7680
  s_waitcnt lgkmcnt(4)
  v_mfma_f32_16x16x32_bf16 v[20:23], v[54:57], a[20:23], v[20:23]
  v_mfma_f32_16x16x32_bf16 v[42:45], v[54:57], a[100:103], v[42:45]
  ds_read_b64_tr_b16 v[68:69], v80 offset:10240
  ds_read_b64_tr_b16 v[70:71], v80 offset:12800
  s_waitcnt lgkmcnt(4)
  v_mfma_f32_16x16x32_bf16 v[24:27], v[58:61], a[20:23], v[24:27]
  v_mfma_f32_16x16x32_bf16 v[46:49], v[58:61], a[100:103], v[46:49]
  ds_read_b64_tr_b16 v[72:73], v106 offset:10240
  ds_read_b64_tr_b16 v[74:75], v106 offset:12800
  s_waitcnt lgkmcnt(4)
  v_mfma_f32_16x16x32_bf16 v[28:31], v[62:65], a[20:23], v[28:31]
  v_mfma_f32_16x16x32_bf16 v[50:53], v[62:65], a[100:103], v[50:53]
  ds_read_b64_tr_b16 v[76:77], v80 offset:10304
  ds_read_b64_tr_b16 v[78:79], v80 offset:12864
  s_waitcnt lgkmcnt(4)
  v_mfma_f32_16x16x32_bf16 v[12:15], v[68:71], a[40:43], v[12:15]
  v_mfma_f32_16x16x32_bf16 v[34:37], v[68:71], a[120:123], v[34:37]
  ds_read_b64_tr_b16 v[92:93], v106 offset:10304
  ds_read_b64_tr_b16 v[94:95], v106 offset:12864
  s_waitcnt lgkmcnt(4)
  v_mfma_f32_16x16x32_bf16 v[16:19], v[72:75], a[40:43], v[16:19]
  v_mfma_f32_16x16x32_bf16 v[38:41], v[72:75], a[120:123], v[38:41]
  ds_read_b64_tr_b16 v[54:55], v108 offset:10240
  ds_read_b64_tr_b16 v[56:57], v108 offset:12800
  s_waitcnt lgkmcnt(4)
  v_mfma_f32_16x16x32_bf16 v[20:23], v[76:79], a[40:43], v[20:23]
  v_mfma_f32_16x16x32_bf16 v[42:45], v[76:79], a[120:123], v[42:45]
  ds_read_b64_tr_b16 v[58:59], v80 offset:15360
  ds_read_b64_tr_b16 v[60:61], v80 offset:17920
  s_waitcnt lgkmcnt(4)
  v_mfma_f32_16x16x32_bf16 v[24:27], v[92:95], a[40:43], v[24:27]
  v_mfma_f32_16x16x32_bf16 v[46:49], v[92:95], a[120:123], v[46:49]
  ds_read_b64_tr_b16 v[62:63], v106 offset:15360
  ds_read_b64_tr_b16 v[64:65], v106 offset:17920
  s_waitcnt lgkmcnt(4)
  v_mfma_f32_16x16x32_bf16 v[28:31], v[54:57], a[40:43], v[28:31]
  v_mfma_f32_16x16x32_bf16 v[50:53], v[54:57], a[120:123], v[50:53]
  ds_read_b64_tr_b16 v[68:69], v80 offset:15424
  ds_read_b64_tr_b16 v[70:71], v80 offset:17984
  s_waitcnt lgkmcnt(4)
  v_mfma_f32_16x16x32_bf16 v[12:15], v[58:61], a[60:63], v[12:15]
  v_mfma_f32_16x16x32_bf16 v[34:37], v[58:61], a[140:143], v[34:37]
  ds_read_b64_tr_b16 v[72:73], v106 offset:15424
  ds_read_b64_tr_b16 v[74:75], v106 offset:17984
  s_waitcnt lgkmcnt(4)
  v_mfma_f32_16x16x32_bf16 v[16:19], v[62:65], a[60:63], v[16:19]
  v_mfma_f32_16x16x32_bf16 v[38:41], v[62:65], a[140:143], v[38:41]
  ds_read_b64_tr_b16 v[76:77], v108 offset:15360
  ds_read_b64_tr_b16 v[78:79], v108 offset:17920
  s_waitcnt lgkmcnt(4)
  v_mfma_f32_16x16x32_bf16 v[20:23], v[68:71], a[60:63], v[20:23]
  v_mfma_f32_16x16x32_bf16 v[42:45], v[68:71], a[140:143], v[42:45]
  ds_read_b64_tr_b16 v[92:93], v80 offset:20480
  ds_read_b64_tr_b16 v[94:95], v80 offset:23040
  s_waitcnt lgkmcnt(4)
  v_mfma_f32_16x16x32_bf16 v[24:27], v[72:75], a[60:63], v[24:27]
  v_mfma_f32_16x16x32_bf16 v[46:49], v[72:75], a[140:143], v[46:49]
  ds_read_b64_tr_b16 v[54:55], v106 offset:20480
  ds_read_b64_tr_b16 v[56:57], v106 offset:23040
  s_waitcnt lgkmcnt(4)
  v_mfma_f32_16x16x32_bf16 v[28:31], v[76:79], a[60:63], v[28:31]
  v_mfma_f32_16x16x32_bf16 v[50:53], v[76:79], a[140:143], v[50:53]
  ds_read_b64_tr_b16 v[58:59], v80 offset:20544
  ds_read_b64_tr_b16 v[60:61], v80 offset:23104
  s_waitcnt lgkmcnt(4)
  v_mfma_f32_16x16x32_bf16 v[12:15], v[92:95], a[4:7], v[12:15]
  v_mfma_f32_16x16x32_bf16 v[34:37], v[92:95], a[84:87], v[34:37]
  ds_read_b64_tr_b16 v[62:63], v106 offset:20544
  ds_read_b64_tr_b16 v[64:65], v106 offset:23104
  s_waitcnt lgkmcnt(4)
  v_mfma_f32_16x16x32_bf16 v[16:19], v[54:57], a[4:7], v[16:19]
  v_mfma_f32_16x16x32_bf16 v[38:41], v[54:57], a[84:87], v[38:41]
  ds_read_b64_tr_b16 v[68:69], v108 offset:20480
  ds_read_b64_tr_b16 v[70:71], v108 offset:23040
  s_waitcnt lgkmcnt(4)
  v_mfma_f32_16x16x32_bf16 v[20:23], v[58:61], a[4:7], v[20:23]
  v_mfma_f32_16x16x32_bf16 v[42:45], v[58:61], a[84:87], v[42:45]
  ds_read_b64_tr_b16 v[72:73], v80 offset:25600
  ds_read_b64_tr_b16 v[74:75], v80 offset:28160
  s_waitcnt lgkmcnt(4)
  v_mfma_f32_16x16x32_bf16 v[24:27], v[62:65], a[4:7], v[24:27]
  v_mfma_f32_16x16x32_bf16 v[46:49], v[62:65], a[84:87], v[46:49]
  ds_read_b64_tr_b16 v[76:77], v106 offset:25600
  ds_read_b64_tr_b16 v[78:79], v106 offset:28160
  s_waitcnt lgkmcnt(4)
  v_mfma_f32_16x16x32_bf16 v[28:31], v[68:71], a[4:7], v[28:31]
  v_mfma_f32_16x16x32_bf16 v[50:53], v[68:71], a[84:87], v[50:53]
  ds_read_b64_tr_b16 v[92:93], v80 offset:25664
  ds_read_b64_tr_b16 v[94:95], v80 offset:28224
  s_waitcnt lgkmcnt(4)
  v_mfma_f32_16x16x32_bf16 v[12:15], v[72:75], a[24:27], v[12:15]
  v_mfma_f32_16x16x32_bf16 v[34:37], v[72:75], a[104:107], v[34:37]
  ds_read_b64_tr_b16 v[54:55], v106 offset:25664
  ds_read_b64_tr_b16 v[56:57], v106 offset:28224
  s_waitcnt lgkmcnt(4)
  v_mfma_f32_16x16x32_bf16 v[16:19], v[76:79], a[24:27], v[16:19]
  v_mfma_f32_16x16x32_bf16 v[38:41], v[76:79], a[104:107], v[38:41]
  ds_read_b64_tr_b16 v[58:59], v108 offset:25600
  ds_read_b64_tr_b16 v[60:61], v108 offset:28160
  s_waitcnt lgkmcnt(4)
  v_mfma_f32_16x16x32_bf16 v[20:23], v[92:95], a[24:27], v[20:23]
  v_mfma_f32_16x16x32_bf16 v[42:45], v[92:95], a[104:107], v[42:45]
  ds_read_b64_tr_b16 v[62:63], v80 offset:30720
  ds_read_b64_tr_b16 v[64:65], v80 offset:33280
  s_waitcnt lgkmcnt(4)
  v_mfma_f32_16x16x32_bf16 v[24:27], v[54:57], a[24:27], v[24:27]
  v_mfma_f32_16x16x32_bf16 v[46:49], v[54:57], a[104:107], v[46:49]
  ds_read_b64_tr_b16 v[68:69], v106 offset:30720
  ds_read_b64_tr_b16 v[70:71], v106 offset:33280
  s_waitcnt lgkmcnt(4)
  v_mfma_f32_16x16x32_bf16 v[28:31], v[58:61], a[24:27], v[28:31]
  v_mfma_f32_16x16x32_bf16 v[50:53], v[58:61], a[104:107], v[50:53]
  ds_read_b64_tr_b16 v[72:73], v80 offset:30784
  ds_read_b64_tr_b16 v[74:75], v80 offset:33344
  s_waitcnt lgkmcnt(4)
  v_mfma_f32_16x16x32_bf16 v[12:15], v[62:65], a[44:47], v[12:15]
  v_mfma_f32_16x16x32_bf16 v[34:37], v[62:65], a[124:127], v[34:37]
  ds_read_b64_tr_b16 v[76:77], v106 offset:30784
  ds_read_b64_tr_b16 v[78:79], v106 offset:33344
  s_waitcnt lgkmcnt(4)
  v_mfma_f32_16x16x32_bf16 v[16:19], v[68:71], a[44:47], v[16:19]
  v_mfma_f32_16x16x32_bf16 v[38:41], v[68:71], a[124:127], v[38:41]
  ds_read_b64_tr_b16 v[92:93], v108 offset:30720
  ds_read_b64_tr_b16 v[94:95], v108 offset:33280
  s_waitcnt lgkmcnt(4)
  v_mfma_f32_16x16x32_bf16 v[20:23], v[72:75], a[44:47], v[20:23]
  v_mfma_f32_16x16x32_bf16 v[42:45], v[72:75], a[124:127], v[42:45]
  ds_read_b64_tr_b16 v[54:55], v80 offset:35840
  ds_read_b64_tr_b16 v[56:57], v80 offset:38400
  s_waitcnt lgkmcnt(4)
  v_mfma_f32_16x16x32_bf16 v[24:27], v[76:79], a[44:47], v[24:27]
  v_mfma_f32_16x16x32_bf16 v[46:49], v[76:79], a[124:127], v[46:49]
  ds_read_b64_tr_b16 v[58:59], v106 offset:35840
  ds_read_b64_tr_b16 v[60:61], v106 offset:38400
  s_waitcnt lgkmcnt(4)
  v_mfma_f32_16x16x32_bf16 v[28:31], v[92:95], a[44:47], v[28:31]
  v_mfma_f32_16x16x32_bf16 v[50:53], v[92:95], a[124:127], v[50:53]
  ds_read_b64_tr_b16 v[62:63], v80 offset:35904
  ds_read_b64_tr_b16 v[64:65], v80 offset:38464
  s_waitcnt lgkmcnt(4)
  v_mfma_f32_16x16x32_bf16 v[12:15], v[54:57], a[64:67], v[12:15]
  v_mfma_f32_16x16x32_bf16 v[34:37], v[54:57], a[144:147], v[34:37]
  ds_read_b64_tr_b16 v[68:69], v106 offset:35904
  ds_read_b64_tr_b16 v[70:71], v106 offset:38464
  s_waitcnt lgkmcnt(4)
  v_mfma_f32_16x16x32_bf16 v[16:19], v[58:61], a[64:67], v[16:19]
  v_mfma_f32_16x16x32_bf16 v[38:41], v[58:61], a[144:147], v[38:41]
  ds_read_b64_tr_b16 v[72:73], v108 offset:35840
  ds_read_b64_tr_b16 v[74:75], v108 offset:38400
  s_waitcnt lgkmcnt(4)
  v_mfma_f32_16x16x32_bf16 v[20:23], v[62:65], a[64:67], v[20:23]
  v_mfma_f32_16x16x32_bf16 v[42:45], v[62:65], a[144:147], v[42:45]
  ds_read_b64_tr_b16 v[76:77], v80 offset:40960
  ds_read_b64_tr_b16 v[78:79], v80 offset:43520
  s_waitcnt lgkmcnt(4)
  v_mfma_f32_16x16x32_bf16 v[24:27], v[68:71], a[64:67], v[24:27]
  v_mfma_f32_16x16x32_bf16 v[46:49], v[68:71], a[144:147], v[46:49]
  ds_read_b64_tr_b16 v[92:93], v106 offset:40960
  ds_read_b64_tr_b16 v[94:95], v106 offset:43520
  s_waitcnt lgkmcnt(4)
  v_mfma_f32_16x16x32_bf16 v[28:31], v[72:75], a[64:67], v[28:31]
  v_mfma_f32_16x16x32_bf16 v[50:53], v[72:75], a[144:147], v[50:53]
  ds_read_b64_tr_b16 v[54:55], v80 offset:41024
  ds_read_b64_tr_b16 v[56:57], v80 offset:43584
  s_waitcnt lgkmcnt(4)
  v_mfma_f32_16x16x32_bf16 v[12:15], v[76:79], a[8:11], v[12:15]
  v_mfma_f32_16x16x32_bf16 v[34:37], v[76:79], a[88:91], v[34:37]
  ds_read_b64_tr_b16 v[58:59], v106 offset:41024
  ds_read_b64_tr_b16 v[60:61], v106 offset:43584
  s_waitcnt lgkmcnt(4)
  v_mfma_f32_16x16x32_bf16 v[16:19], v[92:95], a[8:11], v[16:19]
  v_mfma_f32_16x16x32_bf16 v[38:41], v[92:95], a[88:91], v[38:41]
  ds_read_b64_tr_b16 v[62:63], v108 offset:40960
  ds_read_b64_tr_b16 v[64:65], v108 offset:43520
  s_waitcnt lgkmcnt(4)
  v_mfma_f32_16x16x32_bf16 v[20:23], v[54:57], a[8:11], v[20:23]
  v_mfma_f32_16x16x32_bf16 v[42:45], v[54:57], a[88:91], v[42:45]
  ds_read_b64_tr_b16 v[68:69], v80 offset:46080
  ds_read_b64_tr_b16 v[70:71], v80 offset:48640
  s_waitcnt lgkmcnt(4)
  v_mfma_f32_16x16x32_bf16 v[24:27], v[58:61], a[8:11], v[24:27]
  v_mfma_f32_16x16x32_bf16 v[46:49], v[58:61], a[88:91], v[46:49]
  ds_read_b64_tr_b16 v[72:73], v106 offset:46080
  ds_read_b64_tr_b16 v[74:75], v106 offset:48640
  s_waitcnt lgkmcnt(4)
  v_mfma_f32_16x16x32_bf16 v[28:31], v[62:65], a[8:11], v[28:31]
  v_mfma_f32_16x16x32_bf16 v[50:53], v[62:65], a[88:91], v[50:53]
  ds_read_b64_tr_b16 v[76:77], v80 offset:46144
  ds_read_b64_tr_b16 v[78:79], v80 offset:48704
  s_waitcnt lgkmcnt(4)
  v_mfma_f32_16x16x32_bf16 v[12:15], v[68:71], a[28:31], v[12:15]
  v_mfma_f32_16x16x32_bf16 v[34:37], v[68:71], a[108:111], v[34:37]
  ds_read_b64_tr_b16 v[92:93], v106 offset:46144
  ds_read_b64_tr_b16 v[94:95], v106 offset:48704
  s_waitcnt lgkmcnt(4)
  v_mfma_f32_16x16x32_bf16 v[16:19], v[72:75], a[28:31], v[16:19]
  v_mfma_f32_16x16x32_bf16 v[38:41], v[72:75], a[108:111], v[38:41]
  ds_read_b64_tr_b16 v[54:55], v108 offset:46080
  ds_read_b64_tr_b16 v[56:57], v108 offset:48640
  s_waitcnt lgkmcnt(4)
  v_mfma_f32_16x16x32_bf16 v[20:23], v[76:79], a[28:31], v[20:23]
  v_mfma_f32_16x16x32_bf16 v[42:45], v[76:79], a[108:111], v[42:45]
  ds_read_b64_tr_b16 v[58:59], v80 offset:51200
  ds_read_b64_tr_b16 v[60:61], v80 offset:53760
  s_waitcnt lgkmcnt(4)
  v_mfma_f32_16x16x32_bf16 v[24:27], v[92:95], a[28:31], v[24:27]
  v_mfma_f32_16x16x32_bf16 v[46:49], v[92:95], a[108:111], v[46:49]
  ds_read_b64_tr_b16 v[62:63], v106 offset:51200
  ds_read_b64_tr_b16 v[64:65], v106 offset:53760
  s_waitcnt lgkmcnt(4)
  v_mfma_f32_16x16x32_bf16 v[28:31], v[54:57], a[28:31], v[28:31]
  v_mfma_f32_16x16x32_bf16 v[50:53], v[54:57], a[108:111], v[50:53]
  ds_read_b64_tr_b16 v[68:69], v80 offset:51264
  ds_read_b64_tr_b16 v[70:71], v80 offset:53824
  s_waitcnt lgkmcnt(4)
  v_mfma_f32_16x16x32_bf16 v[12:15], v[58:61], a[48:51], v[12:15]
  v_mfma_f32_16x16x32_bf16 v[34:37], v[58:61], a[128:131], v[34:37]
  ds_read_b64_tr_b16 v[72:73], v106 offset:51264
  ds_read_b64_tr_b16 v[74:75], v106 offset:53824
  s_waitcnt lgkmcnt(4)
  v_mfma_f32_16x16x32_bf16 v[16:19], v[62:65], a[48:51], v[16:19]
  v_mfma_f32_16x16x32_bf16 v[38:41], v[62:65], a[128:131], v[38:41]
  ds_read_b64_tr_b16 v[76:77], v108 offset:51200
  ds_read_b64_tr_b16 v[78:79], v108 offset:53760
  s_waitcnt lgkmcnt(4)
  v_mfma_f32_16x16x32_bf16 v[20:23], v[68:71], a[48:51], v[20:23]
  v_mfma_f32_16x16x32_bf16 v[42:45], v[68:71], a[128:131], v[42:45]
  ds_read_b64_tr_b16 v[92:93], v80 offset:56320
  ds_read_b64_tr_b16 v[94:95], v80 offset:58880
  s_waitcnt lgkmcnt(4)
  v_mfma_f32_16x16x32_bf16 v[24:27], v[72:75], a[48:51], v[24:27]
  v_mfma_f32_16x16x32_bf16 v[46:49], v[72:75], a[128:131], v[46:49]
  ds_read_b64_tr_b16 v[54:55], v106 offset:56320
  ds_read_b64_tr_b16 v[56:57], v106 offset:58880
  s_waitcnt lgkmcnt(4)
  v_mfma_f32_16x16x32_bf16 v[28:31], v[76:79], a[48:51], v[28:31]
  v_mfma_f32_16x16x32_bf16 v[50:53], v[76:79], a[128:131], v[50:53]
  ds_read_b64_tr_b16 v[58:59], v80 offset:56384
  ds_read_b64_tr_b16 v[60:61], v80 offset:58944
  s_waitcnt lgkmcnt(4)
  v_mfma_f32_16x16x32_bf16 v[12:15], v[92:95], a[68:71], v[12:15]
  v_mfma_f32_16x16x32_bf16 v[34:37], v[92:95], a[148:151], v[34:37]
  ds_read_b64_tr_b16 v[62:63], v106 offset:56384
  ds_read_b64_tr_b16 v[64:65], v106 offset:58944
  s_waitcnt lgkmcnt(4)
  v_mfma_f32_16x16x32_bf16 v[16:19], v[54:57], a[68:71], v[16:19]
  v_mfma_f32_16x16x32_bf16 v[38:41], v[54:57], a[148:151], v[38:41]
  ds_read_b64_tr_b16 v[68:69], v108 offset:56320
  ds_read_b64_tr_b16 v[70:71], v108 offset:58880
  s_waitcnt lgkmcnt(4)
  v_mfma_f32_16x16x32_bf16 v[20:23], v[58:61], a[68:71], v[20:23]
  v_mfma_f32_16x16x32_bf16 v[42:45], v[58:61], a[148:151], v[42:45]
  ds_read_b64_tr_b16 v[72:73], v33
  ds_read_b64_tr_b16 v[74:75], v33 offset:2560
  s_waitcnt lgkmcnt(4)
  v_mfma_f32_16x16x32_bf16 v[24:27], v[62:65], a[68:71], v[24:27]
  v_mfma_f32_16x16x32_bf16 v[46:49], v[62:65], a[148:151], v[46:49]
  ds_read_b64_tr_b16 v[76:77], v81
  ds_read_b64_tr_b16 v[78:79], v81 offset:2560
  s_waitcnt lgkmcnt(4)
  v_mfma_f32_16x16x32_bf16 v[28:31], v[68:71], a[68:71], v[28:31]
  v_mfma_f32_16x16x32_bf16 v[50:53], v[68:71], a[148:151], v[50:53]
  ds_read_b64_tr_b16 v[92:93], v33 offset:64
  ds_read_b64_tr_b16 v[94:95], v33 offset:2624
  s_waitcnt lgkmcnt(4)
  v_mfma_f32_16x16x32_bf16 v[12:15], v[72:75], a[12:15], v[12:15]
  v_mfma_f32_16x16x32_bf16 v[34:37], v[72:75], a[92:95], v[34:37]
  ds_read_b64_tr_b16 v[54:55], v81 offset:64
  ds_read_b64_tr_b16 v[56:57], v81 offset:2624
  s_waitcnt lgkmcnt(4)
  v_mfma_f32_16x16x32_bf16 v[16:19], v[76:79], a[12:15], v[16:19]
  v_mfma_f32_16x16x32_bf16 v[38:41], v[76:79], a[92:95], v[38:41]
  ds_read_b64_tr_b16 v[58:59], v107
  ds_read_b64_tr_b16 v[60:61], v107 offset:2560
  s_waitcnt lgkmcnt(4)
  v_mfma_f32_16x16x32_bf16 v[20:23], v[92:95], a[12:15], v[20:23]
  v_mfma_f32_16x16x32_bf16 v[42:45], v[92:95], a[92:95], v[42:45]
  ds_read_b64_tr_b16 v[62:63], v33 offset:5120
  ds_read_b64_tr_b16 v[64:65], v33 offset:7680
  s_waitcnt lgkmcnt(4)
  v_mfma_f32_16x16x32_bf16 v[24:27], v[54:57], a[12:15], v[24:27]
  v_mfma_f32_16x16x32_bf16 v[46:49], v[54:57], a[92:95], v[46:49]
  ds_read_b64_tr_b16 v[68:69], v81 offset:5120
  ds_read_b64_tr_b16 v[70:71], v81 offset:7680
  s_waitcnt lgkmcnt(4)
  v_mfma_f32_16x16x32_bf16 v[28:31], v[58:61], a[12:15], v[28:31]
  v_mfma_f32_16x16x32_bf16 v[50:53], v[58:61], a[92:95], v[50:53]
  ds_read_b64_tr_b16 v[72:73], v33 offset:5184
  ds_read_b64_tr_b16 v[74:75], v33 offset:7744
  s_waitcnt lgkmcnt(4)
  v_mfma_f32_16x16x32_bf16 v[12:15], v[62:65], a[32:35], v[12:15]
  v_mfma_f32_16x16x32_bf16 v[34:37], v[62:65], a[112:115], v[34:37]
  ds_read_b64_tr_b16 v[76:77], v81 offset:5184
  ds_read_b64_tr_b16 v[78:79], v81 offset:7744
  s_waitcnt lgkmcnt(4)
  v_mfma_f32_16x16x32_bf16 v[16:19], v[68:71], a[32:35], v[16:19]
  v_mfma_f32_16x16x32_bf16 v[38:41], v[68:71], a[112:115], v[38:41]
  ds_read_b64_tr_b16 v[92:93], v107 offset:5120
  ds_read_b64_tr_b16 v[94:95], v107 offset:7680
  s_waitcnt lgkmcnt(4)
  v_mfma_f32_16x16x32_bf16 v[20:23], v[72:75], a[32:35], v[20:23]
  v_mfma_f32_16x16x32_bf16 v[42:45], v[72:75], a[112:115], v[42:45]
  ds_read_b64_tr_b16 v[54:55], v33 offset:10240
  ds_read_b64_tr_b16 v[56:57], v33 offset:12800
  s_waitcnt lgkmcnt(4)
  v_mfma_f32_16x16x32_bf16 v[24:27], v[76:79], a[32:35], v[24:27]
  v_mfma_f32_16x16x32_bf16 v[46:49], v[76:79], a[112:115], v[46:49]
  ds_read_b64_tr_b16 v[58:59], v81 offset:10240
  ds_read_b64_tr_b16 v[60:61], v81 offset:12800
  s_waitcnt lgkmcnt(4)
  v_mfma_f32_16x16x32_bf16 v[28:31], v[92:95], a[32:35], v[28:31]
  v_mfma_f32_16x16x32_bf16 v[50:53], v[92:95], a[112:115], v[50:53]
  ds_read_b64_tr_b16 v[62:63], v33 offset:10304
  ds_read_b64_tr_b16 v[64:65], v33 offset:12864
  s_waitcnt lgkmcnt(4)
  v_mfma_f32_16x16x32_bf16 v[12:15], v[54:57], a[52:55], v[12:15]
  v_mfma_f32_16x16x32_bf16 v[34:37], v[54:57], a[132:135], v[34:37]
  ds_read_b64_tr_b16 v[68:69], v81 offset:10304
  ds_read_b64_tr_b16 v[70:71], v81 offset:12864
  s_waitcnt lgkmcnt(4)
  v_mfma_f32_16x16x32_bf16 v[16:19], v[58:61], a[52:55], v[16:19]
  v_mfma_f32_16x16x32_bf16 v[38:41], v[58:61], a[132:135], v[38:41]
  ds_read_b64_tr_b16 v[72:73], v107 offset:10240
  ds_read_b64_tr_b16 v[74:75], v107 offset:12800
  s_waitcnt lgkmcnt(4)
  v_mfma_f32_16x16x32_bf16 v[20:23], v[62:65], a[52:55], v[20:23]
  v_mfma_f32_16x16x32_bf16 v[42:45], v[62:65], a[132:135], v[42:45]
  ds_read_b64_tr_b16 v[76:77], v33 offset:15360
  ds_read_b64_tr_b16 v[78:79], v33 offset:17920
  s_waitcnt lgkmcnt(4)
  v_mfma_f32_16x16x32_bf16 v[24:27], v[68:71], a[52:55], v[24:27]
  v_mfma_f32_16x16x32_bf16 v[46:49], v[68:71], a[132:135], v[46:49]
  ds_read_b64_tr_b16 v[92:93], v81 offset:15360
  ds_read_b64_tr_b16 v[94:95], v81 offset:17920
  s_waitcnt lgkmcnt(4)
  v_mfma_f32_16x16x32_bf16 v[28:31], v[72:75], a[52:55], v[28:31]
  v_mfma_f32_16x16x32_bf16 v[50:53], v[72:75], a[132:135], v[50:53]
  ds_read_b64_tr_b16 v[54:55], v33 offset:15424
  ds_read_b64_tr_b16 v[56:57], v33 offset:17984
  s_waitcnt lgkmcnt(4)
  v_mfma_f32_16x16x32_bf16 v[12:15], v[76:79], a[72:75], v[12:15]
  v_mfma_f32_16x16x32_bf16 v[34:37], v[76:79], a[152:155], v[34:37]
  ds_read_b64_tr_b16 v[58:59], v81 offset:15424
  ds_read_b64_tr_b16 v[60:61], v81 offset:17984
  s_waitcnt lgkmcnt(4)
  v_mfma_f32_16x16x32_bf16 v[16:19], v[92:95], a[72:75], v[16:19]
  v_mfma_f32_16x16x32_bf16 v[38:41], v[92:95], a[152:155], v[38:41]
  ds_read_b64_tr_b16 v[62:63], v107 offset:15360
  ds_read_b64_tr_b16 v[64:65], v107 offset:17920
  s_waitcnt lgkmcnt(4)
  v_mfma_f32_16x16x32_bf16 v[20:23], v[54:57], a[72:75], v[20:23]
  v_mfma_f32_16x16x32_bf16 v[42:45], v[54:57], a[152:155], v[42:45]
  ds_read_b64_tr_b16 v[68:69], v109 offset:20480
  ds_read_b64_tr_b16 v[70:71], v109 offset:21120
  s_waitcnt lgkmcnt(4)
  v_mfma_f32_16x16x32_bf16 v[24:27], v[58:61], a[72:75], v[24:27]
  v_mfma_f32_16x16x32_bf16 v[46:49], v[58:61], a[152:155], v[46:49]
  ds_read_b64_tr_b16 v[72:73], v110 offset:20480
  ds_read_b64_tr_b16 v[74:75], v110 offset:21120
  s_waitcnt lgkmcnt(4)
  v_mfma_f32_16x16x32_bf16 v[28:31], v[62:65], a[72:75], v[28:31]
  v_mfma_f32_16x16x32_bf16 v[50:53], v[62:65], a[152:155], v[50:53]
  ds_read_b64_tr_b16 v[76:77], v109 offset:20544
  ds_read_b64_tr_b16 v[78:79], v109 offset:21184
  s_waitcnt lgkmcnt(4)
  v_mfma_f32_16x16x32_bf16 v[12:15], v[68:71], a[16:19], v[12:15]
  v_mfma_f32_16x16x32_bf16 v[34:37], v[68:71], a[96:99], v[34:37]
  ds_read_b64_tr_b16 v[92:93], v110 offset:20544
  ds_read_b64_tr_b16 v[94:95], v110 offset:21184
  s_waitcnt lgkmcnt(4)
  v_mfma_f32_16x16x32_bf16 v[16:19], v[72:75], a[16:19], v[16:19]
  v_mfma_f32_16x16x32_bf16 v[38:41], v[72:75], a[96:99], v[38:41]
  ds_read_b64_tr_b16 v[54:55], v111 offset:20480
  ds_read_b64_tr_b16 v[56:57], v111 offset:21120
  s_waitcnt lgkmcnt(4)
  v_mfma_f32_16x16x32_bf16 v[20:23], v[76:79], a[16:19], v[20:23]
  v_mfma_f32_16x16x32_bf16 v[42:45], v[76:79], a[96:99], v[42:45]
  ds_read_b64_tr_b16 v[58:59], v109 offset:25600
  ds_read_b64_tr_b16 v[60:61], v109 offset:26240
  s_waitcnt lgkmcnt(4)
  v_mfma_f32_16x16x32_bf16 v[24:27], v[92:95], a[16:19], v[24:27]
  v_mfma_f32_16x16x32_bf16 v[46:49], v[92:95], a[96:99], v[46:49]
  ds_read_b64_tr_b16 v[62:63], v110 offset:25600
  ds_read_b64_tr_b16 v[64:65], v110 offset:26240
  s_waitcnt lgkmcnt(4)
  v_mfma_f32_16x16x32_bf16 v[28:31], v[54:57], a[16:19], v[28:31]
  v_mfma_f32_16x16x32_bf16 v[50:53], v[54:57], a[96:99], v[50:53]
  ds_read_b64_tr_b16 v[68:69], v109 offset:25664
  ds_read_b64_tr_b16 v[70:71], v109 offset:26304
  s_waitcnt lgkmcnt(4)
  v_mfma_f32_16x16x32_bf16 v[12:15], v[58:61], a[36:39], v[12:15]
  v_mfma_f32_16x16x32_bf16 v[34:37], v[58:61], a[116:119], v[34:37]
  ds_read_b64_tr_b16 v[72:73], v110 offset:25664
  ds_read_b64_tr_b16 v[74:75], v110 offset:26304
  s_waitcnt lgkmcnt(4)
  v_mfma_f32_16x16x32_bf16 v[16:19], v[62:65], a[36:39], v[16:19]
  v_mfma_f32_16x16x32_bf16 v[38:41], v[62:65], a[116:119], v[38:41]
  ds_read_b64_tr_b16 v[76:77], v111 offset:25600
  ds_read_b64_tr_b16 v[78:79], v111 offset:26240
  s_waitcnt lgkmcnt(4)
  v_mfma_f32_16x16x32_bf16 v[20:23], v[68:71], a[36:39], v[20:23]
  v_mfma_f32_16x16x32_bf16 v[42:45], v[68:71], a[116:119], v[42:45]
  ds_read_b64_tr_b16 v[92:93], v109 offset:30720
  ds_read_b64_tr_b16 v[94:95], v109 offset:31360
  s_waitcnt lgkmcnt(4)
  v_mfma_f32_16x16x32_bf16 v[24:27], v[72:75], a[36:39], v[24:27]
  v_mfma_f32_16x16x32_bf16 v[46:49], v[72:75], a[116:119], v[46:49]
  ds_read_b64_tr_b16 v[54:55], v110 offset:30720
  ds_read_b64_tr_b16 v[56:57], v110 offset:31360
  s_waitcnt lgkmcnt(4)
  v_mfma_f32_16x16x32_bf16 v[28:31], v[76:79], a[36:39], v[28:31]
  v_mfma_f32_16x16x32_bf16 v[50:53], v[76:79], a[116:119], v[50:53]
  ds_read_b64_tr_b16 v[58:59], v109 offset:30784
  ds_read_b64_tr_b16 v[60:61], v109 offset:31424
  s_waitcnt lgkmcnt(4)
  v_mfma_f32_16x16x32_bf16 v[12:15], v[92:95], a[56:59], v[12:15]
  v_mfma_f32_16x16x32_bf16 v[34:37], v[92:95], a[136:139], v[34:37]
  ds_read_b64_tr_b16 v[62:63], v110 offset:30784
  ds_read_b64_tr_b16 v[64:65], v110 offset:31424
  s_waitcnt lgkmcnt(4)
  v_mfma_f32_16x16x32_bf16 v[16:19], v[54:57], a[56:59], v[16:19]
  v_mfma_f32_16x16x32_bf16 v[38:41], v[54:57], a[136:139], v[38:41]
  ds_read_b64_tr_b16 v[68:69], v111 offset:30720
  ds_read_b64_tr_b16 v[70:71], v111 offset:31360
  s_waitcnt lgkmcnt(4)
  v_mfma_f32_16x16x32_bf16 v[20:23], v[58:61], a[56:59], v[20:23]
  v_mfma_f32_16x16x32_bf16 v[42:45], v[58:61], a[136:139], v[42:45]
  ds_read_b64_tr_b16 v[72:73], v109 offset:35840
  ds_read_b64_tr_b16 v[74:75], v109 offset:36480
  s_waitcnt lgkmcnt(4)
  v_mfma_f32_16x16x32_bf16 v[24:27], v[62:65], a[56:59], v[24:27]
  v_mfma_f32_16x16x32_bf16 v[46:49], v[62:65], a[136:139], v[46:49]
  ds_read_b64_tr_b16 v[76:77], v110 offset:35840
  ds_read_b64_tr_b16 v[78:79], v110 offset:36480
  s_waitcnt lgkmcnt(4)
  v_mfma_f32_16x16x32_bf16 v[28:31], v[68:71], a[56:59], v[28:31]
  v_mfma_f32_16x16x32_bf16 v[50:53], v[68:71], a[136:139], v[50:53]
  ds_read_b64_tr_b16 v[92:93], v109 offset:35904
  ds_read_b64_tr_b16 v[94:95], v109 offset:36544
  s_waitcnt lgkmcnt(4)
  v_mfma_f32_16x16x32_bf16 v[12:15], v[72:75], a[76:79], v[12:15]
  v_mfma_f32_16x16x32_bf16 v[34:37], v[72:75], a[156:159], v[34:37]
  ds_read_b64_tr_b16 v[54:55], v110 offset:35904
  ds_read_b64_tr_b16 v[56:57], v110 offset:36544
  s_waitcnt lgkmcnt(4)
  v_mfma_f32_16x16x32_bf16 v[16:19], v[76:79], a[76:79], v[16:19]
  v_mfma_f32_16x16x32_bf16 v[38:41], v[76:79], a[156:159], v[38:41]
  ds_read_b64_tr_b16 v[58:59], v111 offset:35840
  ds_read_b64_tr_b16 v[60:61], v111 offset:36480
  s_waitcnt lgkmcnt(4)
  v_mfma_f32_16x16x32_bf16 v[20:23], v[92:95], a[76:79], v[20:23]
  v_mfma_f32_16x16x32_bf16 v[42:45], v[92:95], a[156:159], v[42:45]
  s_waitcnt lgkmcnt(2)
  v_mfma_f32_16x16x32_bf16 v[24:27], v[54:57], a[76:79], v[24:27]
  v_mfma_f32_16x16x32_bf16 v[46:49], v[54:57], a[156:159], v[46:49]
  s_waitcnt lgkmcnt(0)
  v_mfma_f32_16x16x32_bf16 v[28:31], v[58:61], a[76:79], v[28:31]
  v_mfma_f32_16x16x32_bf16 v[50:53], v[58:61], a[156:159], v[50:53]
  v_cvt_pk_bf16_f32 v124, v12, v13
  v_cvt_pk_bf16_f32 v125, v14, v15
  v_cvt_pk_bf16_f32 v126, v16, v17
  v_cvt_pk_bf16_f32 v127, v18, v19
  v_cvt_pk_bf16_f32 v128, v20, v21
  v_cvt_pk_bf16_f32 v129, v22, v23
  v_cvt_pk_bf16_f32 v130, v24, v25
  v_cvt_pk_bf16_f32 v131, v26, v27
  v_cmp_u_f32 vcc, v12, v34
  s_nop 4
  s_cbranch_vccnz L_redoB
  s_branch L_stB
L_end:
  s_endpgm
.section .rodata,"a"
.p2align 6
.amdhsa_kernel concat_heads__sliding_local_dilated__linear_attn_block__prompt_kernel
  .amdhsa_next_free_vgpr 512
  .amdhsa_next_free_sgpr 102
  .amdhsa_accum_offset 256
  .amdhsa_group_segment_fixed_size 0
  .amdhsa_kernarg_size 72
  .amdhsa_user_sgpr_count 2
  .amdhsa_user_sgpr_kernarg_segment_ptr 1
  .amdhsa_system_sgpr_workgroup_id_x 1
.end_amdhsa_kernel
```
